```python
import torch

def _softmax(x, axis=-1):
    return torch.softmax(x, dim=axis)
def _gelu(x):
    return torch.nn.functional.gelu(x, approximate="tanh")
def _silu(x):
    return torch.nn.functional.silu(x)
def _sigmoid(x):
    return torch.sigmoid(x)
def _layernorm(x, axis=-1, eps=1e-5):
    m = x.mean(dim=axis, keepdim=True)
    v = x.var(dim=axis, keepdim=True, unbiased=False)
    return (x - m) / torch.sqrt(v + eps)
def _scatter_add(tgt, idx, src, axis=0):
    return tgt.clone().index_add_(axis, idx, src)
def _segment_sum(src, seg, n):
    out = torch.zeros((n,) + src.shape[1:], dtype=src.dtype)
    return out.index_add_(0, seg, src)
def _pad(x, pw):
    flat = tuple(v for pair in reversed(pw) for v in pair)
    return torch.nn.functional.pad(x, flat)

kernel_name = 'concat_heads__ssm_conv_h3__ssm_conv_s5__prompt'

def setup_inputs():

    _w = (lambda a: (lambda t: t.to(torch.bfloat16) if t.is_floating_point() else t)(torch.as_tensor(a)))
    def _A_setup():
        B, S, D = 1, 2048, 640
        ks = 4
        return {
            "q": _w((lambda *s: torch.randn(*s, dtype=torch.bfloat16) * 0.05)(B, S, D)),
            "k": _w((lambda *s: torch.randn(*s, dtype=torch.bfloat16) * 0.2)(B, S, D)),
            "v": _w((lambda *s: torch.randn(*s, dtype=torch.bfloat16) * 0.2)(B, S, D)),
            "shift_k": _w((lambda *s: torch.randn(*s, dtype=torch.bfloat16) * 0.2)(D, ks) * 0.5),
            "ssm_k": _w((lambda *s: torch.randn(*s, dtype=torch.bfloat16) * 0.8)(D, S) * (1.0 / S ** 0.5)),
            "ssm_D": _w((lambda *s: torch.randn(*s, dtype=torch.bfloat16) * 0.2)(D)),
        }
    _A_in = _A_setup()

    def _B_setup():
        B, S, D = 1, 2048, 640
        P = D
        Lambda_re = -0.5 * (lambda _x: torch.exp(torch.as_tensor(_x)))((lambda *s: torch.randn(*s, dtype=torch.bfloat16) * 0.2)(P))
        Lambda_im = (lambda *s: torch.randn(*s, dtype=torch.bfloat16) * 0.4)(P) * 1.0
        B_re = (lambda *s: torch.randn(*s, dtype=torch.bfloat16) * 0.2)(P, D) * (D ** -0.5)
        B_im = (lambda *s: torch.randn(*s, dtype=torch.bfloat16) * 0.2)(P, D) * (D ** -0.5)
        C_re = (lambda *s: torch.randn(*s, dtype=torch.bfloat16) * 0.2)(D, P) * (P ** -0.5)
        C_im = (lambda *s: torch.randn(*s, dtype=torch.bfloat16) * 0.2)(D, P) * (P ** -0.5)
        log_dt = (lambda *s: torch.randn(*s, dtype=torch.bfloat16) * 0.2)(P) * 0.3 - 2.0
        Dskip = (lambda *s: torch.randn(*s, dtype=torch.bfloat16) * 0.05)(D)
        return {
            "x": _w((lambda *s: torch.randn(*s, dtype=torch.bfloat16) * 0.05)(B, S, D)),
            "Lambda_re": _w(Lambda_re),
            "Lambda_im": _w(Lambda_im),
            "B_re": _w(B_re),
            "B_im": _w(B_im),
            "C_re": _w(C_re),
            "C_im": _w(C_im),
            "log_dt": _w(log_dt),
            "Dskip": _w(Dskip),
        }
    _B_in = _B_setup()

    return {
        "A_q": _A_in["q"],
        "A_k": _A_in["k"],
        "A_v": _A_in["v"],
        "A_shift_k": _A_in["shift_k"],
        "A_ssm_k": _A_in["ssm_k"],
        "A_ssm_D": _A_in["ssm_D"],
        "B_x": _B_in["x"],
        "B_Lambda_re": _B_in["Lambda_re"],
        "B_Lambda_im": _B_in["Lambda_im"],
        "B_B_re": _B_in["B_re"],
        "B_B_im": _B_in["B_im"],
        "B_C_re": _B_in["C_re"],
        "B_C_im": _B_in["C_im"],
        "B_log_dt": _B_in["log_dt"],
        "B_Dskip": _B_in["Dskip"],
    }

def reference(A_q, A_k, A_v, A_shift_k, A_ssm_k, A_ssm_D, B_x, B_Lambda_re, B_Lambda_im, B_B_re, B_B_im, B_C_re, B_C_im, B_log_dt, B_Dskip):
    def _A_ref(q, k, v, shift_k, ssm_k, ssm_D):
        B, S, D = q.shape
        ks = shift_k.shape[-1]
        k_pad = _pad(k, ((0, 0), (ks - 1, 0), (0, 0)))
        k_shift = torch.zeros_like(k)
        for t in range(ks):
            k_shift = k_shift + k_pad[:, t:t + S, :] * shift_k[:, ks - 1 - t][None, None, :]
        kv = k_shift * v
        L = 2 * S
        kv_pad = _pad(kv, ((0, 0), (0, S), (0, 0)))
        kf_pad = _pad(ssm_k, ((0, 0), (0, S)))
        kv_f = (lambda x, axes=(-2,-1): torch.fft.rfft2(x.float(), dim=axes))(kv_pad[:, None, :, :], axes=(1, 2))
        kf_f = (lambda x, axes=(-2,-1): torch.fft.rfft2(x.float(), dim=axes))(kf_pad[:, None, :], axes=(1, 2))
        kf_f = (lambda x, *d: x.permute(*d))(kf_f, 1, 2, 0)
        y_f = kv_f * kf_f[None, :, :, :]
        y = (lambda x, s, axes=(-2,-1): torch.fft.irfft2(x, s=s, dim=axes).to(torch.bfloat16))(y_f, (1, L), axes=(1, 2))[:, 0, :S, :]
        y = y + kv * ssm_D[None, None, :]
        return q * y

    def _B_ref(x, Lambda_re, Lambda_im, B_re, B_im, C_re, C_im, log_dt, Dskip):
        Bsz, L, H = x.shape
        Lam = Lambda_re + 1j * Lambda_im
        Bmat = B_re + 1j * B_im
        Cmat = C_re + 1j * C_im
        dt = torch.exp(log_dt)
        Lam_bar = torch.exp(dt * Lam)
        B_bar = ((Lam_bar - 1.0) / Lam)[:, None] * Bmat
        Bu = torch.einsum("bld,pd->blp", x + 0j, B_bar)
        h = torch.zeros_like(Bu[:, 0, :])
        hs = []
        for t in range(L):
            h = Lam_bar[None, :] * h + Bu[:, t, :]
            hs.append(h)
        hseq = torch.stack(hs, 1)
        y = 2.0 * torch.einsum("blp,dp->bld", hseq, Cmat).real + x * Dskip[None, None, :]
        return y

    a = _A_ref(A_q, A_k, A_v, A_shift_k, A_ssm_k, A_ssm_D)
    b = _B_ref(B_x, B_Lambda_re, B_Lambda_im, B_B_re, B_B_im, B_C_re, B_C_im, B_log_dt, B_Dskip)
    return torch.concatenate([a, b], axis=-1)
```

```asm
; @launch grid=(256,1,1) block=(512,1,1) lds=163840
.amdgcn_target "amdgcn-amd-amdhsa--gfx950"
.text
.p2align 12
.globl concat_heads__ssm_conv_h3__ssm_conv_s5__prompt_kernel
.p2align 8
.type concat_heads__ssm_conv_h3__ssm_conv_s5__prompt_kernel,@function
concat_heads__ssm_conv_h3__ssm_conv_s5__prompt_kernel:
    s_cmp_ge_u32 s2, 256
    s_cbranch_scc1 L_exit
    s_load_dwordx16 s[48:63], s[0:1], 0
    s_load_dwordx16 s[64:79], s[0:1], 64
    s_load_dwordx4 s[80:83], s[0:1], 128
    v_lshrrev_b32 v4, 6, v0
    v_and_b32 v1, 63, v0
    v_readfirstlane_b32 s3, v4
    v_and_b32 v2, 15, v1
    v_lshrrev_b32 v3, 4, v1
    s_and_b32 s44, s2, 7
    s_lshr_b32 s45, s2, 3
    s_cmp_lg_u32 s45, 0
    s_cbranch_scc1 L_roles
    s_getpc_b64 s[12:13]
L_pc:
    s_sub_u32 s12, s12, L_pc-concat_heads__ssm_conv_h3__ssm_conv_s5__prompt_kernel
    s_subb_u32 s13, s13, 0
    v_lshlrev_b32 v4, 7, v0
    v_min_u32 v4, L_exit-concat_heads__ssm_conv_h3__ssm_conv_s5__prompt_kernel, v4
    global_load_dword v5, v4, s[12:13]
    s_branch L_pf2
L_roles:
    s_cmp_eq_u32 s45, 31
    s_cbranch_scc1 L_pf2
    s_cmp_ge_u32 s45, 21
    s_cbranch_scc1 L_conv
    s_sub_u32 s40, s45, 1
    s_and_b32 s36, s40, 3
    s_lshr_b32 s37, s40, 2
    s_lshr_b32 s38, s44, 1
    s_lshl_b32 s38, s38, 2
    s_add_u32 s38, s38, s36
    s_and_b32 s39, s44, 1
    s_mul_i32 s39, s39, 5
    s_add_u32 s39, s39, s37
    s_lshl_b32 s39, s39, 2
    s_and_b32 s47, s3, 3
    s_add_u32 s39, s39, s47
    s_lshl_b32 s100, s47, 12
    s_lshl_b32 s101, s47, 13
    s_movk_i32 s46, 1280
    s_add_u32 s45, s36, s37
    s_and_b32 s45, s45, 1
    s_cmp_lt_u32 s3, 4
    s_cbranch_scc1 L_gc
    v_and_b32 v4, 7, v1
    v_xor_b32 v4, v4, v3
    v_lshlrev_b32 v4, 4, v4
    v_xor_b32 v5, 64, v4
    v_lshrrev_b32 v6, 3, v1
    s_lshl_b32 s43, s38, 7
    s_lshr_b32 s47, s100, 11
    s_add_u32 s43, s43, s47
    v_lshl_add_u32 v7, v6, 3, s43
    v_mul_lo_u32 v7, v7, s46
    v_add_u32 v32, 0, v7
    v_add_u32 v32, v32, v4
    v_add_u32 v33, 81920, v7
    v_add_u32 v33, v33, v5
    v_add_u32 v34, 1280, v7
    v_add_u32 v34, v34, v4
    v_add_u32 v35, 83200, v7
    v_add_u32 v35, v35, v5
    s_lshl_b32 s43, s39, 4
    v_add_u32 v7, s43, v6
    v_mul_lo_u32 v7, v7, s46
    v_add_u32 v36, v7, v4
    v_add_u32 v37, 10240, v7
    v_add_u32 v37, v37, v5
    s_mov_b32 s14, 2621440
    s_mov_b32 s15, 0x00020000
    s_mov_b32 s18, 819200
    s_mov_b32 s19, 0x00020000
    s_mov_b32 s22, 819200
    s_mov_b32 s23, 0x00020000
    s_waitcnt lgkmcnt(0)
    s_load_dword s42, s[82:83], 2560
    s_mov_b32 s12, s60
    s_and_b32 s13, s61, 0xffff
    s_mov_b32 s16, s66
    s_and_b32 s17, s67, 0xffff
    s_mov_b32 s20, s68
    s_and_b32 s21, s69, 0xffff
    s_xor_b32 s40, s45, 0
    s_lshl_b32 s40, s40, 7
    s_add_u32 m0, s100, 0
    s_nop 0
    buffer_load_dwordx4 v32, s[12:15], s40 offen  lds
    s_add_u32 m0, s100, 1024
    s_nop 0
    buffer_load_dwordx4 v33, s[12:15], s40 offen  lds
    s_add_u32 m0, s100, 2048
    s_nop 0
    buffer_load_dwordx4 v34, s[12:15], s40 offen  lds
    s_add_u32 m0, s100, 3072
    s_nop 0
    buffer_load_dwordx4 v35, s[12:15], s40 offen  lds
    s_add_u32 m0, s100, 16384
    s_nop 0
    buffer_load_dwordx4 v36, s[16:19], s40 offen  lds
    s_add_u32 m0, s100, 17408
    s_nop 0
    buffer_load_dwordx4 v37, s[16:19], s40 offen  lds
    s_add_u32 m0, s100, 18432
    s_nop 0
    buffer_load_dwordx4 v36, s[20:23], s40 offen  lds
    s_add_u32 m0, s100, 19456
    s_nop 0
    buffer_load_dwordx4 v37, s[20:23], s40 offen  lds
    s_xor_b32 s40, s45, 1
    s_lshl_b32 s40, s40, 7
    s_add_u32 m0, s100, 32768
    s_nop 0
    buffer_load_dwordx4 v32, s[12:15], s40 offen  lds
    s_add_u32 m0, s100, 33792
    s_nop 0
    buffer_load_dwordx4 v33, s[12:15], s40 offen  lds
    s_add_u32 m0, s100, 34816
    s_nop 0
    buffer_load_dwordx4 v34, s[12:15], s40 offen  lds
    s_add_u32 m0, s100, 35840
    s_nop 0
    buffer_load_dwordx4 v35, s[12:15], s40 offen  lds
    s_add_u32 m0, s100, 49152
    s_nop 0
    buffer_load_dwordx4 v36, s[16:19], s40 offen  lds
    s_add_u32 m0, s100, 50176
    s_nop 0
    buffer_load_dwordx4 v37, s[16:19], s40 offen  lds
    s_add_u32 m0, s100, 51200
    s_nop 0
    buffer_load_dwordx4 v36, s[20:23], s40 offen  lds
    s_add_u32 m0, s100, 52224
    s_nop 0
    buffer_load_dwordx4 v37, s[20:23], s40 offen  lds
    s_waitcnt lgkmcnt(0)
    s_add_u32 s42, s42, 2654435769
    s_waitcnt vmcnt(8)
    s_barrier
    s_xor_b32 s40, s45, 2
    s_lshl_b32 s40, s40, 7
    s_add_u32 m0, s100, 65536
    s_nop 0
    buffer_load_dwordx4 v32, s[12:15], s40 offen  lds
    s_add_u32 m0, s100, 66560
    s_nop 0
    buffer_load_dwordx4 v33, s[12:15], s40 offen  lds
    s_add_u32 m0, s100, 67584
    s_nop 0
    buffer_load_dwordx4 v34, s[12:15], s40 offen  lds
    s_add_u32 m0, s100, 68608
    s_nop 0
    buffer_load_dwordx4 v35, s[12:15], s40 offen  lds
    s_add_u32 m0, s100, 81920
    s_nop 0
    buffer_load_dwordx4 v36, s[16:19], s40 offen  lds
    s_add_u32 m0, s100, 82944
    s_nop 0
    buffer_load_dwordx4 v37, s[16:19], s40 offen  lds
    s_add_u32 m0, s100, 83968
    s_nop 0
    buffer_load_dwordx4 v36, s[20:23], s40 offen  lds
    s_add_u32 m0, s100, 84992
    s_nop 0
    buffer_load_dwordx4 v37, s[20:23], s40 offen  lds
    s_mov_b32 s24, s70
    s_and_b32 s25, s71, 0xffff
    s_mov_b32 s26, 819200
    s_mov_b32 s27, 0x00020000
    s_mov_b32 s28, s72
    s_and_b32 s29, s73, 0xffff
    s_mov_b32 s30, 819200
    s_mov_b32 s31, 0x00020000
    s_mov_b32 s4, s82
    s_and_b32 s5, s83, 0xffff
    s_mov_b32 s6, 268435456
    s_mov_b32 s7, 0x00020000
    s_waitcnt vmcnt(8)
    s_barrier
    s_xor_b32 s40, s45, 3
    s_lshl_b32 s40, s40, 7
    s_add_u32 m0, s100, 98304
    s_nop 0
    buffer_load_dwordx4 v32, s[12:15], s40 offen  lds
    s_add_u32 m0, s100, 99328
    s_nop 0
    buffer_load_dwordx4 v33, s[12:15], s40 offen  lds
    s_add_u32 m0, s100, 100352
    s_nop 0
    buffer_load_dwordx4 v34, s[12:15], s40 offen  lds
    s_add_u32 m0, s100, 101376
    s_nop 0
    buffer_load_dwordx4 v35, s[12:15], s40 offen  lds
    s_add_u32 m0, s100, 114688
    s_nop 0
    buffer_load_dwordx4 v36, s[16:19], s40 offen  lds
    s_add_u32 m0, s100, 115712
    s_nop 0
    buffer_load_dwordx4 v37, s[16:19], s40 offen  lds
    s_add_u32 m0, s100, 116736
    s_nop 0
    buffer_load_dwordx4 v36, s[20:23], s40 offen  lds
    s_add_u32 m0, s100, 117760
    s_nop 0
    buffer_load_dwordx4 v37, s[20:23], s40 offen  lds
    s_lshl_b32 s41, s37, 2
    s_add_u32 s41, s41, s36
    s_and_b32 s43, s44, 1
    s_lshl_b32 s47, s43, 2
    s_add_u32 s36, s36, s47
    s_mul_i32 s43, s43, 3
    s_lshr_b32 s37, s41, 3
    s_add_u32 s37, s37, s43
    s_and_b32 s47, s41, 7
    s_cmp_lt_u32 s41, 16
    s_cselect_b32 s37, s37, 2
    s_cselect_b32 s36, s47, s36
    s_andn2_b32 s41, s44, 1
    s_lshl_b32 s41, s41, 2
    s_add_u32 s41, s41, s36
    s_mov_b32 s73, 0
    s_waitcnt vmcnt(8)
    s_barrier
    s_xor_b32 s40, s45, 4
    s_lshl_b32 s40, s40, 7
    s_add_u32 m0, s100, 131072
    s_nop 0
    buffer_load_dwordx4 v32, s[12:15], s40 offen  lds
    s_add_u32 m0, s100, 132096
    s_nop 0
    buffer_load_dwordx4 v33, s[12:15], s40 offen  lds
    s_add_u32 m0, s100, 133120
    s_nop 0
    buffer_load_dwordx4 v34, s[12:15], s40 offen  lds
    s_add_u32 m0, s100, 134144
    s_nop 0
    buffer_load_dwordx4 v35, s[12:15], s40 offen  lds
    s_add_u32 m0, s100, 147456
    s_nop 0
    buffer_load_dwordx4 v36, s[16:19], s40 offen  lds
    s_add_u32 m0, s100, 148480
    s_nop 0
    buffer_load_dwordx4 v37, s[16:19], s40 offen  lds
    s_add_u32 m0, s100, 149504
    s_nop 0
    buffer_load_dwordx4 v36, s[20:23], s40 offen  lds
    s_add_u32 m0, s100, 150528
    s_nop 0
    buffer_load_dwordx4 v37, s[20:23], s40 offen  lds
    s_lshl_b32 s43, s37, 7
    s_lshr_b32 s47, s100, 7
    s_add_u32 s43, s43, s47
    v_lshl_add_u32 v7, v6, 2, s43
    v_mul_lo_u32 v7, v7, s46
    v_add_u32 v20, 0, v7
    v_add_u32 v20, v20, v4
    v_add_u32 v21, 2560, v7
    v_add_u32 v21, v21, v5
    v_add_u32 v22, 1280, v7
    v_add_u32 v22, v22, v4
    v_add_u32 v23, 3840, v7
    v_add_u32 v23, v23, v5
    v_lshrrev_b32 v4, 1, v2
    v_lshrrev_b32 v5, 1, v3
    v_xor_b32 v5, v5, v4
    v_lshlrev_b32 v5, 4, v5
    v_lshl_add_u32 v16, v2, 7, v5
    v_and_b32 v5, 1, v3
    v_lshl_add_u32 v16, v5, 12, v16
    v_add_u32 v16, s101, v16
    v_lshlrev_b32 v4, 4, v1
    v_add_u32 v17, 65536, v4
    v_add_u32 v18, 131072, v4
    v_add_u32 v24, s101, v17
    s_mul_i32 s43, s41, 163840
    s_add_u32 s43, s43, s100
    s_add_u32 s43, s43, 1048576
    v_add_u32 v19, s43, v4
    s_waitcnt vmcnt(8)
    s_barrier
    s_xor_b32 s40, s45, 5
    s_lshl_b32 s40, s40, 7
    s_add_u32 m0, s100, 0
    s_nop 0
    buffer_load_dwordx4 v32, s[12:15], s40 offen  lds
    s_add_u32 m0, s100, 1024
    s_nop 0
    buffer_load_dwordx4 v33, s[12:15], s40 offen  lds
    s_add_u32 m0, s100, 2048
    s_nop 0
    buffer_load_dwordx4 v34, s[12:15], s40 offen  lds
    s_add_u32 m0, s100, 3072
    s_nop 0
    buffer_load_dwordx4 v35, s[12:15], s40 offen  lds
    s_add_u32 m0, s100, 16384
    s_nop 0
    buffer_load_dwordx4 v36, s[16:19], s40 offen  lds
    s_add_u32 m0, s100, 17408
    s_nop 0
    buffer_load_dwordx4 v37, s[16:19], s40 offen  lds
    s_add_u32 m0, s100, 18432
    s_nop 0
    buffer_load_dwordx4 v36, s[20:23], s40 offen  lds
    s_add_u32 m0, s100, 19456
    s_nop 0
    buffer_load_dwordx4 v37, s[20:23], s40 offen  lds
    s_lshl_b32 s43, s37, 7
    s_lshr_b32 s47, s100, 7
    s_add_u32 s43, s43, s47
    v_and_b32 v4, 7, v2
    v_lshl_add_u32 v4, v4, 2, s43
    v_lshrrev_b32 v6, 3, v2
    s_lshr_b32 s43, s41, 1
    s_lshl_b32 s43, s43, 7
    s_and_b32 s47, s41, 1
    s_lshl_b32 s47, s47, 2
    s_add_u32 s43, s43, s47
    v_lshl_add_u32 v5, v3, 5, s43
    v_mul_lo_u32 v5, v5, s46
    v_mul_u32_u24 v6, 10240, v6
    v_lshl_add_u32 v26, v4, 1, v5
    v_add_u32 v26, v26, v6
    v_lshlrev_b32 v27, 1, v4
    s_lshr_b32 s43, s41, 1
    s_mul_i32 s43, s43, 5120
    s_lshr_b32 s47, s100, 5
    s_nop 0
    s_add_u32 s43, s43, 262144
    v_min_u32 v4, 9, v1
    v_lshl_add_u32 v25, v4, 9, s43
    v_mov_b32 v29, 0
    s_waitcnt vmcnt(8)
    s_barrier
    s_xor_b32 s40, s45, 6
    s_lshl_b32 s40, s40, 7
    s_add_u32 m0, s100, 32768
    s_nop 0
    buffer_load_dwordx4 v32, s[12:15], s40 offen  lds
    s_add_u32 m0, s100, 33792
    s_nop 0
    buffer_load_dwordx4 v33, s[12:15], s40 offen  lds
    s_add_u32 m0, s100, 34816
    s_nop 0
    buffer_load_dwordx4 v34, s[12:15], s40 offen  lds
    s_add_u32 m0, s100, 35840
    s_nop 0
    buffer_load_dwordx4 v35, s[12:15], s40 offen  lds
    s_add_u32 m0, s100, 49152
    s_nop 0
    buffer_load_dwordx4 v36, s[16:19], s40 offen  lds
    s_add_u32 m0, s100, 50176
    s_nop 0
    buffer_load_dwordx4 v37, s[16:19], s40 offen  lds
    s_add_u32 m0, s100, 51200
    s_nop 0
    buffer_load_dwordx4 v36, s[20:23], s40 offen  lds
    s_add_u32 m0, s100, 52224
    s_nop 0
    buffer_load_dwordx4 v37, s[20:23], s40 offen  lds
    s_waitcnt vmcnt(8)
    s_barrier
    s_xor_b32 s40, s45, 7
    s_lshl_b32 s40, s40, 7
    s_add_u32 m0, s100, 65536
    s_nop 0
    buffer_load_dwordx4 v32, s[12:15], s40 offen  lds
    s_add_u32 m0, s100, 66560
    s_nop 0
    buffer_load_dwordx4 v33, s[12:15], s40 offen  lds
    s_add_u32 m0, s100, 67584
    s_nop 0
    buffer_load_dwordx4 v34, s[12:15], s40 offen  lds
    s_add_u32 m0, s100, 68608
    s_nop 0
    buffer_load_dwordx4 v35, s[12:15], s40 offen  lds
    s_add_u32 m0, s100, 81920
    s_nop 0
    buffer_load_dwordx4 v36, s[16:19], s40 offen  lds
    s_add_u32 m0, s100, 82944
    s_nop 0
    buffer_load_dwordx4 v37, s[16:19], s40 offen  lds
    s_add_u32 m0, s100, 83968
    s_nop 0
    buffer_load_dwordx4 v36, s[20:23], s40 offen  lds
    s_add_u32 m0, s100, 84992
    s_nop 0
    buffer_load_dwordx4 v37, s[20:23], s40 offen  lds
    s_waitcnt vmcnt(8)
    s_barrier
    s_xor_b32 s40, s45, 8
    s_lshl_b32 s40, s40, 7
    s_add_u32 m0, s100, 98304
    s_nop 0
    buffer_load_dwordx4 v32, s[12:15], s40 offen  lds
    s_add_u32 m0, s100, 99328
    s_nop 0
    buffer_load_dwordx4 v33, s[12:15], s40 offen  lds
    s_add_u32 m0, s100, 100352
    s_nop 0
    buffer_load_dwordx4 v34, s[12:15], s40 offen  lds
    s_add_u32 m0, s100, 101376
    s_nop 0
    buffer_load_dwordx4 v35, s[12:15], s40 offen  lds
    s_add_u32 m0, s100, 114688
    s_nop 0
    buffer_load_dwordx4 v36, s[16:19], s40 offen  lds
    s_add_u32 m0, s100, 115712
    s_nop 0
    buffer_load_dwordx4 v37, s[16:19], s40 offen  lds
    s_add_u32 m0, s100, 116736
    s_nop 0
    buffer_load_dwordx4 v36, s[20:23], s40 offen  lds
    s_add_u32 m0, s100, 117760
    s_nop 0
    buffer_load_dwordx4 v37, s[20:23], s40 offen  lds
    s_waitcnt vmcnt(8)
    s_barrier
    s_xor_b32 s40, s45, 9
    s_lshl_b32 s40, s40, 7
    s_add_u32 m0, s100, 131072
    s_nop 0
    buffer_load_dwordx4 v32, s[12:15], s40 offen  lds
    s_add_u32 m0, s100, 132096
    s_nop 0
    buffer_load_dwordx4 v33, s[12:15], s40 offen  lds
    s_add_u32 m0, s100, 133120
    s_nop 0
    buffer_load_dwordx4 v34, s[12:15], s40 offen  lds
    s_add_u32 m0, s100, 134144
    s_nop 0
    buffer_load_dwordx4 v35, s[12:15], s40 offen  lds
    s_add_u32 m0, s100, 147456
    s_nop 0
    buffer_load_dwordx4 v36, s[16:19], s40 offen  lds
    s_add_u32 m0, s100, 148480
    s_nop 0
    buffer_load_dwordx4 v37, s[16:19], s40 offen  lds
    s_add_u32 m0, s100, 149504
    s_nop 0
    buffer_load_dwordx4 v36, s[20:23], s40 offen  lds
    s_add_u32 m0, s100, 150528
    s_nop 0
    buffer_load_dwordx4 v37, s[20:23], s40 offen  lds
    s_waitcnt vmcnt(8)
    s_barrier
    s_mov_b32 s40, 0
    s_lshl_b32 s40, s40, 7
    s_add_u32 m0, s101, 0
    s_nop 0
    buffer_load_dwordx4 v20, s[24:27], s40 offen  lds
    s_add_u32 m0, s101, 1024
    s_nop 0
    buffer_load_dwordx4 v21, s[24:27], s40 offen  lds
    s_add_u32 m0, s101, 2048
    s_nop 0
    buffer_load_dwordx4 v22, s[24:27], s40 offen  lds
    s_add_u32 m0, s101, 3072
    s_nop 0
    buffer_load_dwordx4 v23, s[24:27], s40 offen  lds
    s_add_u32 m0, s101, 4096
    s_nop 0
    buffer_load_dwordx4 v20, s[28:31], s40 offen  lds
    s_add_u32 m0, s101, 5120
    s_nop 0
    buffer_load_dwordx4 v21, s[28:31], s40 offen  lds
    s_add_u32 m0, s101, 6144
    s_nop 0
    buffer_load_dwordx4 v22, s[28:31], s40 offen  lds
    s_add_u32 m0, s101, 7168
    s_nop 0
    buffer_load_dwordx4 v23, s[28:31], s40 offen  lds
    s_waitcnt vmcnt(8)
    s_barrier
    s_mov_b32 s40, 1
    s_lshl_b32 s40, s40, 7
    s_add_u32 m0, s101, 32768
    s_nop 0
    buffer_load_dwordx4 v20, s[24:27], s40 offen  lds
    s_add_u32 m0, s101, 33792
    s_nop 0
    buffer_load_dwordx4 v21, s[24:27], s40 offen  lds
    s_add_u32 m0, s101, 34816
    s_nop 0
    buffer_load_dwordx4 v22, s[24:27], s40 offen  lds
    s_add_u32 m0, s101, 35840
    s_nop 0
    buffer_load_dwordx4 v23, s[24:27], s40 offen  lds
    s_add_u32 m0, s101, 36864
    s_nop 0
    buffer_load_dwordx4 v20, s[28:31], s40 offen  lds
    s_add_u32 m0, s101, 37888
    s_nop 0
    buffer_load_dwordx4 v21, s[28:31], s40 offen  lds
    s_add_u32 m0, s101, 38912
    s_nop 0
    buffer_load_dwordx4 v22, s[28:31], s40 offen  lds
    s_add_u32 m0, s101, 39936
    s_nop 0
    buffer_load_dwordx4 v23, s[28:31], s40 offen  lds
    s_barrier
    s_mov_b32 s40, 2
    s_lshl_b32 s40, s40, 7
    s_add_u32 m0, s101, 65536
    s_nop 0
    buffer_load_dwordx4 v20, s[24:27], s40 offen  lds
    s_add_u32 m0, s101, 66560
    s_nop 0
    buffer_load_dwordx4 v21, s[24:27], s40 offen  lds
    s_add_u32 m0, s101, 67584
    s_nop 0
    buffer_load_dwordx4 v22, s[24:27], s40 offen  lds
    s_add_u32 m0, s101, 68608
    s_nop 0
    buffer_load_dwordx4 v23, s[24:27], s40 offen  lds
    s_add_u32 m0, s101, 69632
    s_nop 0
    buffer_load_dwordx4 v20, s[28:31], s40 offen  lds
    s_add_u32 m0, s101, 70656
    s_nop 0
    buffer_load_dwordx4 v21, s[28:31], s40 offen  lds
    s_add_u32 m0, s101, 71680
    s_nop 0
    buffer_load_dwordx4 v22, s[28:31], s40 offen  lds
    s_add_u32 m0, s101, 72704
    s_nop 0
    buffer_load_dwordx4 v23, s[28:31], s40 offen  lds
    s_mov_b32 s40, 3
    s_lshl_b32 s40, s40, 7
    s_add_u32 m0, s101, 98304
    s_nop 0
    buffer_load_dwordx4 v20, s[24:27], s40 offen  lds
    s_add_u32 m0, s101, 99328
    s_nop 0
    buffer_load_dwordx4 v21, s[24:27], s40 offen  lds
    s_add_u32 m0, s101, 100352
    s_nop 0
    buffer_load_dwordx4 v22, s[24:27], s40 offen  lds
    s_add_u32 m0, s101, 101376
    s_nop 0
    buffer_load_dwordx4 v23, s[24:27], s40 offen  lds
    s_add_u32 m0, s101, 102400
    s_nop 0
    buffer_load_dwordx4 v20, s[28:31], s40 offen  lds
    s_add_u32 m0, s101, 103424
    s_nop 0
    buffer_load_dwordx4 v21, s[28:31], s40 offen  lds
    s_add_u32 m0, s101, 104448
    s_nop 0
    buffer_load_dwordx4 v22, s[28:31], s40 offen  lds
    s_add_u32 m0, s101, 105472
    s_nop 0
    buffer_load_dwordx4 v23, s[28:31], s40 offen  lds
    s_mov_b32 s40, 4
    s_lshl_b32 s40, s40, 7
    s_add_u32 m0, s101, 131072
    s_nop 0
    buffer_load_dwordx4 v20, s[24:27], s40 offen  lds
Lhk_g_0:
    s_cbranch_execz Lhk_g_4
    s_add_u32 m0, s101, 132096
    s_nop 0
    buffer_load_dwordx4 v21, s[24:27], s40 offen  lds
    s_add_u32 m0, s101, 133120
    s_nop 0
    buffer_load_dwordx4 v22, s[24:27], s40 offen  lds
    s_add_u32 m0, s101, 134144
    s_nop 0
    buffer_load_dwordx4 v23, s[24:27], s40 offen  lds
    s_add_u32 m0, s101, 135168
    s_nop 0
    buffer_load_dwordx4 v20, s[28:31], s40 offen  lds
    s_add_u32 m0, s101, 136192
    s_nop 0
    buffer_load_dwordx4 v21, s[28:31], s40 offen  lds
    s_add_u32 m0, s101, 137216
    s_nop 0
    buffer_load_dwordx4 v22, s[28:31], s40 offen  lds
    s_add_u32 m0, s101, 138240
    s_nop 0
    buffer_load_dwordx4 v23, s[28:31], s40 offen  lds
    s_mov_b32 s43, 20480
    buffer_load_dwordx2 v[40:41], v26, s[12:15], 0 offen offset:0
    buffer_load_dwordx2 v[42:43], v26, s[12:15], s43 offen offset:0
    buffer_load_dwordx2 v[44:45], v26, s[12:15], 0 offen offset:1280
    buffer_load_dwordx2 v[46:47], v26, s[12:15], s43 offen offset:1280
    buffer_load_dwordx2 v[48:49], v26, s[12:15], 0 offen offset:2560
    buffer_load_dwordx2 v[50:51], v26, s[12:15], s43 offen offset:2560
    buffer_load_dwordx2 v[52:53], v26, s[12:15], 0 offen offset:3840
    buffer_load_dwordx2 v[54:55], v26, s[12:15], s43 offen offset:3840
    global_load_dwordx2 v[30:31], v27, s[76:77]
    s_waitcnt vmcnt(41)
    v_xor_b32 v12, 0, v16
    v_xor_b32 v13, 32, v16
    v_xor_b32 v14, 64, v16
    v_xor_b32 v15, 96, v16
    ds_read_b128 v[96:99], v12 offset:0
    ds_read_b128 v[100:103], v12 offset:2048
    ds_read_b128 v[104:107], v13 offset:0
    ds_read_b128 v[108:111], v13 offset:2048
    ds_read_b128 v[112:115], v14 offset:0
    ds_read_b128 v[116:119], v14 offset:2048
    ds_read_b128 v[120:123], v15 offset:0
    ds_read_b128 v[124:127], v15 offset:2048
    s_waitcnt vmcnt(33)
    v_xor_b32 v12, 0, v16
    v_xor_b32 v13, 32, v16
    v_xor_b32 v14, 64, v16
    v_xor_b32 v15, 96, v16
    ds_read_b128 v[128:131], v12 offset:32768
    ds_read_b128 v[132:135], v12 offset:34816
    ds_read_b128 v[136:139], v13 offset:32768
    ds_read_b128 v[140:143], v13 offset:34816
    ds_read_b128 v[144:147], v14 offset:32768
    ds_read_b128 v[148:151], v14 offset:34816
    ds_read_b128 v[152:155], v15 offset:32768
    ds_read_b128 v[156:159], v15 offset:34816
    s_waitcnt vmcnt(25)
    v_xor_b32 v12, 0, v16
    v_add_u32 v12, 65536, v12
    v_xor_b32 v13, 32, v16
    v_add_u32 v13, 65536, v13
    v_xor_b32 v14, 64, v16
    v_add_u32 v14, 65536, v14
    v_xor_b32 v15, 96, v16
    v_add_u32 v15, 65536, v15
    ds_read_b128 v[160:163], v12 offset:0
    ds_read_b128 v[164:167], v12 offset:2048
    ds_read_b128 v[168:171], v13 offset:0
    ds_read_b128 v[172:175], v13 offset:2048
    ds_read_b128 v[176:179], v14 offset:0
    ds_read_b128 v[180:183], v14 offset:2048
    ds_read_b128 v[184:187], v15 offset:0
    ds_read_b128 v[188:191], v15 offset:2048
    s_waitcnt lgkmcnt(0)
    s_barrier
    s_waitcnt vmcnt(17)
    v_xor_b32 v12, 0, v16
    v_add_u32 v12, 65536, v12
    v_xor_b32 v13, 32, v16
    v_add_u32 v13, 65536, v13
    v_xor_b32 v14, 64, v16
    v_add_u32 v14, 65536, v14
    v_xor_b32 v15, 96, v16
    v_add_u32 v15, 65536, v15
    ds_read_b128 v[192:195], v12 offset:32768
    ds_read_b128 v[196:199], v12 offset:34816
    ds_read_b128 v[200:203], v13 offset:32768
    ds_read_b128 v[204:207], v13 offset:34816
    ds_read_b128 v[208:211], v14 offset:32768
    ds_read_b128 v[212:215], v14 offset:34816
    ds_read_b128 v[216:219], v15 offset:32768
    ds_read_b128 v[220:223], v15 offset:34816
    s_waitcnt vmcnt(9)
    v_xor_b32 v12, 0, v16
    v_add_u32 v12, 131072, v12
    v_xor_b32 v13, 32, v16
    v_add_u32 v13, 131072, v13
    v_xor_b32 v14, 64, v16
    v_add_u32 v14, 131072, v14
    v_xor_b32 v15, 96, v16
    v_add_u32 v15, 131072, v15
    ds_read_b128 v[224:227], v12 offset:0
    ds_read_b128 v[228:231], v12 offset:2048
    ds_read_b128 v[232:235], v13 offset:0
    ds_read_b128 v[236:239], v13 offset:2048
    ds_read_b128 v[240:243], v14 offset:0
    ds_read_b128 v[244:247], v14 offset:2048
    ds_read_b128 v[248:251], v15 offset:0
    ds_read_b128 v[252:255], v15 offset:2048
    s_waitcnt lgkmcnt(0)
    s_barrier
    s_waitcnt vmcnt(0)
    v_lshlrev_b32 v32, 16, v30
    v_and_b32 v33, 0xffff0000, v30
    v_lshlrev_b32 v34, 16, v31
    v_and_b32 v35, 0xffff0000, v31
    v_lshlrev_b32 v4, 16, v40
    v_and_b32 v5, 0xffff0000, v40
    v_lshlrev_b32 v6, 16, v41
    v_and_b32 v7, 0xffff0000, v41
    v_pk_mul_f32 v[4:5], v[4:5], v[32:33]
    v_pk_mul_f32 v[6:7], v[6:7], v[34:35]
    v_lshlrev_b32 v8, 16, v42
    v_and_b32 v9, 0xffff0000, v42
    v_lshlrev_b32 v10, 16, v43
    v_and_b32 v11, 0xffff0000, v43
    v_pk_mul_f32 v[8:9], v[8:9], v[32:33]
    v_pk_mul_f32 v[10:11], v[10:11], v[34:35]
    v_mov_b32_dpp v64, v4 quad_perm:[0,1,2,3] row_mask:0xf bank_mask:0x3
    v_mov_b32_dpp v65, v4 row_ror:8 row_mask:0xf bank_mask:0x3
    v_mov_b32_dpp v68, v5 quad_perm:[0,1,2,3] row_mask:0xf bank_mask:0x3
    v_mov_b32_dpp v69, v5 row_ror:8 row_mask:0xf bank_mask:0x3
    v_mov_b32_dpp v64, v6 row_ror:8 row_mask:0xf bank_mask:0xc
    v_mov_b32_dpp v65, v6 quad_perm:[0,1,2,3] row_mask:0xf bank_mask:0xc
    v_mov_b32_dpp v68, v7 row_ror:8 row_mask:0xf bank_mask:0xc
    v_mov_b32_dpp v69, v7 quad_perm:[0,1,2,3] row_mask:0xf bank_mask:0xc
    v_mov_b32_dpp v66, v8 quad_perm:[0,1,2,3] row_mask:0xf bank_mask:0x3
    v_mov_b32_dpp v67, v8 row_ror:8 row_mask:0xf bank_mask:0x3
    v_mov_b32_dpp v70, v9 quad_perm:[0,1,2,3] row_mask:0xf bank_mask:0x3
    v_mov_b32_dpp v71, v9 row_ror:8 row_mask:0xf bank_mask:0x3
    v_mov_b32_dpp v66, v10 row_ror:8 row_mask:0xf bank_mask:0xc
    v_mov_b32_dpp v67, v10 quad_perm:[0,1,2,3] row_mask:0xf bank_mask:0xc
    v_mov_b32_dpp v70, v11 row_ror:8 row_mask:0xf bank_mask:0xc
    v_mov_b32_dpp v71, v11 quad_perm:[0,1,2,3] row_mask:0xf bank_mask:0xc
    v_lshlrev_b32 v4, 16, v44
    v_and_b32 v5, 0xffff0000, v44
    v_lshlrev_b32 v6, 16, v45
    v_and_b32 v7, 0xffff0000, v45
    v_pk_mul_f32 v[4:5], v[4:5], v[32:33]
    v_pk_mul_f32 v[6:7], v[6:7], v[34:35]
    v_lshlrev_b32 v8, 16, v46
    v_and_b32 v9, 0xffff0000, v46
    v_lshlrev_b32 v10, 16, v47
    v_and_b32 v11, 0xffff0000, v47
    v_pk_mul_f32 v[8:9], v[8:9], v[32:33]
    v_pk_mul_f32 v[10:11], v[10:11], v[34:35]
    v_mov_b32_dpp v72, v4 quad_perm:[0,1,2,3] row_mask:0xf bank_mask:0x3
    v_mov_b32_dpp v73, v4 row_ror:8 row_mask:0xf bank_mask:0x3
    v_mov_b32_dpp v76, v5 quad_perm:[0,1,2,3] row_mask:0xf bank_mask:0x3
    v_mov_b32_dpp v77, v5 row_ror:8 row_mask:0xf bank_mask:0x3
    v_mov_b32_dpp v72, v6 row_ror:8 row_mask:0xf bank_mask:0xc
    v_mov_b32_dpp v73, v6 quad_perm:[0,1,2,3] row_mask:0xf bank_mask:0xc
    v_mov_b32_dpp v76, v7 row_ror:8 row_mask:0xf bank_mask:0xc
    v_mov_b32_dpp v77, v7 quad_perm:[0,1,2,3] row_mask:0xf bank_mask:0xc
    v_mov_b32_dpp v74, v8 quad_perm:[0,1,2,3] row_mask:0xf bank_mask:0x3
    v_mov_b32_dpp v75, v8 row_ror:8 row_mask:0xf bank_mask:0x3
    v_mov_b32_dpp v78, v9 quad_perm:[0,1,2,3] row_mask:0xf bank_mask:0x3
    v_mov_b32_dpp v79, v9 row_ror:8 row_mask:0xf bank_mask:0x3
    v_mov_b32_dpp v74, v10 row_ror:8 row_mask:0xf bank_mask:0xc
    v_mov_b32_dpp v75, v10 quad_perm:[0,1,2,3] row_mask:0xf bank_mask:0xc
    v_mov_b32_dpp v78, v11 row_ror:8 row_mask:0xf bank_mask:0xc
    v_mov_b32_dpp v79, v11 quad_perm:[0,1,2,3] row_mask:0xf bank_mask:0xc
    v_lshlrev_b32 v4, 16, v48
    v_and_b32 v5, 0xffff0000, v48
    v_lshlrev_b32 v6, 16, v49
    v_and_b32 v7, 0xffff0000, v49
    v_pk_mul_f32 v[4:5], v[4:5], v[32:33]
    v_pk_mul_f32 v[6:7], v[6:7], v[34:35]
    v_lshlrev_b32 v8, 16, v50
    v_and_b32 v9, 0xffff0000, v50
    v_lshlrev_b32 v10, 16, v51
    v_and_b32 v11, 0xffff0000, v51
    v_pk_mul_f32 v[8:9], v[8:9], v[32:33]
    v_pk_mul_f32 v[10:11], v[10:11], v[34:35]
    v_mov_b32_dpp v80, v4 quad_perm:[0,1,2,3] row_mask:0xf bank_mask:0x3
    v_mov_b32_dpp v81, v4 row_ror:8 row_mask:0xf bank_mask:0x3
    v_mov_b32_dpp v84, v5 quad_perm:[0,1,2,3] row_mask:0xf bank_mask:0x3
    v_mov_b32_dpp v85, v5 row_ror:8 row_mask:0xf bank_mask:0x3
    v_mov_b32_dpp v80, v6 row_ror:8 row_mask:0xf bank_mask:0xc
    v_mov_b32_dpp v81, v6 quad_perm:[0,1,2,3] row_mask:0xf bank_mask:0xc
    v_mov_b32_dpp v84, v7 row_ror:8 row_mask:0xf bank_mask:0xc
    v_mov_b32_dpp v85, v7 quad_perm:[0,1,2,3] row_mask:0xf bank_mask:0xc
    v_mov_b32_dpp v82, v8 quad_perm:[0,1,2,3] row_mask:0xf bank_mask:0x3
    v_mov_b32_dpp v83, v8 row_ror:8 row_mask:0xf bank_mask:0x3
    v_mov_b32_dpp v86, v9 quad_perm:[0,1,2,3] row_mask:0xf bank_mask:0x3
    v_mov_b32_dpp v87, v9 row_ror:8 row_mask:0xf bank_mask:0x3
    v_mov_b32_dpp v82, v10 row_ror:8 row_mask:0xf bank_mask:0xc
    v_mov_b32_dpp v83, v10 quad_perm:[0,1,2,3] row_mask:0xf bank_mask:0xc
    v_mov_b32_dpp v86, v11 row_ror:8 row_mask:0xf bank_mask:0xc
    v_mov_b32_dpp v87, v11 quad_perm:[0,1,2,3] row_mask:0xf bank_mask:0xc
    v_lshlrev_b32 v4, 16, v52
    v_and_b32 v5, 0xffff0000, v52
    v_lshlrev_b32 v6, 16, v53
    v_and_b32 v7, 0xffff0000, v53
    v_pk_mul_f32 v[4:5], v[4:5], v[32:33]
    v_pk_mul_f32 v[6:7], v[6:7], v[34:35]
    v_lshlrev_b32 v8, 16, v54
    v_and_b32 v9, 0xffff0000, v54
    v_lshlrev_b32 v10, 16, v55
    v_and_b32 v11, 0xffff0000, v55
    v_pk_mul_f32 v[8:9], v[8:9], v[32:33]
    v_pk_mul_f32 v[10:11], v[10:11], v[34:35]
    v_mov_b32_dpp v88, v4 quad_perm:[0,1,2,3] row_mask:0xf bank_mask:0x3
    v_mov_b32_dpp v89, v4 row_ror:8 row_mask:0xf bank_mask:0x3
    v_mov_b32_dpp v92, v5 quad_perm:[0,1,2,3] row_mask:0xf bank_mask:0x3
    v_mov_b32_dpp v93, v5 row_ror:8 row_mask:0xf bank_mask:0x3
    v_mov_b32_dpp v88, v6 row_ror:8 row_mask:0xf bank_mask:0xc
    v_mov_b32_dpp v89, v6 quad_perm:[0,1,2,3] row_mask:0xf bank_mask:0xc
    v_mov_b32_dpp v92, v7 row_ror:8 row_mask:0xf bank_mask:0xc
    v_mov_b32_dpp v93, v7 quad_perm:[0,1,2,3] row_mask:0xf bank_mask:0xc
    v_mov_b32_dpp v90, v8 quad_perm:[0,1,2,3] row_mask:0xf bank_mask:0x3
    v_mov_b32_dpp v91, v8 row_ror:8 row_mask:0xf bank_mask:0x3
    v_mov_b32_dpp v94, v9 quad_perm:[0,1,2,3] row_mask:0xf bank_mask:0x3
    v_mov_b32_dpp v95, v9 row_ror:8 row_mask:0xf bank_mask:0x3
    v_mov_b32_dpp v90, v10 row_ror:8 row_mask:0xf bank_mask:0xc
    v_mov_b32_dpp v91, v10 quad_perm:[0,1,2,3] row_mask:0xf bank_mask:0xc
    v_mov_b32_dpp v94, v11 row_ror:8 row_mask:0xf bank_mask:0xc
    v_mov_b32_dpp v95, v11 quad_perm:[0,1,2,3] row_mask:0xf bank_mask:0xc
    s_mov_b32 s47, 200000
    s_mov_b64 exec, 1023
Lpl_1:
    s_sleep 4
    buffer_load_dword v28, v25, s[4:7], 0 offen sc1
    s_waitcnt vmcnt(0)
    v_cmp_ne_u32 vcc, s42, v28
    s_nop 0
    s_and_b32 exec_lo, vcc_lo, exec_lo
    s_cbranch_scc0 Lpok_2
    s_sub_u32 s47, s47, 1
    s_cbranch_scc0 Lpl_1
Lpok_2:
    s_mov_b64 exec, -1
    s_setprio 3
    s_mov_b32 s40, 0
    s_lshl_b32 s40, s40, 14
    s_add_u32 m0, s101, 98304
    s_nop 0
    buffer_load_dwordx4 v19, s[4:7], s40 offen offset:0 sc1 lds
    buffer_load_dwordx4 v19, s[4:7], s40 offen offset:1024 sc1 lds
    buffer_load_dwordx4 v19, s[4:7], s40 offen offset:2048 sc1 lds
    buffer_load_dwordx4 v19, s[4:7], s40 offen offset:3072 sc1 lds
    s_mov_b32 s40, 1
    s_lshl_b32 s40, s40, 14
    s_add_u32 m0, s101, 102400
    s_nop 0
    buffer_load_dwordx4 v19, s[4:7], s40 offen offset:0 sc1 lds
    buffer_load_dwordx4 v19, s[4:7], s40 offen offset:1024 sc1 lds
    buffer_load_dwordx4 v19, s[4:7], s40 offen offset:2048 sc1 lds
    buffer_load_dwordx4 v19, s[4:7], s40 offen offset:3072 sc1 lds
    s_mov_b32 s40, 2
    s_lshl_b32 s40, s40, 14
    s_add_u32 m0, s101, 131072
    s_nop 0
    buffer_load_dwordx4 v19, s[4:7], s40 offen offset:0 sc1 lds
    buffer_load_dwordx4 v19, s[4:7], s40 offen offset:1024 sc1 lds
    buffer_load_dwordx4 v19, s[4:7], s40 offen offset:2048 sc1 lds
    buffer_load_dwordx4 v19, s[4:7], s40 offen offset:3072 sc1 lds
    s_mov_b32 s40, 3
    s_lshl_b32 s40, s40, 14
    s_add_u32 m0, s101, 135168
    s_nop 0
    buffer_load_dwordx4 v19, s[4:7], s40 offen offset:0 sc1 lds
    buffer_load_dwordx4 v19, s[4:7], s40 offen offset:1024 sc1 lds
    buffer_load_dwordx4 v19, s[4:7], s40 offen offset:2048 sc1 lds
    buffer_load_dwordx4 v19, s[4:7], s40 offen offset:3072 sc1 lds
    s_waitcnt vmcnt(12)
    s_barrier
    ds_read_b128 v[32:35], v17 offset:32768
    ds_read_b128 v[36:39], v17 offset:33792
    ds_read_b128 v[40:43], v17 offset:34816
    ds_read_b128 v[44:47], v17 offset:35840
    s_waitcnt lgkmcnt(0)
    v_mfma_f32_16x16x32_bf16 v[64:67], v[32:35], v[96:99], v[64:67]
    ds_read_b128 v[48:51], v17 offset:40960
    v_mfma_f32_16x16x32_bf16 v[68:71], v[32:35], v[100:103], v[68:71]
    ds_read_b128 v[52:55], v17 offset:41984
    v_mfma_f32_16x16x32_bf16 v[72:75], v[36:39], v[96:99], v[72:75]
    ds_read_b128 v[56:59], v17 offset:43008
    v_mfma_f32_16x16x32_bf16 v[76:79], v[36:39], v[100:103], v[76:79]
    ds_read_b128 v[60:63], v17 offset:44032
    v_mfma_f32_16x16x32_bf16 v[80:83], v[40:43], v[96:99], v[80:83]
    v_mfma_f32_16x16x32_bf16 v[84:87], v[40:43], v[100:103], v[84:87]
    v_mfma_f32_16x16x32_bf16 v[88:91], v[44:47], v[96:99], v[88:91]
    v_mfma_f32_16x16x32_bf16 v[92:95], v[44:47], v[100:103], v[92:95]
    s_waitcnt lgkmcnt(0)
    v_mfma_f32_16x16x32_bf16 v[64:67], v[48:51], v[104:107], v[64:67]
    ds_read_b128 v[32:35], v17 offset:49152
    v_mfma_f32_16x16x32_bf16 v[68:71], v[48:51], v[108:111], v[68:71]
    ds_read_b128 v[36:39], v17 offset:50176
    v_mfma_f32_16x16x32_bf16 v[72:75], v[52:55], v[104:107], v[72:75]
    ds_read_b128 v[40:43], v17 offset:51200
    v_mfma_f32_16x16x32_bf16 v[76:79], v[52:55], v[108:111], v[76:79]
    ds_read_b128 v[44:47], v17 offset:52224
    v_mfma_f32_16x16x32_bf16 v[80:83], v[56:59], v[104:107], v[80:83]
    v_mfma_f32_16x16x32_bf16 v[84:87], v[56:59], v[108:111], v[84:87]
    v_mfma_f32_16x16x32_bf16 v[88:91], v[60:63], v[104:107], v[88:91]
    v_mfma_f32_16x16x32_bf16 v[92:95], v[60:63], v[108:111], v[92:95]
    s_waitcnt lgkmcnt(0)
    v_mfma_f32_16x16x32_bf16 v[64:67], v[32:35], v[112:115], v[64:67]
    ds_read_b128 v[48:51], v17 offset:57344
    v_mfma_f32_16x16x32_bf16 v[68:71], v[32:35], v[116:119], v[68:71]
    ds_read_b128 v[52:55], v17 offset:58368
    v_mfma_f32_16x16x32_bf16 v[72:75], v[36:39], v[112:115], v[72:75]
    ds_read_b128 v[56:59], v17 offset:59392
    v_mfma_f32_16x16x32_bf16 v[76:79], v[36:39], v[116:119], v[76:79]
    ds_read_b128 v[60:63], v17 offset:60416
    v_mfma_f32_16x16x32_bf16 v[80:83], v[40:43], v[112:115], v[80:83]
    v_mfma_f32_16x16x32_bf16 v[84:87], v[40:43], v[116:119], v[84:87]
    v_mfma_f32_16x16x32_bf16 v[88:91], v[44:47], v[112:115], v[88:91]
    v_mfma_f32_16x16x32_bf16 v[92:95], v[44:47], v[116:119], v[92:95]
    s_waitcnt lgkmcnt(0)
    s_waitcnt vmcnt(8)
    s_barrier
    v_mfma_f32_16x16x32_bf16 v[64:67], v[48:51], v[120:123], v[64:67]
    ds_read_b128 v[32:35], v17 offset:36864
    v_mfma_f32_16x16x32_bf16 v[68:71], v[48:51], v[124:127], v[68:71]
    ds_read_b128 v[36:39], v17 offset:37888
    v_mfma_f32_16x16x32_bf16 v[72:75], v[52:55], v[120:123], v[72:75]
    ds_read_b128 v[40:43], v17 offset:38912
    v_mfma_f32_16x16x32_bf16 v[76:79], v[52:55], v[124:127], v[76:79]
    ds_read_b128 v[44:47], v17 offset:39936
    v_mfma_f32_16x16x32_bf16 v[80:83], v[56:59], v[120:123], v[80:83]
    v_mfma_f32_16x16x32_bf16 v[84:87], v[56:59], v[124:127], v[84:87]
    v_mfma_f32_16x16x32_bf16 v[88:91], v[60:63], v[120:123], v[88:91]
    v_mfma_f32_16x16x32_bf16 v[92:95], v[60:63], v[124:127], v[92:95]
    s_waitcnt lgkmcnt(0)
    v_mfma_f32_16x16x32_bf16 v[64:67], v[32:35], v[128:131], v[64:67]
    ds_read_b128 v[48:51], v17 offset:45056
    v_mfma_f32_16x16x32_bf16 v[68:71], v[32:35], v[132:135], v[68:71]
    ds_read_b128 v[52:55], v17 offset:46080
    v_mfma_f32_16x16x32_bf16 v[72:75], v[36:39], v[128:131], v[72:75]
    ds_read_b128 v[56:59], v17 offset:47104
    v_mfma_f32_16x16x32_bf16 v[76:79], v[36:39], v[132:135], v[76:79]
    ds_read_b128 v[60:63], v17 offset:48128
    v_mfma_f32_16x16x32_bf16 v[80:83], v[40:43], v[128:131], v[80:83]
    v_mfma_f32_16x16x32_bf16 v[84:87], v[40:43], v[132:135], v[84:87]
    v_mfma_f32_16x16x32_bf16 v[88:91], v[44:47], v[128:131], v[88:91]
    v_mfma_f32_16x16x32_bf16 v[92:95], v[44:47], v[132:135], v[92:95]
    s_waitcnt lgkmcnt(0)
    v_mfma_f32_16x16x32_bf16 v[64:67], v[48:51], v[136:139], v[64:67]
    ds_read_b128 v[32:35], v17 offset:53248
    v_mfma_f32_16x16x32_bf16 v[68:71], v[48:51], v[140:143], v[68:71]
    ds_read_b128 v[36:39], v17 offset:54272
    v_mfma_f32_16x16x32_bf16 v[72:75], v[52:55], v[136:139], v[72:75]
    ds_read_b128 v[40:43], v17 offset:55296
    v_mfma_f32_16x16x32_bf16 v[76:79], v[52:55], v[140:143], v[76:79]
    ds_read_b128 v[44:47], v17 offset:56320
    v_mfma_f32_16x16x32_bf16 v[80:83], v[56:59], v[136:139], v[80:83]
    v_mfma_f32_16x16x32_bf16 v[84:87], v[56:59], v[140:143], v[84:87]
    v_mfma_f32_16x16x32_bf16 v[88:91], v[60:63], v[136:139], v[88:91]
    v_mfma_f32_16x16x32_bf16 v[92:95], v[60:63], v[140:143], v[92:95]
    s_waitcnt lgkmcnt(0)
    v_mfma_f32_16x16x32_bf16 v[64:67], v[32:35], v[144:147], v[64:67]
    ds_read_b128 v[48:51], v17 offset:61440
    v_mfma_f32_16x16x32_bf16 v[68:71], v[32:35], v[148:151], v[68:71]
    ds_read_b128 v[52:55], v17 offset:62464
    v_mfma_f32_16x16x32_bf16 v[72:75], v[36:39], v[144:147], v[72:75]
    ds_read_b128 v[56:59], v17 offset:63488
    v_mfma_f32_16x16x32_bf16 v[76:79], v[36:39], v[148:151], v[76:79]
    ds_read_b128 v[60:63], v17 offset:64512
    v_mfma_f32_16x16x32_bf16 v[80:83], v[40:43], v[144:147], v[80:83]
    v_mfma_f32_16x16x32_bf16 v[84:87], v[40:43], v[148:151], v[84:87]
    v_mfma_f32_16x16x32_bf16 v[88:91], v[44:47], v[144:147], v[88:91]
    v_mfma_f32_16x16x32_bf16 v[92:95], v[44:47], v[148:151], v[92:95]
    s_waitcnt lgkmcnt(0)
    s_waitcnt vmcnt(4)
    s_barrier
    v_mfma_f32_16x16x32_bf16 v[64:67], v[48:51], v[152:155], v[64:67]
    ds_read_b128 v[32:35], v18 offset:0
    v_mfma_f32_16x16x32_bf16 v[68:71], v[48:51], v[156:159], v[68:71]
    ds_read_b128 v[36:39], v18 offset:1024
    v_mfma_f32_16x16x32_bf16 v[72:75], v[52:55], v[152:155], v[72:75]
    ds_read_b128 v[40:43], v18 offset:2048
    v_mfma_f32_16x16x32_bf16 v[76:79], v[52:55], v[156:159], v[76:79]
    ds_read_b128 v[44:47], v18 offset:3072
    v_mfma_f32_16x16x32_bf16 v[80:83], v[56:59], v[152:155], v[80:83]
    v_mfma_f32_16x16x32_bf16 v[84:87], v[56:59], v[156:159], v[84:87]
    v_mfma_f32_16x16x32_bf16 v[88:91], v[60:63], v[152:155], v[88:91]
    v_mfma_f32_16x16x32_bf16 v[92:95], v[60:63], v[156:159], v[92:95]
    s_waitcnt lgkmcnt(0)
    v_mfma_f32_16x16x32_bf16 v[64:67], v[32:35], v[160:163], v[64:67]
    ds_read_b128 v[48:51], v18 offset:8192
    v_mfma_f32_16x16x32_bf16 v[68:71], v[32:35], v[164:167], v[68:71]
    ds_read_b128 v[52:55], v18 offset:9216
    v_mfma_f32_16x16x32_bf16 v[72:75], v[36:39], v[160:163], v[72:75]
    ds_read_b128 v[56:59], v18 offset:10240
    v_mfma_f32_16x16x32_bf16 v[76:79], v[36:39], v[164:167], v[76:79]
    ds_read_b128 v[60:63], v18 offset:11264
    v_mfma_f32_16x16x32_bf16 v[80:83], v[40:43], v[160:163], v[80:83]
    v_mfma_f32_16x16x32_bf16 v[84:87], v[40:43], v[164:167], v[84:87]
    v_mfma_f32_16x16x32_bf16 v[88:91], v[44:47], v[160:163], v[88:91]
    v_mfma_f32_16x16x32_bf16 v[92:95], v[44:47], v[164:167], v[92:95]
    s_waitcnt lgkmcnt(0)
    v_mfma_f32_16x16x32_bf16 v[64:67], v[48:51], v[168:171], v[64:67]
    ds_read_b128 v[32:35], v18 offset:16384
    v_mfma_f32_16x16x32_bf16 v[68:71], v[48:51], v[172:175], v[68:71]
    ds_read_b128 v[36:39], v18 offset:17408
    v_mfma_f32_16x16x32_bf16 v[72:75], v[52:55], v[168:171], v[72:75]
    ds_read_b128 v[40:43], v18 offset:18432
    v_mfma_f32_16x16x32_bf16 v[76:79], v[52:55], v[172:175], v[76:79]
    ds_read_b128 v[44:47], v18 offset:19456
    v_mfma_f32_16x16x32_bf16 v[80:83], v[56:59], v[168:171], v[80:83]
    v_mfma_f32_16x16x32_bf16 v[84:87], v[56:59], v[172:175], v[84:87]
    v_mfma_f32_16x16x32_bf16 v[88:91], v[60:63], v[168:171], v[88:91]
    v_mfma_f32_16x16x32_bf16 v[92:95], v[60:63], v[172:175], v[92:95]
    s_waitcnt lgkmcnt(0)
    v_mfma_f32_16x16x32_bf16 v[64:67], v[32:35], v[176:179], v[64:67]
    ds_read_b128 v[48:51], v18 offset:24576
    v_mfma_f32_16x16x32_bf16 v[68:71], v[32:35], v[180:183], v[68:71]
    ds_read_b128 v[52:55], v18 offset:25600
    v_mfma_f32_16x16x32_bf16 v[72:75], v[36:39], v[176:179], v[72:75]
    ds_read_b128 v[56:59], v18 offset:26624
    v_mfma_f32_16x16x32_bf16 v[76:79], v[36:39], v[180:183], v[76:79]
    ds_read_b128 v[60:63], v18 offset:27648
    v_mfma_f32_16x16x32_bf16 v[80:83], v[40:43], v[176:179], v[80:83]
    v_mfma_f32_16x16x32_bf16 v[84:87], v[40:43], v[180:183], v[84:87]
    v_mfma_f32_16x16x32_bf16 v[88:91], v[44:47], v[176:179], v[88:91]
    v_mfma_f32_16x16x32_bf16 v[92:95], v[44:47], v[180:183], v[92:95]
    s_waitcnt lgkmcnt(0)
    s_waitcnt vmcnt(0)
    s_barrier
    v_mfma_f32_16x16x32_bf16 v[64:67], v[48:51], v[184:187], v[64:67]
    ds_read_b128 v[32:35], v18 offset:4096
    v_mfma_f32_16x16x32_bf16 v[68:71], v[48:51], v[188:191], v[68:71]
    ds_read_b128 v[36:39], v18 offset:5120
    v_mfma_f32_16x16x32_bf16 v[72:75], v[52:55], v[184:187], v[72:75]
    ds_read_b128 v[40:43], v18 offset:6144
    v_mfma_f32_16x16x32_bf16 v[76:79], v[52:55], v[188:191], v[76:79]
    ds_read_b128 v[44:47], v18 offset:7168
    v_mfma_f32_16x16x32_bf16 v[80:83], v[56:59], v[184:187], v[80:83]
    v_mfma_f32_16x16x32_bf16 v[84:87], v[56:59], v[188:191], v[84:87]
    v_mfma_f32_16x16x32_bf16 v[88:91], v[60:63], v[184:187], v[88:91]
    v_mfma_f32_16x16x32_bf16 v[92:95], v[60:63], v[188:191], v[92:95]
    s_waitcnt lgkmcnt(0)
    v_mfma_f32_16x16x32_bf16 v[64:67], v[32:35], v[192:195], v[64:67]
    ds_read_b128 v[48:51], v18 offset:12288
    v_mfma_f32_16x16x32_bf16 v[68:71], v[32:35], v[196:199], v[68:71]
    ds_read_b128 v[52:55], v18 offset:13312
    v_mfma_f32_16x16x32_bf16 v[72:75], v[36:39], v[192:195], v[72:75]
    ds_read_b128 v[56:59], v18 offset:14336
    v_mfma_f32_16x16x32_bf16 v[76:79], v[36:39], v[196:199], v[76:79]
    ds_read_b128 v[60:63], v18 offset:15360
    v_mfma_f32_16x16x32_bf16 v[80:83], v[40:43], v[192:195], v[80:83]
    v_mfma_f32_16x16x32_bf16 v[84:87], v[40:43], v[196:199], v[84:87]
    v_mfma_f32_16x16x32_bf16 v[88:91], v[44:47], v[192:195], v[88:91]
    v_mfma_f32_16x16x32_bf16 v[92:95], v[44:47], v[196:199], v[92:95]
    s_waitcnt lgkmcnt(0)
    v_mfma_f32_16x16x32_bf16 v[64:67], v[48:51], v[200:203], v[64:67]
    ds_read_b128 v[32:35], v18 offset:20480
    v_mfma_f32_16x16x32_bf16 v[68:71], v[48:51], v[204:207], v[68:71]
    ds_read_b128 v[36:39], v18 offset:21504
    v_mfma_f32_16x16x32_bf16 v[72:75], v[52:55], v[200:203], v[72:75]
    ds_read_b128 v[40:43], v18 offset:22528
    v_mfma_f32_16x16x32_bf16 v[76:79], v[52:55], v[204:207], v[76:79]
    ds_read_b128 v[44:47], v18 offset:23552
    v_mfma_f32_16x16x32_bf16 v[80:83], v[56:59], v[200:203], v[80:83]
    v_mfma_f32_16x16x32_bf16 v[84:87], v[56:59], v[204:207], v[84:87]
    v_mfma_f32_16x16x32_bf16 v[88:91], v[60:63], v[200:203], v[88:91]
    v_mfma_f32_16x16x32_bf16 v[92:95], v[60:63], v[204:207], v[92:95]
    s_waitcnt lgkmcnt(0)
    v_mfma_f32_16x16x32_bf16 v[64:67], v[32:35], v[208:211], v[64:67]
    ds_read_b128 v[48:51], v18 offset:28672
    v_mfma_f32_16x16x32_bf16 v[68:71], v[32:35], v[212:215], v[68:71]
    ds_read_b128 v[52:55], v18 offset:29696
    v_mfma_f32_16x16x32_bf16 v[72:75], v[36:39], v[208:211], v[72:75]
    ds_read_b128 v[56:59], v18 offset:30720
    v_mfma_f32_16x16x32_bf16 v[76:79], v[36:39], v[212:215], v[76:79]
    ds_read_b128 v[60:63], v18 offset:31744
    v_mfma_f32_16x16x32_bf16 v[80:83], v[40:43], v[208:211], v[80:83]
    v_mfma_f32_16x16x32_bf16 v[84:87], v[40:43], v[212:215], v[84:87]
    v_mfma_f32_16x16x32_bf16 v[88:91], v[44:47], v[208:211], v[88:91]
    v_mfma_f32_16x16x32_bf16 v[92:95], v[44:47], v[212:215], v[92:95]
    s_waitcnt lgkmcnt(0)
    s_barrier
    v_mfma_f32_16x16x32_bf16 v[64:67], v[48:51], v[216:219], v[64:67]
    ds_read_b128 v[32:35], v17 offset:0
    v_mfma_f32_16x16x32_bf16 v[68:71], v[48:51], v[220:223], v[68:71]
    ds_read_b128 v[36:39], v17 offset:1024
    v_mfma_f32_16x16x32_bf16 v[72:75], v[52:55], v[216:219], v[72:75]
    ds_read_b128 v[40:43], v17 offset:2048
    v_mfma_f32_16x16x32_bf16 v[76:79], v[52:55], v[220:223], v[76:79]
    ds_read_b128 v[44:47], v17 offset:3072
    v_mfma_f32_16x16x32_bf16 v[80:83], v[56:59], v[216:219], v[80:83]
    v_mfma_f32_16x16x32_bf16 v[84:87], v[56:59], v[220:223], v[84:87]
    v_mfma_f32_16x16x32_bf16 v[88:91], v[60:63], v[216:219], v[88:91]
    v_mfma_f32_16x16x32_bf16 v[92:95], v[60:63], v[220:223], v[92:95]
    s_waitcnt lgkmcnt(0)
    v_mfma_f32_16x16x32_bf16 v[64:67], v[32:35], v[224:227], v[64:67]
    ds_read_b128 v[48:51], v17 offset:8192
    v_mfma_f32_16x16x32_bf16 v[68:71], v[32:35], v[228:231], v[68:71]
    ds_read_b128 v[52:55], v17 offset:9216
    v_mfma_f32_16x16x32_bf16 v[72:75], v[36:39], v[224:227], v[72:75]
    ds_read_b128 v[56:59], v17 offset:10240
    v_mfma_f32_16x16x32_bf16 v[76:79], v[36:39], v[228:231], v[76:79]
    ds_read_b128 v[60:63], v17 offset:11264
    v_mfma_f32_16x16x32_bf16 v[80:83], v[40:43], v[224:227], v[80:83]
    v_mfma_f32_16x16x32_bf16 v[84:87], v[40:43], v[228:231], v[84:87]
    v_mfma_f32_16x16x32_bf16 v[88:91], v[44:47], v[224:227], v[88:91]
    v_mfma_f32_16x16x32_bf16 v[92:95], v[44:47], v[228:231], v[92:95]
    s_waitcnt lgkmcnt(0)
    v_mfma_f32_16x16x32_bf16 v[64:67], v[48:51], v[232:235], v[64:67]
    ds_read_b128 v[32:35], v17 offset:16384
    v_mfma_f32_16x16x32_bf16 v[68:71], v[48:51], v[236:239], v[68:71]
    ds_read_b128 v[36:39], v17 offset:17408
    v_mfma_f32_16x16x32_bf16 v[72:75], v[52:55], v[232:235], v[72:75]
    ds_read_b128 v[40:43], v17 offset:18432
    v_mfma_f32_16x16x32_bf16 v[76:79], v[52:55], v[236:239], v[76:79]
    ds_read_b128 v[44:47], v17 offset:19456
    v_mfma_f32_16x16x32_bf16 v[80:83], v[56:59], v[232:235], v[80:83]
    v_mfma_f32_16x16x32_bf16 v[84:87], v[56:59], v[236:239], v[84:87]
    v_mfma_f32_16x16x32_bf16 v[88:91], v[60:63], v[232:235], v[88:91]
    v_mfma_f32_16x16x32_bf16 v[92:95], v[60:63], v[236:239], v[92:95]
    s_waitcnt lgkmcnt(0)
    v_mfma_f32_16x16x32_bf16 v[64:67], v[32:35], v[240:243], v[64:67]
    ds_read_b128 v[48:51], v17 offset:24576
    v_mfma_f32_16x16x32_bf16 v[68:71], v[32:35], v[244:247], v[68:71]
    ds_read_b128 v[52:55], v17 offset:25600
    v_mfma_f32_16x16x32_bf16 v[72:75], v[36:39], v[240:243], v[72:75]
    ds_read_b128 v[56:59], v17 offset:26624
    v_mfma_f32_16x16x32_bf16 v[76:79], v[36:39], v[244:247], v[76:79]
    ds_read_b128 v[60:63], v17 offset:27648
    v_mfma_f32_16x16x32_bf16 v[80:83], v[40:43], v[240:243], v[80:83]
    v_mfma_f32_16x16x32_bf16 v[84:87], v[40:43], v[244:247], v[84:87]
    v_mfma_f32_16x16x32_bf16 v[88:91], v[44:47], v[240:243], v[88:91]
    v_mfma_f32_16x16x32_bf16 v[92:95], v[44:47], v[244:247], v[92:95]
    s_waitcnt lgkmcnt(0)
    s_barrier
    v_mfma_f32_16x16x32_bf16 v[64:67], v[48:51], v[248:251], v[64:67]
    v_mfma_f32_16x16x32_bf16 v[68:71], v[48:51], v[252:255], v[68:71]
    v_mfma_f32_16x16x32_bf16 v[72:75], v[52:55], v[248:251], v[72:75]
    v_mfma_f32_16x16x32_bf16 v[76:79], v[52:55], v[252:255], v[76:79]
    v_mfma_f32_16x16x32_bf16 v[80:83], v[56:59], v[248:251], v[80:83]
    v_mfma_f32_16x16x32_bf16 v[84:87], v[56:59], v[252:255], v[84:87]
    v_mfma_f32_16x16x32_bf16 v[88:91], v[60:63], v[248:251], v[88:91]
    v_mfma_f32_16x16x32_bf16 v[92:95], v[60:63], v[252:255], v[92:95]
    s_setprio 0
    s_barrier
    v_mov_b32_dpp v96, v64 quad_perm:[0,1,2,3] row_mask:0xf bank_mask:0x3
    v_mov_b32_dpp v98, v64 row_ror:8 row_mask:0xf bank_mask:0x3
    v_mov_b32_dpp v97, v68 quad_perm:[0,1,2,3] row_mask:0xf bank_mask:0x3
    v_mov_b32_dpp v99, v68 row_ror:8 row_mask:0xf bank_mask:0x3
    v_mov_b32_dpp v96, v65 row_ror:8 row_mask:0xf bank_mask:0xc
    v_mov_b32_dpp v98, v65 quad_perm:[0,1,2,3] row_mask:0xf bank_mask:0xc
    v_mov_b32_dpp v97, v69 row_ror:8 row_mask:0xf bank_mask:0xc
    v_mov_b32_dpp v99, v69 quad_perm:[0,1,2,3] row_mask:0xf bank_mask:0xc
    ds_write_b128 v24, v[96:99] offset:32768
    v_mov_b32_dpp v100, v66 quad_perm:[0,1,2,3] row_mask:0xf bank_mask:0x3
    v_mov_b32_dpp v102, v66 row_ror:8 row_mask:0xf bank_mask:0x3
    v_mov_b32_dpp v101, v70 quad_perm:[0,1,2,3] row_mask:0xf bank_mask:0x3
    v_mov_b32_dpp v103, v70 row_ror:8 row_mask:0xf bank_mask:0x3
    v_mov_b32_dpp v100, v67 row_ror:8 row_mask:0xf bank_mask:0xc
    v_mov_b32_dpp v102, v67 quad_perm:[0,1,2,3] row_mask:0xf bank_mask:0xc
    v_mov_b32_dpp v101, v71 row_ror:8 row_mask:0xf bank_mask:0xc
    v_mov_b32_dpp v103, v71 quad_perm:[0,1,2,3] row_mask:0xf bank_mask:0xc
    ds_write_b128 v24, v[100:103] offset:33792
Lhk_g_1:
    s_cbranch_execz Lhr_g
    v_mov_b32_dpp v104, v72 quad_perm:[0,1,2,3] row_mask:0xf bank_mask:0x3
    v_mov_b32_dpp v106, v72 row_ror:8 row_mask:0xf bank_mask:0x3
    v_mov_b32_dpp v105, v76 quad_perm:[0,1,2,3] row_mask:0xf bank_mask:0x3
    v_mov_b32_dpp v107, v76 row_ror:8 row_mask:0xf bank_mask:0x3
    v_mov_b32_dpp v104, v73 row_ror:8 row_mask:0xf bank_mask:0xc
    v_mov_b32_dpp v106, v73 quad_perm:[0,1,2,3] row_mask:0xf bank_mask:0xc
    v_mov_b32_dpp v105, v77 row_ror:8 row_mask:0xf bank_mask:0xc
    v_mov_b32_dpp v107, v77 quad_perm:[0,1,2,3] row_mask:0xf bank_mask:0xc
    ds_write_b128 v24, v[104:107] offset:34816
    v_mov_b32_dpp v108, v74 quad_perm:[0,1,2,3] row_mask:0xf bank_mask:0x3
    v_mov_b32_dpp v110, v74 row_ror:8 row_mask:0xf bank_mask:0x3
    v_mov_b32_dpp v109, v78 quad_perm:[0,1,2,3] row_mask:0xf bank_mask:0x3
    v_mov_b32_dpp v111, v78 row_ror:8 row_mask:0xf bank_mask:0x3
    v_mov_b32_dpp v108, v75 row_ror:8 row_mask:0xf bank_mask:0xc
    v_mov_b32_dpp v110, v75 quad_perm:[0,1,2,3] row_mask:0xf bank_mask:0xc
    v_mov_b32_dpp v109, v79 row_ror:8 row_mask:0xf bank_mask:0xc
    v_mov_b32_dpp v111, v79 quad_perm:[0,1,2,3] row_mask:0xf bank_mask:0xc
    ds_write_b128 v24, v[108:111] offset:35840
    s_barrier
    v_mov_b32_dpp v112, v80 quad_perm:[0,1,2,3] row_mask:0xf bank_mask:0x3
    v_mov_b32_dpp v114, v80 row_ror:8 row_mask:0xf bank_mask:0x3
    v_mov_b32_dpp v113, v84 quad_perm:[0,1,2,3] row_mask:0xf bank_mask:0x3
    v_mov_b32_dpp v115, v84 row_ror:8 row_mask:0xf bank_mask:0x3
    v_mov_b32_dpp v112, v81 row_ror:8 row_mask:0xf bank_mask:0xc
    v_mov_b32_dpp v114, v81 quad_perm:[0,1,2,3] row_mask:0xf bank_mask:0xc
    v_mov_b32_dpp v113, v85 row_ror:8 row_mask:0xf bank_mask:0xc
    v_mov_b32_dpp v115, v85 quad_perm:[0,1,2,3] row_mask:0xf bank_mask:0xc
    ds_write_b128 v24, v[112:115] offset:36864
    v_mov_b32_dpp v116, v82 quad_perm:[0,1,2,3] row_mask:0xf bank_mask:0x3
    v_mov_b32_dpp v118, v82 row_ror:8 row_mask:0xf bank_mask:0x3
    v_mov_b32_dpp v117, v86 quad_perm:[0,1,2,3] row_mask:0xf bank_mask:0x3
    v_mov_b32_dpp v119, v86 row_ror:8 row_mask:0xf bank_mask:0x3
    v_mov_b32_dpp v116, v83 row_ror:8 row_mask:0xf bank_mask:0xc
    v_mov_b32_dpp v118, v83 quad_perm:[0,1,2,3] row_mask:0xf bank_mask:0xc
    v_mov_b32_dpp v117, v87 row_ror:8 row_mask:0xf bank_mask:0xc
    v_mov_b32_dpp v119, v87 quad_perm:[0,1,2,3] row_mask:0xf bank_mask:0xc
    ds_write_b128 v24, v[116:119] offset:37888
    v_mov_b32_dpp v120, v88 quad_perm:[0,1,2,3] row_mask:0xf bank_mask:0x3
    v_mov_b32_dpp v122, v88 row_ror:8 row_mask:0xf bank_mask:0x3
    v_mov_b32_dpp v121, v92 quad_perm:[0,1,2,3] row_mask:0xf bank_mask:0x3
    v_mov_b32_dpp v123, v92 row_ror:8 row_mask:0xf bank_mask:0x3
    v_mov_b32_dpp v120, v89 row_ror:8 row_mask:0xf bank_mask:0xc
    v_mov_b32_dpp v122, v89 quad_perm:[0,1,2,3] row_mask:0xf bank_mask:0xc
    v_mov_b32_dpp v121, v93 row_ror:8 row_mask:0xf bank_mask:0xc
    v_mov_b32_dpp v123, v93 quad_perm:[0,1,2,3] row_mask:0xf bank_mask:0xc
    ds_write_b128 v24, v[120:123] offset:38912
    v_mov_b32_dpp v124, v90 quad_perm:[0,1,2,3] row_mask:0xf bank_mask:0x3
    v_mov_b32_dpp v126, v90 row_ror:8 row_mask:0xf bank_mask:0x3
    v_mov_b32_dpp v125, v94 quad_perm:[0,1,2,3] row_mask:0xf bank_mask:0x3
    v_mov_b32_dpp v127, v94 row_ror:8 row_mask:0xf bank_mask:0x3
    v_mov_b32_dpp v124, v91 row_ror:8 row_mask:0xf bank_mask:0xc
    v_mov_b32_dpp v126, v91 quad_perm:[0,1,2,3] row_mask:0xf bank_mask:0xc
    v_mov_b32_dpp v125, v95 row_ror:8 row_mask:0xf bank_mask:0xc
    v_mov_b32_dpp v127, v95 quad_perm:[0,1,2,3] row_mask:0xf bank_mask:0xc
    ds_write_b128 v24, v[124:127] offset:39936
    s_waitcnt vmcnt(0) lgkmcnt(0)
    s_barrier
    s_endpgm
.p2align 12
L_gc:
    s_lshl_b32 s43, s39, 5
    v_lshl_add_u32 v10, v3, 3, s43
    v_lshl_add_u32 v11, v2, 1, s43
    v_lshrrev_b32 v8, 1, v2
    v_xor_b32 v9, v3, v8
    v_lshlrev_b32 v9, 4, v9
    v_lshl_add_u32 v32, v2, 7, v9
    v_xor_b32 v33, 64, v32
    v_add_u32 v34, 65536, v32
    v_add_u32 v35, 65536, v33
    v_add_u32 v36, 131072, v32
    v_add_u32 v37, 131072, v33
    v_add_u32 v38, s100, v32
    v_add_u32 v39, s100, v33
    v_add_u32 v40, s100, v34
    v_add_u32 v41, s100, v35
    v_add_u32 v42, s100, v36
    v_add_u32 v43, s100, v37
    s_lshl_b32 s43, s39, 12
    s_add_u32 s43, s43, 65536
    v_lshl_add_u32 v45, v1, 4, s43
    v_lshl_add_u32 v9, v3, 6, s43
    v_lshl_add_u32 v9, v2, 4, v9
    s_lshl_b32 s43, s38, 8
    s_sub_u32 s43, s43, 192
    v_add_u32 v44, s43, v9
    s_mul_i32 s43, s38, 80
    s_add_u32 s43, s43, s39
    s_lshl_b32 s43, s43, 12
    s_add_u32 s43, s43, 1048576
    v_lshl_add_u32 v46, v1, 4, s43
    s_mul_i32 s43, s38, 40
    s_add_u32 s43, s43, s39
    s_lshl_b32 s43, s43, 7
    s_add_u32 s43, s43, 262144
    v_lshl_add_u32 v47, v1, 2, s43
    v_mov_b32 v15, 0
    s_waitcnt lgkmcnt(0)
    s_load_dword s42, s[82:83], 2560
    global_load_dwordx2 v[4:5], v10, s[62:63]
    global_load_dwordx2 v[6:7], v10, s[64:65]
    global_load_dwordx2 v[12:13], v10, s[74:75]
    global_load_ushort v28, v11, s[62:63]
    global_load_ushort v29, v11, s[64:65]
    global_load_ushort v30, v11, s[74:75]
    s_mov_b32 s4, s82
    s_and_b32 s5, s83, 0xffff
    s_mov_b32 s6, 268435456
    s_mov_b32 s7, 0x00020000
    s_mov_b32 s32, s78
    s_and_b32 s33, s79, 0xffff
    s_mov_b32 s34, 10485760
    s_mov_b32 s35, 0x00020000
    s_mov_b32 s24, s70
    s_and_b32 s25, s71, 0xffff
    s_mov_b32 s26, 819200
    s_mov_b32 s27, 0x00020000
    s_mov_b32 s28, s72
    s_and_b32 s29, s73, 0xffff
    s_mov_b32 s30, 819200
    s_mov_b32 s31, 0x00020000
    s_lshl_b32 s41, s37, 2
    s_add_u32 s41, s41, s36
    s_and_b32 s43, s44, 1
    s_lshl_b32 s47, s43, 2
    s_add_u32 s36, s36, s47
    s_mul_i32 s43, s43, 3
    s_lshr_b32 s37, s41, 3
    s_add_u32 s37, s37, s43
    s_and_b32 s47, s41, 7
    s_cmp_lt_u32 s41, 16
    s_cselect_b32 s37, s37, 2
    s_cselect_b32 s36, s47, s36
    s_andn2_b32 s41, s44, 1
    s_lshl_b32 s41, s41, 2
    s_add_u32 s41, s41, s36
    s_mov_b32 s73, 0
    s_mov_b64 exec, 0
    s_cmp_eq_u32 s3, 0
    s_cbranch_scc1 Lhk_g_0
    s_cmp_eq_u32 s3, 1
    s_cbranch_scc1 Lhk_g_1
    s_cmp_eq_u32 s3, 2
    s_cbranch_scc1 Lhk_g_2
    s_cmp_eq_u32 s3, 3
    s_cbranch_scc1 Lhk_g_3
Lhr_g:
    s_mov_b64 exec, -1
    s_waitcnt vmcnt(0)
    v_lshlrev_b32 v128, 16, v4
    v_and_b32 v129, 0xffff0000, v4
    v_lshlrev_b32 v132, 16, v6
    v_and_b32 v133, 0xffff0000, v6
    v_lshlrev_b32 v8, 16, v12
    v_and_b32 v9, 0xffff0000, v12
    v_lshlrev_b32 v130, 16, v5
    v_and_b32 v131, 0xffff0000, v5
    v_lshlrev_b32 v134, 16, v7
    v_and_b32 v135, 0xffff0000, v7
    v_lshlrev_b32 v10, 16, v13
    v_and_b32 v11, 0xffff0000, v13
    v_mul_f32 v8, 0x3fb8aa3b, v8
    v_mul_f32 v9, 0x3fb8aa3b, v9
    v_mul_f32 v10, 0x3fb8aa3b, v10
    v_mul_f32 v11, 0x3fb8aa3b, v11
    v_exp_f32 v8, v8
    v_exp_f32 v9, v9
    v_exp_f32 v10, v10
    v_exp_f32 v11, v11
    v_cvt_pk_bf16_f32 v4, v8, v9
    v_cvt_pk_bf16_f32 v5, v10, v11
    v_lshlrev_b32 v8, 16, v4
    v_and_b32 v9, 0xffff0000, v4
    v_lshlrev_b32 v10, 16, v5
    v_and_b32 v11, 0xffff0000, v5
    v_pk_mul_f32 v[16:17], v[8:9], v[128:129]
    v_pk_mul_f32 v[20:21], v[8:9], v[132:133]
    v_pk_mul_f32 v[18:19], v[10:11], v[130:131]
    v_pk_mul_f32 v[22:23], v[10:11], v[134:135]
    v_mul_f32 v16, 0x3fb8aa3b, v16
    v_mul_f32 v20, 0.15915494, v20
    v_mul_f32 v17, 0x3fb8aa3b, v17
    v_mul_f32 v21, 0.15915494, v21
    v_mul_f32 v18, 0x3fb8aa3b, v18
    v_mul_f32 v22, 0.15915494, v22
    v_mul_f32 v19, 0x3fb8aa3b, v19
    v_mul_f32 v23, 0.15915494, v23
    v_exp_f32 v8, v16
    v_exp_f32 v9, v17
    v_exp_f32 v10, v18
    v_exp_f32 v11, v19
    v_fract_f32 v212, v20
    v_fract_f32 v213, v21
    v_fract_f32 v214, v22
    v_fract_f32 v215, v23
    v_cos_f32 v208, v212
    v_cos_f32 v209, v213
    v_cos_f32 v210, v214
    v_cos_f32 v211, v215
    v_sin_f32 v212, v212
    v_sin_f32 v213, v213
    v_sin_f32 v214, v214
    v_sin_f32 v215, v215
    v_mul_f32 v208, v208, v8
    v_mul_f32 v209, v209, v9
    v_mul_f32 v210, v210, v10
    v_mul_f32 v211, v211, v11
    v_mul_f32 v212, v212, v8
    v_mul_f32 v213, v213, v9
    v_mul_f32 v214, v214, v10
    v_mul_f32 v215, v215, v11
    v_pk_mul_f32 v[8:9], v[128:129], v[128:129]
    v_pk_fma_f32 v[8:9], v[132:133], v[132:133], v[8:9]
    v_pk_mul_f32 v[10:11], v[130:131], v[130:131]
    v_pk_fma_f32 v[10:11], v[134:135], v[134:135], v[10:11]
    v_rcp_f32 v8, v8
    v_rcp_f32 v9, v9
    v_rcp_f32 v10, v10
    v_rcp_f32 v11, v11
    v_add_f32 v136, -1.0, v208
    v_add_f32 v137, -1.0, v209
    v_add_f32 v138, -1.0, v210
    v_add_f32 v139, -1.0, v211
    v_pk_add_f32 v[8:9], v[8:9], v[8:9]
    v_pk_add_f32 v[10:11], v[10:11], v[10:11]
    v_pk_mul_f32 v[140:141], v[136:137], v[128:129]
    v_pk_mul_f32 v[144:145], v[212:213], v[128:129]
    v_pk_mul_f32 v[142:143], v[138:139], v[130:131]
    v_pk_mul_f32 v[146:147], v[214:215], v[130:131]
    v_pk_fma_f32 v[140:141], v[212:213], v[132:133], v[140:141]
    v_pk_fma_f32 v[144:145], v[136:137], v[132:133], v[144:145] neg_lo:[1,0,0] neg_hi:[1,0,0]
    v_pk_fma_f32 v[142:143], v[214:215], v[134:135], v[142:143]
    v_pk_fma_f32 v[146:147], v[138:139], v[134:135], v[146:147] neg_lo:[1,0,0] neg_hi:[1,0,0]
    v_pk_mul_f32 v[248:249], v[140:141], v[8:9]
    v_pk_mul_f32 v[252:253], v[144:145], v[8:9]
    v_pk_mul_f32 v[250:251], v[142:143], v[10:11]
    v_pk_mul_f32 v[254:255], v[146:147], v[10:11]
    s_waitcnt lgkmcnt(0)
    s_add_u32 s42, s42, 2654435769
    s_barrier
    ds_read_b128 v[160:163], v38 offset:16384
    ds_read_b128 v[164:167], v38 offset:18432
    ds_read_b128 v[128:131], v32 offset:0
    ds_read_b128 v[132:135], v32 offset:2048
    ds_read_b128 v[136:139], v32 offset:4096
    ds_read_b128 v[140:143], v32 offset:6144
    ds_read_b128 v[144:147], v32 offset:8192
    ds_read_b128 v[148:151], v32 offset:10240
    ds_read_b128 v[152:155], v32 offset:12288
    ds_read_b128 v[156:159], v32 offset:14336
    s_waitcnt lgkmcnt(0)
    v_mfma_f32_16x16x32_bf16 v[64:67], v[160:163], v[128:131], 0
    ds_read_b128 v[200:203], v39 offset:16384
    v_mfma_f32_16x16x32_bf16 v[68:71], v[164:167], v[128:131], 0
    ds_read_b128 v[204:207], v39 offset:18432
    v_mfma_f32_16x16x32_bf16 v[72:75], v[160:163], v[132:135], 0
    ds_read_b128 v[168:171], v33 offset:0
    v_mfma_f32_16x16x32_bf16 v[76:79], v[164:167], v[132:135], 0
    ds_read_b128 v[172:175], v33 offset:2048
    v_mfma_f32_16x16x32_bf16 v[80:83], v[160:163], v[136:139], 0
    ds_read_b128 v[176:179], v33 offset:4096
    v_mfma_f32_16x16x32_bf16 v[84:87], v[164:167], v[136:139], 0
    ds_read_b128 v[180:183], v33 offset:6144
    v_mfma_f32_16x16x32_bf16 v[88:91], v[160:163], v[140:143], 0
    ds_read_b128 v[184:187], v33 offset:8192
    v_mfma_f32_16x16x32_bf16 v[92:95], v[164:167], v[140:143], 0
    ds_read_b128 v[188:191], v33 offset:10240
    v_mfma_f32_16x16x32_bf16 v[96:99], v[160:163], v[144:147], 0
    ds_read_b128 v[192:195], v33 offset:12288
    v_mfma_f32_16x16x32_bf16 v[100:103], v[164:167], v[144:147], 0
    ds_read_b128 v[196:199], v33 offset:14336
    v_mul_f32 v224, v208, v208
    v_mfma_f32_16x16x32_bf16 v[104:107], v[160:163], v[148:151], 0
    v_mul_f32 v228, v208, v212
    v_mul_f32 v225, v209, v209
    v_mfma_f32_16x16x32_bf16 v[108:111], v[164:167], v[148:151], 0
    v_mul_f32 v229, v209, v213
    v_mul_f32 v226, v210, v210
    v_mfma_f32_16x16x32_bf16 v[112:115], v[160:163], v[152:155], 0
    v_mul_f32 v230, v210, v214
    v_mul_f32 v227, v211, v211
    v_mfma_f32_16x16x32_bf16 v[116:119], v[164:167], v[152:155], 0
    v_mul_f32 v231, v211, v215
    v_fma_f32 v224, -v212, v212, v224
    v_mfma_f32_16x16x32_bf16 v[120:123], v[160:163], v[156:159], 0
    v_add_f32 v228, v228, v228
    v_fma_f32 v225, -v213, v213, v225
    v_mfma_f32_16x16x32_bf16 v[124:127], v[164:167], v[156:159], 0
    v_add_f32 v229, v229, v229
    v_fma_f32 v226, -v214, v214, v226
    s_waitcnt lgkmcnt(0)
    s_barrier
    v_mfma_f32_16x16x32_bf16 v[64:67], v[200:203], v[168:171], v[64:67]
    ds_read_b128 v[160:163], v38 offset:49152
    v_mfma_f32_16x16x32_bf16 v[68:71], v[204:207], v[168:171], v[68:71]
    ds_read_b128 v[164:167], v38 offset:51200
    v_mfma_f32_16x16x32_bf16 v[72:75], v[200:203], v[172:175], v[72:75]
    ds_read_b128 v[128:131], v32 offset:32768
    v_mfma_f32_16x16x32_bf16 v[76:79], v[204:207], v[172:175], v[76:79]
    ds_read_b128 v[132:135], v32 offset:34816
    v_mfma_f32_16x16x32_bf16 v[80:83], v[200:203], v[176:179], v[80:83]
    ds_read_b128 v[136:139], v32 offset:36864
    v_mfma_f32_16x16x32_bf16 v[84:87], v[204:207], v[176:179], v[84:87]
    ds_read_b128 v[140:143], v32 offset:38912
    v_mfma_f32_16x16x32_bf16 v[88:91], v[200:203], v[180:183], v[88:91]
    ds_read_b128 v[144:147], v32 offset:40960
    v_mfma_f32_16x16x32_bf16 v[92:95], v[204:207], v[180:183], v[92:95]
    ds_read_b128 v[148:151], v32 offset:43008
    v_mfma_f32_16x16x32_bf16 v[96:99], v[200:203], v[184:187], v[96:99]
    ds_read_b128 v[152:155], v32 offset:45056
    v_mfma_f32_16x16x32_bf16 v[100:103], v[204:207], v[184:187], v[100:103]
    ds_read_b128 v[156:159], v32 offset:47104
    v_add_f32 v230, v230, v230
    v_mfma_f32_16x16x32_bf16 v[104:107], v[200:203], v[188:191], v[104:107]
    v_fma_f32 v227, -v215, v215, v227
    v_add_f32 v231, v231, v231
    v_mfma_f32_16x16x32_bf16 v[108:111], v[204:207], v[188:191], v[108:111]
    v_mul_f32 v232, v224, v224
    v_mul_f32 v236, v224, v228
    v_mfma_f32_16x16x32_bf16 v[112:115], v[200:203], v[192:195], v[112:115]
    v_mul_f32 v233, v225, v225
    v_mul_f32 v237, v225, v229
    v_mfma_f32_16x16x32_bf16 v[116:119], v[204:207], v[192:195], v[116:119]
    v_mul_f32 v234, v226, v226
    v_mul_f32 v238, v226, v230
    v_mfma_f32_16x16x32_bf16 v[120:123], v[200:203], v[196:199], v[120:123]
    v_mul_f32 v235, v227, v227
    v_mul_f32 v239, v227, v231
    v_mfma_f32_16x16x32_bf16 v[124:127], v[204:207], v[196:199], v[124:127]
    v_fma_f32 v232, -v228, v228, v232
    v_add_f32 v236, v236, v236
    s_waitcnt lgkmcnt(0)
    v_mfma_f32_16x16x32_bf16 v[64:67], v[160:163], v[128:131], v[64:67]
    ds_read_b128 v[200:203], v39 offset:49152
    v_mfma_f32_16x16x32_bf16 v[68:71], v[164:167], v[128:131], v[68:71]
    ds_read_b128 v[204:207], v39 offset:51200
    v_mfma_f32_16x16x32_bf16 v[72:75], v[160:163], v[132:135], v[72:75]
    ds_read_b128 v[168:171], v33 offset:32768
    v_mfma_f32_16x16x32_bf16 v[76:79], v[164:167], v[132:135], v[76:79]
    ds_read_b128 v[172:175], v33 offset:34816
    v_mfma_f32_16x16x32_bf16 v[80:83], v[160:163], v[136:139], v[80:83]
    ds_read_b128 v[176:179], v33 offset:36864
    v_mfma_f32_16x16x32_bf16 v[84:87], v[164:167], v[136:139], v[84:87]
    ds_read_b128 v[180:183], v33 offset:38912
    v_mfma_f32_16x16x32_bf16 v[88:91], v[160:163], v[140:143], v[88:91]
    ds_read_b128 v[184:187], v33 offset:40960
    v_mfma_f32_16x16x32_bf16 v[92:95], v[164:167], v[140:143], v[92:95]
    ds_read_b128 v[188:191], v33 offset:43008
    v_mfma_f32_16x16x32_bf16 v[96:99], v[160:163], v[144:147], v[96:99]
    ds_read_b128 v[192:195], v33 offset:45056
    v_mfma_f32_16x16x32_bf16 v[100:103], v[164:167], v[144:147], v[100:103]
    ds_read_b128 v[196:199], v33 offset:47104
    v_fma_f32 v233, -v229, v229, v233
    v_mfma_f32_16x16x32_bf16 v[104:107], v[160:163], v[148:151], v[104:107]
    v_add_f32 v237, v237, v237
    v_fma_f32 v234, -v230, v230, v234
    v_mfma_f32_16x16x32_bf16 v[108:111], v[164:167], v[148:151], v[108:111]
    v_add_f32 v238, v238, v238
    v_fma_f32 v235, -v231, v231, v235
    v_mfma_f32_16x16x32_bf16 v[112:115], v[160:163], v[152:155], v[112:115]
    v_add_f32 v239, v239, v239
    v_mul_f32 v216, v232, v232
    v_mfma_f32_16x16x32_bf16 v[116:119], v[164:167], v[152:155], v[116:119]
    v_mul_f32 v220, v232, v236
    v_mul_f32 v217, v233, v233
    v_mfma_f32_16x16x32_bf16 v[120:123], v[160:163], v[156:159], v[120:123]
    v_mul_f32 v221, v233, v237
    v_mul_f32 v218, v234, v234
    v_mfma_f32_16x16x32_bf16 v[124:127], v[164:167], v[156:159], v[124:127]
    v_mul_f32 v222, v234, v238
    v_mul_f32 v219, v235, v235
    s_waitcnt lgkmcnt(0)
    s_barrier
    v_mfma_f32_16x16x32_bf16 v[64:67], v[200:203], v[168:171], v[64:67]
    ds_read_b128 v[160:163], v40 offset:16384
    v_mfma_f32_16x16x32_bf16 v[68:71], v[204:207], v[168:171], v[68:71]
    ds_read_b128 v[164:167], v40 offset:18432
    v_mfma_f32_16x16x32_bf16 v[72:75], v[200:203], v[172:175], v[72:75]
    ds_read_b128 v[128:131], v34 offset:0
    v_mfma_f32_16x16x32_bf16 v[76:79], v[204:207], v[172:175], v[76:79]
    ds_read_b128 v[132:135], v34 offset:2048
    v_mfma_f32_16x16x32_bf16 v[80:83], v[200:203], v[176:179], v[80:83]
    ds_read_b128 v[136:139], v34 offset:4096
    v_mfma_f32_16x16x32_bf16 v[84:87], v[204:207], v[176:179], v[84:87]
    ds_read_b128 v[140:143], v34 offset:6144
    v_mfma_f32_16x16x32_bf16 v[88:91], v[200:203], v[180:183], v[88:91]
    ds_read_b128 v[144:147], v34 offset:8192
    v_mfma_f32_16x16x32_bf16 v[92:95], v[204:207], v[180:183], v[92:95]
    ds_read_b128 v[148:151], v34 offset:10240
    v_mfma_f32_16x16x32_bf16 v[96:99], v[200:203], v[184:187], v[96:99]
    ds_read_b128 v[152:155], v34 offset:12288
    v_mfma_f32_16x16x32_bf16 v[100:103], v[204:207], v[184:187], v[100:103]
    ds_read_b128 v[156:159], v34 offset:14336
    v_mul_f32 v223, v235, v239
    v_mfma_f32_16x16x32_bf16 v[104:107], v[200:203], v[188:191], v[104:107]
    v_fma_f32 v216, -v236, v236, v216
    v_add_f32 v220, v220, v220
    v_mfma_f32_16x16x32_bf16 v[108:111], v[204:207], v[188:191], v[108:111]
    v_fma_f32 v217, -v237, v237, v217
    v_add_f32 v221, v221, v221
    v_mfma_f32_16x16x32_bf16 v[112:115], v[200:203], v[192:195], v[112:115]
    v_fma_f32 v218, -v238, v238, v218
    v_add_f32 v222, v222, v222
    v_mfma_f32_16x16x32_bf16 v[116:119], v[204:207], v[192:195], v[116:119]
    v_fma_f32 v219, -v239, v239, v219
    v_add_f32 v223, v223, v223
    v_mfma_f32_16x16x32_bf16 v[120:123], v[200:203], v[196:199], v[120:123]
    v_mul_f32 v224, v216, v216
    v_mul_f32 v228, v216, v220
    v_mfma_f32_16x16x32_bf16 v[124:127], v[204:207], v[196:199], v[124:127]
    v_mul_f32 v225, v217, v217
    v_mul_f32 v229, v217, v221
    s_waitcnt lgkmcnt(0)
    v_mfma_f32_16x16x32_bf16 v[64:67], v[160:163], v[128:131], v[64:67]
    ds_read_b128 v[200:203], v41 offset:16384
    v_mfma_f32_16x16x32_bf16 v[68:71], v[164:167], v[128:131], v[68:71]
    ds_read_b128 v[204:207], v41 offset:18432
    v_mfma_f32_16x16x32_bf16 v[72:75], v[160:163], v[132:135], v[72:75]
    ds_read_b128 v[168:171], v35 offset:0
    v_mfma_f32_16x16x32_bf16 v[76:79], v[164:167], v[132:135], v[76:79]
    ds_read_b128 v[172:175], v35 offset:2048
    v_mfma_f32_16x16x32_bf16 v[80:83], v[160:163], v[136:139], v[80:83]
    ds_read_b128 v[176:179], v35 offset:4096
    v_mfma_f32_16x16x32_bf16 v[84:87], v[164:167], v[136:139], v[84:87]
    ds_read_b128 v[180:183], v35 offset:6144
    v_mfma_f32_16x16x32_bf16 v[88:91], v[160:163], v[140:143], v[88:91]
    ds_read_b128 v[184:187], v35 offset:8192
    v_mfma_f32_16x16x32_bf16 v[92:95], v[164:167], v[140:143], v[92:95]
    ds_read_b128 v[188:191], v35 offset:10240
    v_mfma_f32_16x16x32_bf16 v[96:99], v[160:163], v[144:147], v[96:99]
    ds_read_b128 v[192:195], v35 offset:12288
    v_mfma_f32_16x16x32_bf16 v[100:103], v[164:167], v[144:147], v[100:103]
    ds_read_b128 v[196:199], v35 offset:14336
    v_mul_f32 v226, v218, v218
    v_mfma_f32_16x16x32_bf16 v[104:107], v[160:163], v[148:151], v[104:107]
    v_mul_f32 v230, v218, v222
    v_mul_f32 v227, v219, v219
    v_mfma_f32_16x16x32_bf16 v[108:111], v[164:167], v[148:151], v[108:111]
    v_mul_f32 v231, v219, v223
    v_fma_f32 v224, -v220, v220, v224
    v_mfma_f32_16x16x32_bf16 v[112:115], v[160:163], v[152:155], v[112:115]
    v_add_f32 v228, v228, v228
    v_fma_f32 v225, -v221, v221, v225
    v_mfma_f32_16x16x32_bf16 v[116:119], v[164:167], v[152:155], v[116:119]
    v_add_f32 v229, v229, v229
    v_fma_f32 v226, -v222, v222, v226
    v_mfma_f32_16x16x32_bf16 v[120:123], v[160:163], v[156:159], v[120:123]
    v_add_f32 v230, v230, v230
    v_fma_f32 v227, -v223, v223, v227
    v_mfma_f32_16x16x32_bf16 v[124:127], v[164:167], v[156:159], v[124:127]
    v_add_f32 v231, v231, v231
    v_mul_f32 v232, v224, v224
    s_waitcnt lgkmcnt(0)
    s_barrier
    v_mfma_f32_16x16x32_bf16 v[64:67], v[200:203], v[168:171], v[64:67]
    ds_read_b128 v[160:163], v40 offset:49152
    v_mfma_f32_16x16x32_bf16 v[68:71], v[204:207], v[168:171], v[68:71]
    ds_read_b128 v[164:167], v40 offset:51200
    v_mfma_f32_16x16x32_bf16 v[72:75], v[200:203], v[172:175], v[72:75]
    ds_read_b128 v[128:131], v34 offset:32768
    v_mfma_f32_16x16x32_bf16 v[76:79], v[204:207], v[172:175], v[76:79]
    ds_read_b128 v[132:135], v34 offset:34816
    v_mfma_f32_16x16x32_bf16 v[80:83], v[200:203], v[176:179], v[80:83]
    ds_read_b128 v[136:139], v34 offset:36864
    v_mfma_f32_16x16x32_bf16 v[84:87], v[204:207], v[176:179], v[84:87]
    ds_read_b128 v[140:143], v34 offset:38912
    v_mfma_f32_16x16x32_bf16 v[88:91], v[200:203], v[180:183], v[88:91]
    ds_read_b128 v[144:147], v34 offset:40960
    v_mfma_f32_16x16x32_bf16 v[92:95], v[204:207], v[180:183], v[92:95]
    ds_read_b128 v[148:151], v34 offset:43008
    v_mfma_f32_16x16x32_bf16 v[96:99], v[200:203], v[184:187], v[96:99]
    ds_read_b128 v[152:155], v34 offset:45056
    v_mfma_f32_16x16x32_bf16 v[100:103], v[204:207], v[184:187], v[100:103]
    ds_read_b128 v[156:159], v34 offset:47104
    v_mul_f32 v236, v224, v228
    v_mfma_f32_16x16x32_bf16 v[104:107], v[200:203], v[188:191], v[104:107]
    v_mul_f32 v233, v225, v225
    v_mul_f32 v237, v225, v229
    v_mfma_f32_16x16x32_bf16 v[108:111], v[204:207], v[188:191], v[108:111]
    v_mul_f32 v234, v226, v226
    v_mul_f32 v238, v226, v230
    v_mfma_f32_16x16x32_bf16 v[112:115], v[200:203], v[192:195], v[112:115]
    v_mul_f32 v235, v227, v227
    v_mul_f32 v239, v227, v231
    v_mfma_f32_16x16x32_bf16 v[116:119], v[204:207], v[192:195], v[116:119]
    v_fma_f32 v232, -v228, v228, v232
    v_add_f32 v236, v236, v236
    v_mfma_f32_16x16x32_bf16 v[120:123], v[200:203], v[196:199], v[120:123]
    v_fma_f32 v233, -v229, v229, v233
    v_add_f32 v237, v237, v237
    v_mfma_f32_16x16x32_bf16 v[124:127], v[204:207], v[196:199], v[124:127]
    v_fma_f32 v234, -v230, v230, v234
    v_add_f32 v238, v238, v238
    s_waitcnt lgkmcnt(0)
    v_mfma_f32_16x16x32_bf16 v[64:67], v[160:163], v[128:131], v[64:67]
    ds_read_b128 v[200:203], v41 offset:49152
    v_mfma_f32_16x16x32_bf16 v[68:71], v[164:167], v[128:131], v[68:71]
    ds_read_b128 v[204:207], v41 offset:51200
    v_mfma_f32_16x16x32_bf16 v[72:75], v[160:163], v[132:135], v[72:75]
    ds_read_b128 v[168:171], v35 offset:32768
    v_mfma_f32_16x16x32_bf16 v[76:79], v[164:167], v[132:135], v[76:79]
    ds_read_b128 v[172:175], v35 offset:34816
    v_mfma_f32_16x16x32_bf16 v[80:83], v[160:163], v[136:139], v[80:83]
    ds_read_b128 v[176:179], v35 offset:36864
    v_mfma_f32_16x16x32_bf16 v[84:87], v[164:167], v[136:139], v[84:87]
    ds_read_b128 v[180:183], v35 offset:38912
    v_mfma_f32_16x16x32_bf16 v[88:91], v[160:163], v[140:143], v[88:91]
    ds_read_b128 v[184:187], v35 offset:40960
    v_mfma_f32_16x16x32_bf16 v[92:95], v[164:167], v[140:143], v[92:95]
    ds_read_b128 v[188:191], v35 offset:43008
    v_mfma_f32_16x16x32_bf16 v[96:99], v[160:163], v[144:147], v[96:99]
    ds_read_b128 v[192:195], v35 offset:45056
    v_mfma_f32_16x16x32_bf16 v[100:103], v[164:167], v[144:147], v[100:103]
    ds_read_b128 v[196:199], v35 offset:47104
    v_fma_f32 v235, -v231, v231, v235
    v_mfma_f32_16x16x32_bf16 v[104:107], v[160:163], v[148:151], v[104:107]
    v_add_f32 v239, v239, v239
    v_mul_f32 v240, v232, v232
    v_mfma_f32_16x16x32_bf16 v[108:111], v[164:167], v[148:151], v[108:111]
    v_mul_f32 v244, v232, v236
    v_mul_f32 v241, v233, v233
    v_mfma_f32_16x16x32_bf16 v[112:115], v[160:163], v[152:155], v[112:115]
    v_mul_f32 v245, v233, v237
    v_mul_f32 v242, v234, v234
    v_mfma_f32_16x16x32_bf16 v[116:119], v[164:167], v[152:155], v[116:119]
    v_mul_f32 v246, v234, v238
    v_mul_f32 v243, v235, v235
    v_mfma_f32_16x16x32_bf16 v[120:123], v[160:163], v[156:159], v[120:123]
    v_mul_f32 v247, v235, v239
    v_fma_f32 v240, -v236, v236, v240
    v_mfma_f32_16x16x32_bf16 v[124:127], v[164:167], v[156:159], v[124:127]
    v_add_f32 v244, v244, v244
    v_fma_f32 v241, -v237, v237, v241
    s_waitcnt lgkmcnt(0)
    s_barrier
    v_mfma_f32_16x16x32_bf16 v[64:67], v[200:203], v[168:171], v[64:67]
    ds_read_b128 v[160:163], v42 offset:16384
    v_mfma_f32_16x16x32_bf16 v[68:71], v[204:207], v[168:171], v[68:71]
    ds_read_b128 v[164:167], v42 offset:18432
    v_mfma_f32_16x16x32_bf16 v[72:75], v[200:203], v[172:175], v[72:75]
    ds_read_b128 v[128:131], v36 offset:0
    v_mfma_f32_16x16x32_bf16 v[76:79], v[204:207], v[172:175], v[76:79]
    ds_read_b128 v[132:135], v36 offset:2048
    v_mfma_f32_16x16x32_bf16 v[80:83], v[200:203], v[176:179], v[80:83]
    ds_read_b128 v[136:139], v36 offset:4096
    v_mfma_f32_16x16x32_bf16 v[84:87], v[204:207], v[176:179], v[84:87]
    ds_read_b128 v[140:143], v36 offset:6144
    v_mfma_f32_16x16x32_bf16 v[88:91], v[200:203], v[180:183], v[88:91]
    ds_read_b128 v[144:147], v36 offset:8192
    v_mfma_f32_16x16x32_bf16 v[92:95], v[204:207], v[180:183], v[92:95]
    ds_read_b128 v[148:151], v36 offset:10240
    v_mfma_f32_16x16x32_bf16 v[96:99], v[200:203], v[184:187], v[96:99]
    ds_read_b128 v[152:155], v36 offset:12288
    v_mfma_f32_16x16x32_bf16 v[100:103], v[204:207], v[184:187], v[100:103]
    ds_read_b128 v[156:159], v36 offset:14336
    v_add_f32 v245, v245, v245
    v_mfma_f32_16x16x32_bf16 v[104:107], v[200:203], v[188:191], v[104:107]
    v_fma_f32 v242, -v238, v238, v242
    v_add_f32 v246, v246, v246
    v_mfma_f32_16x16x32_bf16 v[108:111], v[204:207], v[188:191], v[108:111]
    v_fma_f32 v243, -v239, v239, v243
    v_add_f32 v247, v247, v247
    v_mfma_f32_16x16x32_bf16 v[112:115], v[200:203], v[192:195], v[112:115]
    v_lshlrev_b32 v12, 3, v2
    v_cvt_f32_u32 v12, v12
    v_mfma_f32_16x16x32_bf16 v[116:119], v[204:207], v[192:195], v[116:119]
    v_mul_f32 v8, v12, v16
    v_mul_f32 v9, v12, v17
    v_mfma_f32_16x16x32_bf16 v[120:123], v[200:203], v[196:199], v[120:123]
    v_mul_f32 v10, v12, v18
    v_mul_f32 v11, v12, v19
    v_mfma_f32_16x16x32_bf16 v[124:127], v[204:207], v[196:199], v[124:127]
    v_mul_f32 v52, v12, v20
    v_mul_f32 v53, v12, v21
    s_waitcnt lgkmcnt(0)
    v_mfma_f32_16x16x32_bf16 v[64:67], v[160:163], v[128:131], v[64:67]
    ds_read_b128 v[200:203], v43 offset:16384
    v_mfma_f32_16x16x32_bf16 v[68:71], v[164:167], v[128:131], v[68:71]
    ds_read_b128 v[204:207], v43 offset:18432
    v_mfma_f32_16x16x32_bf16 v[72:75], v[160:163], v[132:135], v[72:75]
    ds_read_b128 v[168:171], v37 offset:0
    v_mfma_f32_16x16x32_bf16 v[76:79], v[164:167], v[132:135], v[76:79]
    ds_read_b128 v[172:175], v37 offset:2048
    v_mfma_f32_16x16x32_bf16 v[80:83], v[160:163], v[136:139], v[80:83]
    ds_read_b128 v[176:179], v37 offset:4096
    v_mfma_f32_16x16x32_bf16 v[84:87], v[164:167], v[136:139], v[84:87]
    ds_read_b128 v[180:183], v37 offset:6144
    v_mfma_f32_16x16x32_bf16 v[88:91], v[160:163], v[140:143], v[88:91]
    ds_read_b128 v[184:187], v37 offset:8192
    v_mfma_f32_16x16x32_bf16 v[92:95], v[164:167], v[140:143], v[92:95]
    ds_read_b128 v[188:191], v37 offset:10240
    v_mfma_f32_16x16x32_bf16 v[96:99], v[160:163], v[144:147], v[96:99]
    ds_read_b128 v[192:195], v37 offset:12288
    v_mfma_f32_16x16x32_bf16 v[100:103], v[164:167], v[144:147], v[100:103]
    ds_read_b128 v[196:199], v37 offset:14336
    v_mul_f32 v54, v12, v22
    v_mfma_f32_16x16x32_bf16 v[104:107], v[160:163], v[148:151], v[104:107]
    v_mul_f32 v55, v12, v23
    v_exp_f32 v8, v8
    v_mfma_f32_16x16x32_bf16 v[108:111], v[164:167], v[148:151], v[108:111]
    v_exp_f32 v9, v9
    v_exp_f32 v10, v10
    v_mfma_f32_16x16x32_bf16 v[112:115], v[160:163], v[152:155], v[112:115]
    v_exp_f32 v11, v11
    v_fract_f32 v52, v52
    v_mfma_f32_16x16x32_bf16 v[116:119], v[164:167], v[152:155], v[116:119]
    v_fract_f32 v53, v53
    v_fract_f32 v54, v54
    v_mfma_f32_16x16x32_bf16 v[120:123], v[160:163], v[156:159], v[120:123]
    v_fract_f32 v55, v55
    v_cos_f32 v48, v52
    v_mfma_f32_16x16x32_bf16 v[124:127], v[164:167], v[156:159], v[124:127]
    v_cos_f32 v49, v53
    v_cos_f32 v50, v54
    s_waitcnt lgkmcnt(0)
    s_barrier
    v_mfma_f32_16x16x32_bf16 v[64:67], v[200:203], v[168:171], v[64:67]
    ds_read_b128 v[160:163], v38 offset:16384
    v_mfma_f32_16x16x32_bf16 v[68:71], v[204:207], v[168:171], v[68:71]
    ds_read_b128 v[164:167], v38 offset:18432
    v_mfma_f32_16x16x32_bf16 v[72:75], v[200:203], v[172:175], v[72:75]
    ds_read_b128 v[128:131], v32 offset:0
    v_mfma_f32_16x16x32_bf16 v[76:79], v[204:207], v[172:175], v[76:79]
    ds_read_b128 v[132:135], v32 offset:2048
    v_mfma_f32_16x16x32_bf16 v[80:83], v[200:203], v[176:179], v[80:83]
    ds_read_b128 v[136:139], v32 offset:4096
    v_mfma_f32_16x16x32_bf16 v[84:87], v[204:207], v[176:179], v[84:87]
    ds_read_b128 v[140:143], v32 offset:6144
    v_mfma_f32_16x16x32_bf16 v[88:91], v[200:203], v[180:183], v[88:91]
    ds_read_b128 v[144:147], v32 offset:8192
    v_mfma_f32_16x16x32_bf16 v[92:95], v[204:207], v[180:183], v[92:95]
    ds_read_b128 v[148:151], v32 offset:10240
    v_mfma_f32_16x16x32_bf16 v[96:99], v[200:203], v[184:187], v[96:99]
    ds_read_b128 v[152:155], v32 offset:12288
    v_mfma_f32_16x16x32_bf16 v[100:103], v[204:207], v[184:187], v[100:103]
    ds_read_b128 v[156:159], v32 offset:14336
    v_cos_f32 v51, v55
    v_mfma_f32_16x16x32_bf16 v[104:107], v[200:203], v[188:191], v[104:107]
    v_sin_f32 v52, v52
    v_sin_f32 v53, v53
    v_mfma_f32_16x16x32_bf16 v[108:111], v[204:207], v[188:191], v[108:111]
    v_sin_f32 v54, v54
    v_sin_f32 v55, v55
    v_mfma_f32_16x16x32_bf16 v[112:115], v[200:203], v[192:195], v[112:115]
    v_mul_f32 v48, v48, v8
    v_mul_f32 v49, v49, v9
    v_mfma_f32_16x16x32_bf16 v[116:119], v[204:207], v[192:195], v[116:119]
    v_mul_f32 v50, v50, v10
    v_mul_f32 v51, v51, v11
    v_mfma_f32_16x16x32_bf16 v[120:123], v[200:203], v[196:199], v[120:123]
    v_mul_f32 v52, v52, v8
    v_mul_f32 v53, v53, v9
    v_mfma_f32_16x16x32_bf16 v[124:127], v[204:207], v[196:199], v[124:127]
    v_mul_f32 v54, v54, v10
    v_mul_f32 v55, v55, v11
    s_waitcnt lgkmcnt(0)
    v_mfma_f32_16x16x32_bf16 v[64:67], v[160:163], v[128:131], v[64:67]
    ds_read_b128 v[200:203], v39 offset:16384
    v_mfma_f32_16x16x32_bf16 v[68:71], v[164:167], v[128:131], v[68:71]
    ds_read_b128 v[204:207], v39 offset:18432
    v_mfma_f32_16x16x32_bf16 v[72:75], v[160:163], v[132:135], v[72:75]
    ds_read_b128 v[168:171], v33 offset:0
    v_mfma_f32_16x16x32_bf16 v[76:79], v[164:167], v[132:135], v[76:79]
    ds_read_b128 v[172:175], v33 offset:2048
    v_mfma_f32_16x16x32_bf16 v[80:83], v[160:163], v[136:139], v[80:83]
    ds_read_b128 v[176:179], v33 offset:4096
    v_mfma_f32_16x16x32_bf16 v[84:87], v[164:167], v[136:139], v[84:87]
    ds_read_b128 v[180:183], v33 offset:6144
    v_mfma_f32_16x16x32_bf16 v[88:91], v[160:163], v[140:143], v[88:91]
    ds_read_b128 v[184:187], v33 offset:8192
    v_mfma_f32_16x16x32_bf16 v[92:95], v[164:167], v[140:143], v[92:95]
    ds_read_b128 v[188:191], v33 offset:10240
    v_mfma_f32_16x16x32_bf16 v[96:99], v[160:163], v[144:147], v[96:99]
    ds_read_b128 v[192:195], v33 offset:12288
    v_mfma_f32_16x16x32_bf16 v[100:103], v[164:167], v[144:147], v[100:103]
    ds_read_b128 v[196:199], v33 offset:14336
    v_lshlrev_b32 v30, 16, v30
    v_mfma_f32_16x16x32_bf16 v[104:107], v[160:163], v[148:151], v[104:107]
    v_lshlrev_b32 v28, 16, v28
    v_mul_f32 v30, 0x3fb8aa3b, v30
    v_mfma_f32_16x16x32_bf16 v[108:111], v[164:167], v[148:151], v[108:111]
    v_lshlrev_b32 v29, 16, v29
    v_exp_f32 v30, v30
    v_mfma_f32_16x16x32_bf16 v[112:115], v[160:163], v[152:155], v[112:115]
    v_sub_u32 v13, s38, v3
    v_cvt_pk_bf16_f32 v30, v30, v30
    v_mfma_f32_16x16x32_bf16 v[116:119], v[164:167], v[152:155], v[116:119]
    v_lshlrev_b32 v30, 16, v30
Lhk_g_2:
    s_cbranch_execz Lhr_g
    v_mul_f32 v28, v30, v28
    v_mfma_f32_16x16x32_bf16 v[120:123], v[160:163], v[156:159], v[120:123]
    v_mul_f32 v29, v30, v29
    v_mul_f32 v28, 0x4338aa3b, v28
    v_mfma_f32_16x16x32_bf16 v[124:127], v[164:167], v[156:159], v[124:127]
    v_mul_f32 v29, 0x41a2f983, v29
    v_cmp_lt_i32 s[56:57], 0, v13
    s_waitcnt lgkmcnt(0)
    s_barrier
    v_mfma_f32_16x16x32_bf16 v[64:67], v[200:203], v[168:171], v[64:67]
    ds_read_b128 v[160:163], v38 offset:49152
    v_mfma_f32_16x16x32_bf16 v[68:71], v[204:207], v[168:171], v[68:71]
    ds_read_b128 v[164:167], v38 offset:51200
    v_mfma_f32_16x16x32_bf16 v[72:75], v[200:203], v[172:175], v[72:75]
    ds_read_b128 v[128:131], v32 offset:32768
    v_mfma_f32_16x16x32_bf16 v[76:79], v[204:207], v[172:175], v[76:79]
    ds_read_b128 v[132:135], v32 offset:34816
    v_mfma_f32_16x16x32_bf16 v[80:83], v[200:203], v[176:179], v[80:83]
    ds_read_b128 v[136:139], v32 offset:36864
    v_mfma_f32_16x16x32_bf16 v[84:87], v[204:207], v[176:179], v[84:87]
    ds_read_b128 v[140:143], v32 offset:38912
    v_mfma_f32_16x16x32_bf16 v[88:91], v[200:203], v[180:183], v[88:91]
    ds_read_b128 v[144:147], v32 offset:40960
    v_mfma_f32_16x16x32_bf16 v[92:95], v[204:207], v[180:183], v[92:95]
    ds_read_b128 v[148:151], v32 offset:43008
    v_mfma_f32_16x16x32_bf16 v[96:99], v[200:203], v[184:187], v[96:99]
    ds_read_b128 v[152:155], v32 offset:45056
    v_mfma_f32_16x16x32_bf16 v[100:103], v[204:207], v[184:187], v[100:103]
    ds_read_b128 v[156:159], v32 offset:47104
    v_cmp_lt_i32 s[58:59], 4, v13
    v_mfma_f32_16x16x32_bf16 v[104:107], v[200:203], v[188:191], v[104:107]
    v_cmp_lt_i32 s[60:61], 8, v13
    v_cmp_lt_i32 s[62:63], 12, v13
    v_mfma_f32_16x16x32_bf16 v[108:111], v[204:207], v[188:191], v[108:111]
    v_add_u32 v8, -1, v13
    v_add_u32 v9, -5, v13
    v_mfma_f32_16x16x32_bf16 v[112:115], v[200:203], v[192:195], v[112:115]
    v_add_u32 v10, -9, v13
    v_add_u32 v11, -13, v13
    v_mfma_f32_16x16x32_bf16 v[116:119], v[204:207], v[192:195], v[116:119]
    v_max_i32 v8, 0, v8
    v_max_i32 v9, 0, v9
    v_mfma_f32_16x16x32_bf16 v[120:123], v[200:203], v[196:199], v[120:123]
    v_max_i32 v10, 0, v10
    v_max_i32 v11, 0, v11
    v_mfma_f32_16x16x32_bf16 v[124:127], v[204:207], v[196:199], v[124:127]
    v_cvt_f32_u32 v8, v8
    v_cvt_f32_u32 v9, v9
    s_waitcnt lgkmcnt(0)
    v_mfma_f32_16x16x32_bf16 v[64:67], v[160:163], v[128:131], v[64:67]
    ds_read_b128 v[200:203], v39 offset:49152
    v_mfma_f32_16x16x32_bf16 v[68:71], v[164:167], v[128:131], v[68:71]
    ds_read_b128 v[204:207], v39 offset:51200
    v_mfma_f32_16x16x32_bf16 v[72:75], v[160:163], v[132:135], v[72:75]
    ds_read_b128 v[168:171], v33 offset:32768
    v_mfma_f32_16x16x32_bf16 v[76:79], v[164:167], v[132:135], v[76:79]
    ds_read_b128 v[172:175], v33 offset:34816
    v_mfma_f32_16x16x32_bf16 v[80:83], v[160:163], v[136:139], v[80:83]
    ds_read_b128 v[176:179], v33 offset:36864
    v_mfma_f32_16x16x32_bf16 v[84:87], v[164:167], v[136:139], v[84:87]
    ds_read_b128 v[180:183], v33 offset:38912
    v_mfma_f32_16x16x32_bf16 v[88:91], v[160:163], v[140:143], v[88:91]
    ds_read_b128 v[184:187], v33 offset:40960
    v_mfma_f32_16x16x32_bf16 v[92:95], v[164:167], v[140:143], v[92:95]
    ds_read_b128 v[188:191], v33 offset:43008
    v_mfma_f32_16x16x32_bf16 v[96:99], v[160:163], v[144:147], v[96:99]
    ds_read_b128 v[192:195], v33 offset:45056
    v_mfma_f32_16x16x32_bf16 v[100:103], v[164:167], v[144:147], v[100:103]
    ds_read_b128 v[196:199], v33 offset:47104
    v_cvt_f32_u32 v10, v10
    v_mfma_f32_16x16x32_bf16 v[104:107], v[160:163], v[148:151], v[104:107]
    v_cvt_f32_u32 v11, v11
    v_mul_f32 v57, v8, v29
    v_mfma_f32_16x16x32_bf16 v[108:111], v[164:167], v[148:151], v[108:111]
    v_mul_f32 v59, v9, v29
    v_mul_f32 v61, v10, v29
    v_mfma_f32_16x16x32_bf16 v[112:115], v[160:163], v[152:155], v[112:115]
    v_mul_f32 v63, v11, v29
    v_mul_f32 v8, v8, v28
    v_mfma_f32_16x16x32_bf16 v[116:119], v[164:167], v[152:155], v[116:119]
    v_mul_f32 v9, v9, v28
    v_mul_f32 v10, v10, v28
    v_mfma_f32_16x16x32_bf16 v[120:123], v[160:163], v[156:159], v[120:123]
    v_mul_f32 v11, v11, v28
    v_fract_f32 v57, v57
    v_mfma_f32_16x16x32_bf16 v[124:127], v[164:167], v[156:159], v[124:127]
    v_fract_f32 v59, v59
    v_fract_f32 v61, v61
    s_waitcnt lgkmcnt(0)
    s_barrier
    v_mfma_f32_16x16x32_bf16 v[64:67], v[200:203], v[168:171], v[64:67]
    ds_read_b128 v[160:163], v40 offset:16384
    v_mfma_f32_16x16x32_bf16 v[68:71], v[204:207], v[168:171], v[68:71]
    ds_read_b128 v[164:167], v40 offset:18432
    v_mfma_f32_16x16x32_bf16 v[72:75], v[200:203], v[172:175], v[72:75]
    ds_read_b128 v[128:131], v34 offset:0
    v_mfma_f32_16x16x32_bf16 v[76:79], v[204:207], v[172:175], v[76:79]
    ds_read_b128 v[132:135], v34 offset:2048
    v_mfma_f32_16x16x32_bf16 v[80:83], v[200:203], v[176:179], v[80:83]
    ds_read_b128 v[136:139], v34 offset:4096
    v_mfma_f32_16x16x32_bf16 v[84:87], v[204:207], v[176:179], v[84:87]
    ds_read_b128 v[140:143], v34 offset:6144
    v_mfma_f32_16x16x32_bf16 v[88:91], v[200:203], v[180:183], v[88:91]
    ds_read_b128 v[144:147], v34 offset:8192
    v_mfma_f32_16x16x32_bf16 v[92:95], v[204:207], v[180:183], v[92:95]
    ds_read_b128 v[148:151], v34 offset:10240
    v_mfma_f32_16x16x32_bf16 v[96:99], v[200:203], v[184:187], v[96:99]
    ds_read_b128 v[152:155], v34 offset:12288
    v_mfma_f32_16x16x32_bf16 v[100:103], v[204:207], v[184:187], v[100:103]
    ds_read_b128 v[156:159], v34 offset:14336
    v_fract_f32 v63, v63
    v_mfma_f32_16x16x32_bf16 v[104:107], v[200:203], v[188:191], v[104:107]
    v_exp_f32 v8, v8
    v_exp_f32 v9, v9
    v_mfma_f32_16x16x32_bf16 v[108:111], v[204:207], v[188:191], v[108:111]
    v_exp_f32 v10, v10
    v_exp_f32 v11, v11
    v_mfma_f32_16x16x32_bf16 v[112:115], v[200:203], v[192:195], v[112:115]
    v_cos_f32 v56, v57
    v_cos_f32 v58, v59
    v_mfma_f32_16x16x32_bf16 v[116:119], v[204:207], v[192:195], v[116:119]
    v_cos_f32 v60, v61
    v_cos_f32 v62, v63
    v_mfma_f32_16x16x32_bf16 v[120:123], v[200:203], v[196:199], v[120:123]
    v_sin_f32 v57, v57
    v_sin_f32 v59, v59
    v_mfma_f32_16x16x32_bf16 v[124:127], v[204:207], v[196:199], v[124:127]
    v_sin_f32 v61, v61
    v_sin_f32 v63, v63
    s_waitcnt lgkmcnt(0)
    v_mfma_f32_16x16x32_bf16 v[64:67], v[160:163], v[128:131], v[64:67]
    ds_read_b128 v[200:203], v41 offset:16384
    v_mfma_f32_16x16x32_bf16 v[68:71], v[164:167], v[128:131], v[68:71]
    ds_read_b128 v[204:207], v41 offset:18432
    v_mfma_f32_16x16x32_bf16 v[72:75], v[160:163], v[132:135], v[72:75]
    ds_read_b128 v[168:171], v35 offset:0
    v_mfma_f32_16x16x32_bf16 v[76:79], v[164:167], v[132:135], v[76:79]
    ds_read_b128 v[172:175], v35 offset:2048
    v_mfma_f32_16x16x32_bf16 v[80:83], v[160:163], v[136:139], v[80:83]
    ds_read_b128 v[176:179], v35 offset:4096
    v_mfma_f32_16x16x32_bf16 v[84:87], v[164:167], v[136:139], v[84:87]
    ds_read_b128 v[180:183], v35 offset:6144
    v_mfma_f32_16x16x32_bf16 v[88:91], v[160:163], v[140:143], v[88:91]
    ds_read_b128 v[184:187], v35 offset:8192
    v_mfma_f32_16x16x32_bf16 v[92:95], v[164:167], v[140:143], v[92:95]
    ds_read_b128 v[188:191], v35 offset:10240
    v_mfma_f32_16x16x32_bf16 v[96:99], v[160:163], v[144:147], v[96:99]
    ds_read_b128 v[192:195], v35 offset:12288
    v_mfma_f32_16x16x32_bf16 v[100:103], v[164:167], v[144:147], v[100:103]
    ds_read_b128 v[196:199], v35 offset:14336
    v_mul_f32 v56, v56, v8
    v_mfma_f32_16x16x32_bf16 v[104:107], v[160:163], v[148:151], v[104:107]
    v_mul_f32 v58, v58, v9
    v_mul_f32 v60, v60, v10
    v_mfma_f32_16x16x32_bf16 v[108:111], v[164:167], v[148:151], v[108:111]
    v_mul_f32 v62, v62, v11
    v_mul_f32 v57, v57, v8
    v_mfma_f32_16x16x32_bf16 v[112:115], v[160:163], v[152:155], v[112:115]
    v_mul_f32 v59, v59, v9
    v_mul_f32 v61, v61, v10
    v_mfma_f32_16x16x32_bf16 v[116:119], v[164:167], v[152:155], v[116:119]
    v_mul_f32 v63, v63, v11
    v_lshlrev_b32 v28, 4, v3
    v_mfma_f32_16x16x32_bf16 v[120:123], v[160:163], v[156:159], v[120:123]
    v_and_b32 v4, 7, v1
    v_xor_b32 v4, v4, v3
    v_mfma_f32_16x16x32_bf16 v[124:127], v[164:167], v[156:159], v[124:127]
    v_lshlrev_b32 v4, 4, v4
    v_xor_b32 v5, 64, v4
    s_waitcnt lgkmcnt(0)
    s_barrier
    v_mfma_f32_16x16x32_bf16 v[64:67], v[200:203], v[168:171], v[64:67]
    ds_read_b128 v[160:163], v40 offset:49152
    v_mfma_f32_16x16x32_bf16 v[68:71], v[204:207], v[168:171], v[68:71]
    ds_read_b128 v[164:167], v40 offset:51200
    v_mfma_f32_16x16x32_bf16 v[72:75], v[200:203], v[172:175], v[72:75]
    ds_read_b128 v[128:131], v34 offset:32768
    v_mfma_f32_16x16x32_bf16 v[76:79], v[204:207], v[172:175], v[76:79]
    ds_read_b128 v[132:135], v34 offset:34816
    v_mfma_f32_16x16x32_bf16 v[80:83], v[200:203], v[176:179], v[80:83]
    ds_read_b128 v[136:139], v34 offset:36864
    v_mfma_f32_16x16x32_bf16 v[84:87], v[204:207], v[176:179], v[84:87]
    ds_read_b128 v[140:143], v34 offset:38912
    v_mfma_f32_16x16x32_bf16 v[88:91], v[200:203], v[180:183], v[88:91]
    ds_read_b128 v[144:147], v34 offset:40960
    v_mfma_f32_16x16x32_bf16 v[92:95], v[204:207], v[180:183], v[92:95]
    ds_read_b128 v[148:151], v34 offset:43008
    v_mfma_f32_16x16x32_bf16 v[96:99], v[200:203], v[184:187], v[96:99]
    ds_read_b128 v[152:155], v34 offset:45056
    v_mfma_f32_16x16x32_bf16 v[100:103], v[204:207], v[184:187], v[100:103]
    ds_read_b128 v[156:159], v34 offset:47104
    v_lshrrev_b32 v6, 3, v1
    v_mfma_f32_16x16x32_bf16 v[104:107], v[200:203], v[188:191], v[104:107]
    s_lshl_b32 s43, s37, 7
    s_lshr_b32 s47, s100, 7
    v_mfma_f32_16x16x32_bf16 v[108:111], v[204:207], v[188:191], v[108:111]
    s_add_u32 s43, s43, s47
    v_lshl_add_u32 v7, v6, 2, s43
    v_mfma_f32_16x16x32_bf16 v[112:115], v[200:203], v[192:195], v[112:115]
    v_mul_lo_u32 v7, v7, s46
    v_add_u32 v20, 0, v7
    v_mfma_f32_16x16x32_bf16 v[116:119], v[204:207], v[192:195], v[116:119]
    v_add_u32 v20, v20, v4
    v_add_u32 v21, 2560, v7
    v_mfma_f32_16x16x32_bf16 v[120:123], v[200:203], v[196:199], v[120:123]
    v_add_u32 v21, v21, v5
    v_add_u32 v22, 1280, v7
    v_mfma_f32_16x16x32_bf16 v[124:127], v[204:207], v[196:199], v[124:127]
    v_add_u32 v22, v22, v4
    v_add_u32 v23, 3840, v7
    s_waitcnt lgkmcnt(0)
    v_mfma_f32_16x16x32_bf16 v[64:67], v[160:163], v[128:131], v[64:67]
    ds_read_b128 v[200:203], v41 offset:49152
    v_mfma_f32_16x16x32_bf16 v[68:71], v[164:167], v[128:131], v[68:71]
    ds_read_b128 v[204:207], v41 offset:51200
    v_mfma_f32_16x16x32_bf16 v[72:75], v[160:163], v[132:135], v[72:75]
    ds_read_b128 v[168:171], v35 offset:32768
    v_mfma_f32_16x16x32_bf16 v[76:79], v[164:167], v[132:135], v[76:79]
    ds_read_b128 v[172:175], v35 offset:34816
    v_mfma_f32_16x16x32_bf16 v[80:83], v[160:163], v[136:139], v[80:83]
    ds_read_b128 v[176:179], v35 offset:36864
    v_mfma_f32_16x16x32_bf16 v[84:87], v[164:167], v[136:139], v[84:87]
    ds_read_b128 v[180:183], v35 offset:38912
    v_mfma_f32_16x16x32_bf16 v[88:91], v[160:163], v[140:143], v[88:91]
    ds_read_b128 v[184:187], v35 offset:40960
    v_mfma_f32_16x16x32_bf16 v[92:95], v[164:167], v[140:143], v[92:95]
    ds_read_b128 v[188:191], v35 offset:43008
    v_mfma_f32_16x16x32_bf16 v[96:99], v[160:163], v[144:147], v[96:99]
    ds_read_b128 v[192:195], v35 offset:45056
    v_mfma_f32_16x16x32_bf16 v[100:103], v[164:167], v[144:147], v[100:103]
    ds_read_b128 v[196:199], v35 offset:47104
    v_add_u32 v23, v23, v5
    v_mfma_f32_16x16x32_bf16 v[104:107], v[160:163], v[148:151], v[104:107]
    v_lshrrev_b32 v4, 1, v2
    v_lshrrev_b32 v5, 1, v3
    v_mfma_f32_16x16x32_bf16 v[108:111], v[164:167], v[148:151], v[108:111]
    v_xor_b32 v5, v5, v4
    v_lshlrev_b32 v5, 4, v5
    v_mfma_f32_16x16x32_bf16 v[112:115], v[160:163], v[152:155], v[112:115]
    v_lshl_add_u32 v16, v2, 7, v5
    v_and_b32 v5, 1, v3
    v_mfma_f32_16x16x32_bf16 v[116:119], v[164:167], v[152:155], v[116:119]
    v_lshl_add_u32 v16, v5, 12, v16
    v_add_u32 v16, s101, v16
    v_mfma_f32_16x16x32_bf16 v[120:123], v[160:163], v[156:159], v[120:123]
    v_lshlrev_b32 v4, 4, v1
    v_add_u32 v17, 65536, v4
    v_mfma_f32_16x16x32_bf16 v[124:127], v[164:167], v[156:159], v[124:127]
    v_add_u32 v18, 131072, v4
    v_add_u32 v24, s101, v17
    s_waitcnt lgkmcnt(0)
    s_barrier
    v_mfma_f32_16x16x32_bf16 v[64:67], v[200:203], v[168:171], v[64:67]
    ds_read_b128 v[160:163], v42 offset:16384
    v_mfma_f32_16x16x32_bf16 v[68:71], v[204:207], v[168:171], v[68:71]
    ds_read_b128 v[164:167], v42 offset:18432
    v_mfma_f32_16x16x32_bf16 v[72:75], v[200:203], v[172:175], v[72:75]
    ds_read_b128 v[128:131], v36 offset:0
    v_mfma_f32_16x16x32_bf16 v[76:79], v[204:207], v[172:175], v[76:79]
    ds_read_b128 v[132:135], v36 offset:2048
    v_mfma_f32_16x16x32_bf16 v[80:83], v[200:203], v[176:179], v[80:83]
    ds_read_b128 v[136:139], v36 offset:4096
    v_mfma_f32_16x16x32_bf16 v[84:87], v[204:207], v[176:179], v[84:87]
    ds_read_b128 v[140:143], v36 offset:6144
    v_mfma_f32_16x16x32_bf16 v[88:91], v[200:203], v[180:183], v[88:91]
    ds_read_b128 v[144:147], v36 offset:8192
    v_mfma_f32_16x16x32_bf16 v[92:95], v[204:207], v[180:183], v[92:95]
    ds_read_b128 v[148:151], v36 offset:10240
    v_mfma_f32_16x16x32_bf16 v[96:99], v[200:203], v[184:187], v[96:99]
    ds_read_b128 v[152:155], v36 offset:12288
    v_mfma_f32_16x16x32_bf16 v[100:103], v[204:207], v[184:187], v[100:103]
    ds_read_b128 v[156:159], v36 offset:14336
    s_mul_i32 s43, s41, 163840
    v_mfma_f32_16x16x32_bf16 v[104:107], v[200:203], v[188:191], v[104:107]
    s_add_u32 s43, s43, s100
    s_add_u32 s43, s43, 1048576
    v_mfma_f32_16x16x32_bf16 v[108:111], v[204:207], v[188:191], v[108:111]
    v_add_u32 v19, s43, v4
    s_lshl_b32 s43, s37, 7
    v_mfma_f32_16x16x32_bf16 v[112:115], v[200:203], v[192:195], v[112:115]
    s_lshr_b32 s47, s100, 7
    s_add_u32 s43, s43, s47
    v_mfma_f32_16x16x32_bf16 v[116:119], v[204:207], v[192:195], v[116:119]
    v_and_b32 v4, 7, v2
    v_lshl_add_u32 v4, v4, 2, s43
    v_mfma_f32_16x16x32_bf16 v[120:123], v[200:203], v[196:199], v[120:123]
    v_lshrrev_b32 v6, 3, v2
    s_lshr_b32 s43, s41, 1
    v_mfma_f32_16x16x32_bf16 v[124:127], v[204:207], v[196:199], v[124:127]
    s_lshl_b32 s43, s43, 7
    s_and_b32 s47, s41, 1
    s_waitcnt lgkmcnt(0)
    v_mfma_f32_16x16x32_bf16 v[64:67], v[160:163], v[128:131], v[64:67]
    ds_read_b128 v[200:203], v43 offset:16384
    v_mfma_f32_16x16x32_bf16 v[68:71], v[164:167], v[128:131], v[68:71]
    ds_read_b128 v[204:207], v43 offset:18432
    v_mfma_f32_16x16x32_bf16 v[72:75], v[160:163], v[132:135], v[72:75]
    ds_read_b128 v[168:171], v37 offset:0
    v_mfma_f32_16x16x32_bf16 v[76:79], v[164:167], v[132:135], v[76:79]
    ds_read_b128 v[172:175], v37 offset:2048
    v_mfma_f32_16x16x32_bf16 v[80:83], v[160:163], v[136:139], v[80:83]
    ds_read_b128 v[176:179], v37 offset:4096
    v_mfma_f32_16x16x32_bf16 v[84:87], v[164:167], v[136:139], v[84:87]
    ds_read_b128 v[180:183], v37 offset:6144
    v_mfma_f32_16x16x32_bf16 v[88:91], v[160:163], v[140:143], v[88:91]
    ds_read_b128 v[184:187], v37 offset:8192
    v_mfma_f32_16x16x32_bf16 v[92:95], v[164:167], v[140:143], v[92:95]
    ds_read_b128 v[188:191], v37 offset:10240
    v_mfma_f32_16x16x32_bf16 v[96:99], v[160:163], v[144:147], v[96:99]
    ds_read_b128 v[192:195], v37 offset:12288
    v_mfma_f32_16x16x32_bf16 v[100:103], v[164:167], v[144:147], v[100:103]
    ds_read_b128 v[196:199], v37 offset:14336
    v_mfma_f32_16x16x32_bf16 v[104:107], v[160:163], v[148:151], v[104:107]
    s_lshl_b32 s47, s47, 2
    s_add_u32 s43, s43, s47
    v_mfma_f32_16x16x32_bf16 v[108:111], v[164:167], v[148:151], v[108:111]
    v_lshl_add_u32 v5, v3, 5, s43
    v_mul_lo_u32 v5, v5, s46
    v_mfma_f32_16x16x32_bf16 v[112:115], v[160:163], v[152:155], v[112:115]
    v_lshlrev_b32 v25, 2, v5
    v_lshl_add_u32 v25, v4, 2, v25
    v_mfma_f32_16x16x32_bf16 v[116:119], v[164:167], v[152:155], v[116:119]
    v_mul_u32_u24 v6, 40960, v6
    v_add_u32 v25, 2560, v25
    v_mfma_f32_16x16x32_bf16 v[120:123], v[160:163], v[156:159], v[120:123]
    v_add_u32 v25, v25, v6
    v_mfma_f32_16x16x32_bf16 v[124:127], v[164:167], v[156:159], v[124:127]
    v_lshlrev_b32 v26, 4, v1
    s_waitcnt lgkmcnt(0)
    s_barrier
    v_mfma_f32_16x16x32_bf16 v[64:67], v[200:203], v[168:171], v[64:67]
    v_mfma_f32_16x16x32_bf16 v[68:71], v[204:207], v[168:171], v[68:71]
    v_mfma_f32_16x16x32_bf16 v[72:75], v[200:203], v[172:175], v[72:75]
    v_mfma_f32_16x16x32_bf16 v[76:79], v[204:207], v[172:175], v[76:79]
    v_mfma_f32_16x16x32_bf16 v[80:83], v[200:203], v[176:179], v[80:83]
    v_mfma_f32_16x16x32_bf16 v[84:87], v[204:207], v[176:179], v[84:87]
    v_mfma_f32_16x16x32_bf16 v[88:91], v[200:203], v[180:183], v[88:91]
    v_mfma_f32_16x16x32_bf16 v[92:95], v[204:207], v[180:183], v[92:95]
    v_mfma_f32_16x16x32_bf16 v[96:99], v[200:203], v[184:187], v[96:99]
    v_mfma_f32_16x16x32_bf16 v[100:103], v[204:207], v[184:187], v[100:103]
    v_mfma_f32_16x16x32_bf16 v[104:107], v[200:203], v[188:191], v[104:107]
    v_mfma_f32_16x16x32_bf16 v[108:111], v[204:207], v[188:191], v[108:111]
    v_mfma_f32_16x16x32_bf16 v[112:115], v[200:203], v[192:195], v[112:115]
    v_mfma_f32_16x16x32_bf16 v[116:119], v[204:207], v[192:195], v[116:119]
    v_mfma_f32_16x16x32_bf16 v[120:123], v[200:203], v[196:199], v[120:123]
    v_mfma_f32_16x16x32_bf16 v[124:127], v[204:207], v[196:199], v[124:127]
    v_mov_b32 v34, s42
    v_mov_b32 v35, s42
    v_pk_fma_f32 v[72:73], v[208:209], v[64:65], v[72:73]
    v_pk_fma_f32 v[76:77], v[208:209], v[68:69], v[76:77]
    v_pk_fma_f32 v[74:75], v[210:211], v[66:67], v[74:75]
    v_pk_fma_f32 v[78:79], v[210:211], v[70:71], v[78:79]
    v_pk_fma_f32 v[72:73], v[212:213], v[68:69], v[72:73] neg_lo:[1,0,0] neg_hi:[1,0,0]
    v_pk_fma_f32 v[76:77], v[212:213], v[64:65], v[76:77]
    v_pk_fma_f32 v[74:75], v[214:215], v[70:71], v[74:75] neg_lo:[1,0,0] neg_hi:[1,0,0]
    v_pk_fma_f32 v[78:79], v[214:215], v[66:67], v[78:79]
    v_pk_fma_f32 v[80:81], v[208:209], v[72:73], v[80:81]
    v_pk_fma_f32 v[84:85], v[208:209], v[76:77], v[84:85]
    v_pk_fma_f32 v[82:83], v[210:211], v[74:75], v[82:83]
    v_pk_fma_f32 v[86:87], v[210:211], v[78:79], v[86:87]
    v_pk_fma_f32 v[80:81], v[212:213], v[76:77], v[80:81] neg_lo:[1,0,0] neg_hi:[1,0,0]
    v_pk_fma_f32 v[84:85], v[212:213], v[72:73], v[84:85]
    v_pk_fma_f32 v[82:83], v[214:215], v[78:79], v[82:83] neg_lo:[1,0,0] neg_hi:[1,0,0]
    v_pk_fma_f32 v[86:87], v[214:215], v[74:75], v[86:87]
    v_pk_fma_f32 v[88:89], v[208:209], v[80:81], v[88:89]
    v_pk_fma_f32 v[92:93], v[208:209], v[84:85], v[92:93]
    v_pk_fma_f32 v[90:91], v[210:211], v[82:83], v[90:91]
    v_pk_fma_f32 v[94:95], v[210:211], v[86:87], v[94:95]
    v_pk_fma_f32 v[88:89], v[212:213], v[84:85], v[88:89] neg_lo:[1,0,0] neg_hi:[1,0,0]
    v_pk_fma_f32 v[92:93], v[212:213], v[80:81], v[92:93]
    v_pk_fma_f32 v[90:91], v[214:215], v[86:87], v[90:91] neg_lo:[1,0,0] neg_hi:[1,0,0]
    v_pk_fma_f32 v[94:95], v[214:215], v[82:83], v[94:95]
    v_pk_fma_f32 v[96:97], v[208:209], v[88:89], v[96:97]
    v_pk_fma_f32 v[100:101], v[208:209], v[92:93], v[100:101]
    v_pk_fma_f32 v[98:99], v[210:211], v[90:91], v[98:99]
    v_pk_fma_f32 v[102:103], v[210:211], v[94:95], v[102:103]
    v_pk_fma_f32 v[96:97], v[212:213], v[92:93], v[96:97] neg_lo:[1,0,0] neg_hi:[1,0,0]
    v_pk_fma_f32 v[100:101], v[212:213], v[88:89], v[100:101]
    v_pk_fma_f32 v[98:99], v[214:215], v[94:95], v[98:99] neg_lo:[1,0,0] neg_hi:[1,0,0]
    v_pk_fma_f32 v[102:103], v[214:215], v[90:91], v[102:103]
    v_pk_fma_f32 v[104:105], v[208:209], v[96:97], v[104:105]
    v_pk_fma_f32 v[108:109], v[208:209], v[100:101], v[108:109]
    v_pk_fma_f32 v[106:107], v[210:211], v[98:99], v[106:107]
    v_pk_fma_f32 v[110:111], v[210:211], v[102:103], v[110:111]
    v_pk_fma_f32 v[104:105], v[212:213], v[100:101], v[104:105] neg_lo:[1,0,0] neg_hi:[1,0,0]
    v_pk_fma_f32 v[108:109], v[212:213], v[96:97], v[108:109]
    v_pk_fma_f32 v[106:107], v[214:215], v[102:103], v[106:107] neg_lo:[1,0,0] neg_hi:[1,0,0]
    v_pk_fma_f32 v[110:111], v[214:215], v[98:99], v[110:111]
    v_pk_fma_f32 v[112:113], v[208:209], v[104:105], v[112:113]
    v_pk_fma_f32 v[116:117], v[208:209], v[108:109], v[116:117]
    v_pk_fma_f32 v[114:115], v[210:211], v[106:107], v[114:115]
    v_pk_fma_f32 v[118:119], v[210:211], v[110:111], v[118:119]
    v_pk_fma_f32 v[112:113], v[212:213], v[108:109], v[112:113] neg_lo:[1,0,0] neg_hi:[1,0,0]
    v_pk_fma_f32 v[116:117], v[212:213], v[104:105], v[116:117]
    v_pk_fma_f32 v[114:115], v[214:215], v[110:111], v[114:115] neg_lo:[1,0,0] neg_hi:[1,0,0]
    v_pk_fma_f32 v[118:119], v[214:215], v[106:107], v[118:119]
    v_pk_fma_f32 v[120:121], v[208:209], v[112:113], v[120:121]
    v_pk_fma_f32 v[124:125], v[208:209], v[116:117], v[124:125]
    v_pk_fma_f32 v[122:123], v[210:211], v[114:115], v[122:123]
    v_pk_fma_f32 v[126:127], v[210:211], v[118:119], v[126:127]
    v_pk_fma_f32 v[120:121], v[212:213], v[116:117], v[120:121] neg_lo:[1,0,0] neg_hi:[1,0,0]
    v_pk_fma_f32 v[124:125], v[212:213], v[112:113], v[124:125]
    v_pk_fma_f32 v[122:123], v[214:215], v[118:119], v[122:123] neg_lo:[1,0,0] neg_hi:[1,0,0]
    v_pk_fma_f32 v[126:127], v[214:215], v[114:115], v[126:127]
    v_mov_b32_dpp v8, v120 row_shr:1 row_mask:0xf bank_mask:0xf bound_ctrl:0
    v_mov_b32_dpp v9, v121 row_shr:1 row_mask:0xf bank_mask:0xf bound_ctrl:0
    v_mov_b32_dpp v10, v122 row_shr:1 row_mask:0xf bank_mask:0xf bound_ctrl:0
    v_mov_b32_dpp v11, v123 row_shr:1 row_mask:0xf bank_mask:0xf bound_ctrl:0
    v_mov_b32_dpp v12, v124 row_shr:1 row_mask:0xf bank_mask:0xf bound_ctrl:0
    v_mov_b32_dpp v13, v125 row_shr:1 row_mask:0xf bank_mask:0xf bound_ctrl:0
    v_mov_b32_dpp v14, v126 row_shr:1 row_mask:0xf bank_mask:0xf bound_ctrl:0
    v_mov_b32_dpp v15, v127 row_shr:1 row_mask:0xf bank_mask:0xf bound_ctrl:0
    v_pk_fma_f32 v[36:37], v[216:217], v[8:9], v[120:121]
    v_pk_fma_f32 v[40:41], v[216:217], v[12:13], v[124:125]
    v_pk_fma_f32 v[38:39], v[218:219], v[10:11], v[122:123]
    v_pk_fma_f32 v[42:43], v[218:219], v[14:15], v[126:127]
    v_pk_fma_f32 v[38:39], v[222:223], v[14:15], v[38:39] neg_lo:[1,0,0] neg_hi:[1,0,0]
    v_pk_fma_f32 v[42:43], v[222:223], v[10:11], v[42:43]
    v_pk_fma_f32 v[36:37], v[220:221], v[12:13], v[36:37] neg_lo:[1,0,0] neg_hi:[1,0,0]
    v_pk_fma_f32 v[40:41], v[220:221], v[8:9], v[40:41]
    s_nop 0
    v_mov_b32_dpp v8, v36 row_shr:2 row_mask:0xf bank_mask:0xf bound_ctrl:0
    v_mov_b32_dpp v9, v37 row_shr:2 row_mask:0xf bank_mask:0xf bound_ctrl:0
    v_mov_b32_dpp v10, v38 row_shr:2 row_mask:0xf bank_mask:0xf bound_ctrl:0
    v_mov_b32_dpp v11, v39 row_shr:2 row_mask:0xf bank_mask:0xf bound_ctrl:0
    v_mov_b32_dpp v12, v40 row_shr:2 row_mask:0xf bank_mask:0xf bound_ctrl:0
    v_mov_b32_dpp v13, v41 row_shr:2 row_mask:0xf bank_mask:0xf bound_ctrl:0
    v_mov_b32_dpp v14, v42 row_shr:2 row_mask:0xf bank_mask:0xf bound_ctrl:0
    v_mov_b32_dpp v15, v43 row_shr:2 row_mask:0xf bank_mask:0xf bound_ctrl:0
    v_pk_fma_f32 v[36:37], v[224:225], v[8:9], v[36:37]
    v_pk_fma_f32 v[40:41], v[224:225], v[12:13], v[40:41]
    v_pk_fma_f32 v[38:39], v[226:227], v[10:11], v[38:39]
    v_pk_fma_f32 v[42:43], v[226:227], v[14:15], v[42:43]
    v_pk_fma_f32 v[38:39], v[230:231], v[14:15], v[38:39] neg_lo:[1,0,0] neg_hi:[1,0,0]
    v_pk_fma_f32 v[42:43], v[230:231], v[10:11], v[42:43]
    v_pk_fma_f32 v[36:37], v[228:229], v[12:13], v[36:37] neg_lo:[1,0,0] neg_hi:[1,0,0]
    v_pk_fma_f32 v[40:41], v[228:229], v[8:9], v[40:41]
    s_nop 0
    v_mov_b32_dpp v8, v36 row_shr:4 row_mask:0xf bank_mask:0xf bound_ctrl:0
    v_mov_b32_dpp v9, v37 row_shr:4 row_mask:0xf bank_mask:0xf bound_ctrl:0
    v_mov_b32_dpp v10, v38 row_shr:4 row_mask:0xf bank_mask:0xf bound_ctrl:0
    v_mov_b32_dpp v11, v39 row_shr:4 row_mask:0xf bank_mask:0xf bound_ctrl:0
    v_mov_b32_dpp v12, v40 row_shr:4 row_mask:0xf bank_mask:0xf bound_ctrl:0
    v_mov_b32_dpp v13, v41 row_shr:4 row_mask:0xf bank_mask:0xf bound_ctrl:0
    v_mov_b32_dpp v14, v42 row_shr:4 row_mask:0xf bank_mask:0xf bound_ctrl:0
    v_mov_b32_dpp v15, v43 row_shr:4 row_mask:0xf bank_mask:0xf bound_ctrl:0
    v_pk_fma_f32 v[36:37], v[232:233], v[8:9], v[36:37]
    v_pk_fma_f32 v[40:41], v[232:233], v[12:13], v[40:41]
    v_pk_fma_f32 v[38:39], v[234:235], v[10:11], v[38:39]
    v_pk_fma_f32 v[42:43], v[234:235], v[14:15], v[42:43]
    v_pk_fma_f32 v[38:39], v[238:239], v[14:15], v[38:39] neg_lo:[1,0,0] neg_hi:[1,0,0]
    v_pk_fma_f32 v[42:43], v[238:239], v[10:11], v[42:43]
    v_pk_fma_f32 v[36:37], v[236:237], v[12:13], v[36:37] neg_lo:[1,0,0] neg_hi:[1,0,0]
    v_pk_fma_f32 v[40:41], v[236:237], v[8:9], v[40:41]
    s_nop 0
    v_mov_b32_dpp v8, v36 row_shr:8 row_mask:0xf bank_mask:0xf bound_ctrl:0
    v_mov_b32_dpp v9, v37 row_shr:8 row_mask:0xf bank_mask:0xf bound_ctrl:0
    v_mov_b32_dpp v10, v38 row_shr:8 row_mask:0xf bank_mask:0xf bound_ctrl:0
    v_mov_b32_dpp v11, v39 row_shr:8 row_mask:0xf bank_mask:0xf bound_ctrl:0
    v_mov_b32_dpp v12, v40 row_shr:8 row_mask:0xf bank_mask:0xf bound_ctrl:0
    v_mov_b32_dpp v13, v41 row_shr:8 row_mask:0xf bank_mask:0xf bound_ctrl:0
    v_mov_b32_dpp v14, v42 row_shr:8 row_mask:0xf bank_mask:0xf bound_ctrl:0
    v_mov_b32_dpp v15, v43 row_shr:8 row_mask:0xf bank_mask:0xf bound_ctrl:0
    v_pk_fma_f32 v[36:37], v[240:241], v[8:9], v[36:37]
    v_pk_fma_f32 v[40:41], v[240:241], v[12:13], v[40:41]
    v_pk_fma_f32 v[38:39], v[242:243], v[10:11], v[38:39]
    v_pk_fma_f32 v[42:43], v[242:243], v[14:15], v[42:43]
    v_pk_fma_f32 v[38:39], v[246:247], v[14:15], v[38:39] neg_lo:[1,0,0] neg_hi:[1,0,0]
    v_pk_fma_f32 v[42:43], v[246:247], v[10:11], v[42:43]
    v_pk_fma_f32 v[36:37], v[244:245], v[12:13], v[36:37] neg_lo:[1,0,0] neg_hi:[1,0,0]
    v_pk_fma_f32 v[40:41], v[244:245], v[8:9], v[40:41]
    v_mov_b32 v32, v39
    v_mov_b32 v33, v43
    s_nop 0
    v_mov_b32_dpp v32, v38 row_shl:1 row_mask:0xf bank_mask:0xf
    v_mov_b32_dpp v33, v42 row_shl:1 row_mask:0xf bank_mask:0xf
    s_nop 0
    v_mov_b32_dpp v32, v37 row_shl:2 row_mask:0xf bank_mask:0xf
    v_mov_b32_dpp v33, v41 row_shl:2 row_mask:0xf bank_mask:0xf
    s_nop 0
    v_mov_b32_dpp v32, v36 row_shl:3 row_mask:0xf bank_mask:0xf
    v_mov_b32_dpp v33, v40 row_shl:3 row_mask:0xf bank_mask:0xf
    s_mov_b32 exec_lo, 0xf000f000
    s_mov_b32 exec_hi, 0xf000f000
    buffer_store_dwordx4 v[32:35], v44, s[4:7], 0 offen sc1
    s_mov_b64 exec, -1
    v_mov_b64 v[224:225], 0
    v_mov_b32 v226, s42
    v_mov_b64 v[228:229], 0
    v_mov_b32 v230, s42
    v_mov_b64 v[232:233], 0
    v_mov_b32 v234, s42
    v_mov_b64 v[236:237], 0
    v_mov_b32 v238, s42
    v_mov_b32_dpp v216, v36 row_shr:1 row_mask:0xf bank_mask:0xf bound_ctrl:0
    v_mov_b32_dpp v217, v37 row_shr:1 row_mask:0xf bank_mask:0xf bound_ctrl:0
    v_mov_b32_dpp v218, v38 row_shr:1 row_mask:0xf bank_mask:0xf bound_ctrl:0
    v_mov_b32_dpp v219, v39 row_shr:1 row_mask:0xf bank_mask:0xf bound_ctrl:0
    v_mov_b32_dpp v220, v40 row_shr:1 row_mask:0xf bank_mask:0xf bound_ctrl:0
    v_mov_b32_dpp v221, v41 row_shr:1 row_mask:0xf bank_mask:0xf bound_ctrl:0
    v_mov_b32_dpp v222, v42 row_shr:1 row_mask:0xf bank_mask:0xf bound_ctrl:0
    v_mov_b32_dpp v223, v43 row_shr:1 row_mask:0xf bank_mask:0xf bound_ctrl:0
    v_pk_mul_f32 v[128:129], v[248:249], v[208:209]
    v_pk_mul_f32 v[132:133], v[248:249], v[212:213]
    v_pk_mul_f32 v[130:131], v[250:251], v[210:211]
    v_pk_mul_f32 v[134:135], v[250:251], v[214:215]
    v_pk_fma_f32 v[128:129], v[252:253], v[212:213], v[128:129] neg_lo:[1,0,0] neg_hi:[1,0,0]
    v_pk_fma_f32 v[132:133], v[252:253], v[208:209], v[132:133]
    v_pk_fma_f32 v[130:131], v[254:255], v[214:215], v[130:131] neg_lo:[1,0,0] neg_hi:[1,0,0]
    v_pk_fma_f32 v[134:135], v[254:255], v[210:211], v[134:135]
    v_pk_mul_f32 v[240:241], v[248:249], v[64:65]
    v_pk_mul_f32 v[242:243], v[250:251], v[66:67]
    v_pk_fma_f32 v[240:241], v[252:253], v[68:69], v[240:241] neg_lo:[1,0,0] neg_hi:[1,0,0]
    v_pk_fma_f32 v[242:243], v[254:255], v[70:71], v[242:243] neg_lo:[1,0,0] neg_hi:[1,0,0]
    v_pk_mul_f32 v[68:69], v[248:249], v[68:69] neg_lo:[1,0] neg_hi:[1,0]
    v_pk_mul_f32 v[70:71], v[250:251], v[70:71] neg_lo:[1,0] neg_hi:[1,0]
    v_pk_fma_f32 v[68:69], v[252:253], v[64:65], v[68:69] neg_lo:[1,0,0] neg_hi:[1,0,0]
    v_pk_fma_f32 v[70:71], v[254:255], v[66:67], v[70:71] neg_lo:[1,0,0] neg_hi:[1,0,0]
    v_pk_mul_f32 v[136:137], v[128:129], v[208:209]
    v_pk_mul_f32 v[140:141], v[128:129], v[212:213]
    v_pk_mul_f32 v[138:139], v[130:131], v[210:211]
    v_pk_mul_f32 v[142:143], v[130:131], v[214:215]
    v_pk_fma_f32 v[136:137], v[132:133], v[212:213], v[136:137] neg_lo:[1,0,0] neg_hi:[1,0,0]
    v_pk_fma_f32 v[140:141], v[132:133], v[208:209], v[140:141]
    v_pk_fma_f32 v[138:139], v[134:135], v[214:215], v[138:139] neg_lo:[1,0,0] neg_hi:[1,0,0]
    v_pk_fma_f32 v[142:143], v[134:135], v[210:211], v[142:143]
    v_pk_mul_f32 v[64:65], v[248:249], v[72:73]
    v_pk_mul_f32 v[66:67], v[250:251], v[74:75]
    v_pk_fma_f32 v[64:65], v[252:253], v[76:77], v[64:65] neg_lo:[1,0,0] neg_hi:[1,0,0]
    v_pk_fma_f32 v[66:67], v[254:255], v[78:79], v[66:67] neg_lo:[1,0,0] neg_hi:[1,0,0]
    v_pk_mul_f32 v[76:77], v[248:249], v[76:77] neg_lo:[1,0] neg_hi:[1,0]
    v_pk_mul_f32 v[78:79], v[250:251], v[78:79] neg_lo:[1,0] neg_hi:[1,0]
    v_pk_fma_f32 v[76:77], v[252:253], v[72:73], v[76:77] neg_lo:[1,0,0] neg_hi:[1,0,0]
    v_pk_fma_f32 v[78:79], v[254:255], v[74:75], v[78:79] neg_lo:[1,0,0] neg_hi:[1,0,0]
    v_pk_mul_f32 v[144:145], v[136:137], v[208:209]
    v_pk_mul_f32 v[148:149], v[136:137], v[212:213]
    v_pk_mul_f32 v[146:147], v[138:139], v[210:211]
    v_pk_mul_f32 v[150:151], v[138:139], v[214:215]
    v_pk_fma_f32 v[144:145], v[140:141], v[212:213], v[144:145] neg_lo:[1,0,0] neg_hi:[1,0,0]
    v_pk_fma_f32 v[148:149], v[140:141], v[208:209], v[148:149]
    v_pk_fma_f32 v[146:147], v[142:143], v[214:215], v[146:147] neg_lo:[1,0,0] neg_hi:[1,0,0]
    v_pk_fma_f32 v[150:151], v[142:143], v[210:211], v[150:151]
    v_pk_mul_f32 v[72:73], v[248:249], v[80:81]
    v_pk_mul_f32 v[74:75], v[250:251], v[82:83]
    v_pk_fma_f32 v[72:73], v[252:253], v[84:85], v[72:73] neg_lo:[1,0,0] neg_hi:[1,0,0]
    v_pk_fma_f32 v[74:75], v[254:255], v[86:87], v[74:75] neg_lo:[1,0,0] neg_hi:[1,0,0]
    v_pk_mul_f32 v[84:85], v[248:249], v[84:85] neg_lo:[1,0] neg_hi:[1,0]
    v_pk_mul_f32 v[86:87], v[250:251], v[86:87] neg_lo:[1,0] neg_hi:[1,0]
    v_pk_fma_f32 v[84:85], v[252:253], v[80:81], v[84:85] neg_lo:[1,0,0] neg_hi:[1,0,0]
    v_pk_fma_f32 v[86:87], v[254:255], v[82:83], v[86:87] neg_lo:[1,0,0] neg_hi:[1,0,0]
    v_pk_mul_f32 v[152:153], v[144:145], v[208:209]
    v_pk_mul_f32 v[156:157], v[144:145], v[212:213]
    v_pk_mul_f32 v[154:155], v[146:147], v[210:211]
    v_pk_mul_f32 v[158:159], v[146:147], v[214:215]
    v_pk_fma_f32 v[152:153], v[148:149], v[212:213], v[152:153] neg_lo:[1,0,0] neg_hi:[1,0,0]
    v_pk_fma_f32 v[156:157], v[148:149], v[208:209], v[156:157]
    v_pk_fma_f32 v[154:155], v[150:151], v[214:215], v[154:155] neg_lo:[1,0,0] neg_hi:[1,0,0]
    v_pk_fma_f32 v[158:159], v[150:151], v[210:211], v[158:159]
    v_pk_mul_f32 v[80:81], v[248:249], v[88:89]
    v_pk_mul_f32 v[82:83], v[250:251], v[90:91]
    v_pk_fma_f32 v[80:81], v[252:253], v[92:93], v[80:81] neg_lo:[1,0,0] neg_hi:[1,0,0]
    v_pk_fma_f32 v[82:83], v[254:255], v[94:95], v[82:83] neg_lo:[1,0,0] neg_hi:[1,0,0]
    v_pk_mul_f32 v[92:93], v[248:249], v[92:93] neg_lo:[1,0] neg_hi:[1,0]
    v_pk_mul_f32 v[94:95], v[250:251], v[94:95] neg_lo:[1,0] neg_hi:[1,0]
    v_pk_fma_f32 v[92:93], v[252:253], v[88:89], v[92:93] neg_lo:[1,0,0] neg_hi:[1,0,0]
    v_pk_fma_f32 v[94:95], v[254:255], v[90:91], v[94:95] neg_lo:[1,0,0] neg_hi:[1,0,0]
    v_pk_mul_f32 v[160:161], v[152:153], v[208:209]
    v_pk_mul_f32 v[164:165], v[152:153], v[212:213]
    v_pk_mul_f32 v[162:163], v[154:155], v[210:211]
    v_pk_mul_f32 v[166:167], v[154:155], v[214:215]
Lhk_g_3:
    s_cbranch_execz Lhr_g
    v_pk_fma_f32 v[160:161], v[156:157], v[212:213], v[160:161] neg_lo:[1,0,0] neg_hi:[1,0,0]
    v_pk_fma_f32 v[164:165], v[156:157], v[208:209], v[164:165]
    v_pk_fma_f32 v[162:163], v[158:159], v[214:215], v[162:163] neg_lo:[1,0,0] neg_hi:[1,0,0]
    v_pk_fma_f32 v[166:167], v[158:159], v[210:211], v[166:167]
    v_pk_mul_f32 v[88:89], v[248:249], v[96:97]
    v_pk_mul_f32 v[90:91], v[250:251], v[98:99]
    v_pk_fma_f32 v[88:89], v[252:253], v[100:101], v[88:89] neg_lo:[1,0,0] neg_hi:[1,0,0]
    v_pk_fma_f32 v[90:91], v[254:255], v[102:103], v[90:91] neg_lo:[1,0,0] neg_hi:[1,0,0]
    v_pk_mul_f32 v[100:101], v[248:249], v[100:101] neg_lo:[1,0] neg_hi:[1,0]
    v_pk_mul_f32 v[102:103], v[250:251], v[102:103] neg_lo:[1,0] neg_hi:[1,0]
    v_pk_fma_f32 v[100:101], v[252:253], v[96:97], v[100:101] neg_lo:[1,0,0] neg_hi:[1,0,0]
    v_pk_fma_f32 v[102:103], v[254:255], v[98:99], v[102:103] neg_lo:[1,0,0] neg_hi:[1,0,0]
    v_pk_mul_f32 v[168:169], v[160:161], v[208:209]
    v_pk_mul_f32 v[172:173], v[160:161], v[212:213]
    v_pk_mul_f32 v[170:171], v[162:163], v[210:211]
    v_pk_mul_f32 v[174:175], v[162:163], v[214:215]
    v_pk_fma_f32 v[168:169], v[164:165], v[212:213], v[168:169] neg_lo:[1,0,0] neg_hi:[1,0,0]
    v_pk_fma_f32 v[172:173], v[164:165], v[208:209], v[172:173]
    v_pk_fma_f32 v[170:171], v[166:167], v[214:215], v[170:171] neg_lo:[1,0,0] neg_hi:[1,0,0]
    v_pk_fma_f32 v[174:175], v[166:167], v[210:211], v[174:175]
    v_pk_mul_f32 v[96:97], v[248:249], v[104:105]
    v_pk_mul_f32 v[98:99], v[250:251], v[106:107]
    v_pk_fma_f32 v[96:97], v[252:253], v[108:109], v[96:97] neg_lo:[1,0,0] neg_hi:[1,0,0]
    v_pk_fma_f32 v[98:99], v[254:255], v[110:111], v[98:99] neg_lo:[1,0,0] neg_hi:[1,0,0]
    v_pk_mul_f32 v[108:109], v[248:249], v[108:109] neg_lo:[1,0] neg_hi:[1,0]
    v_pk_mul_f32 v[110:111], v[250:251], v[110:111] neg_lo:[1,0] neg_hi:[1,0]
    v_pk_fma_f32 v[108:109], v[252:253], v[104:105], v[108:109] neg_lo:[1,0,0] neg_hi:[1,0,0]
    v_pk_fma_f32 v[110:111], v[254:255], v[106:107], v[110:111] neg_lo:[1,0,0] neg_hi:[1,0,0]
    v_pk_mul_f32 v[176:177], v[168:169], v[208:209]
    v_pk_mul_f32 v[180:181], v[168:169], v[212:213]
    v_pk_mul_f32 v[178:179], v[170:171], v[210:211]
    s_mov_b64 exec, s[56:57]
    buffer_load_dwordx3 v[224:226], v45, s[4:7], 0 offen offset:0 sc1
    s_mov_b64 exec, s[58:59]
    buffer_load_dwordx3 v[228:230], v45, s[4:7], 0 offen offset:1024 sc1
    s_mov_b64 exec, s[60:61]
    buffer_load_dwordx3 v[232:234], v45, s[4:7], 0 offen offset:2048 sc1
    s_mov_b64 exec, s[62:63]
    buffer_load_dwordx3 v[236:238], v45, s[4:7], 0 offen offset:3072 sc1
    s_mov_b64 exec, -1
    v_pk_mul_f32 v[182:183], v[170:171], v[214:215]
    v_pk_fma_f32 v[176:177], v[172:173], v[212:213], v[176:177] neg_lo:[1,0,0] neg_hi:[1,0,0]
    v_pk_fma_f32 v[180:181], v[172:173], v[208:209], v[180:181]
    v_pk_fma_f32 v[178:179], v[174:175], v[214:215], v[178:179] neg_lo:[1,0,0] neg_hi:[1,0,0]
    v_pk_fma_f32 v[182:183], v[174:175], v[210:211], v[182:183]
    v_pk_mul_f32 v[104:105], v[248:249], v[112:113]
    v_pk_mul_f32 v[106:107], v[250:251], v[114:115]
    v_pk_fma_f32 v[104:105], v[252:253], v[116:117], v[104:105] neg_lo:[1,0,0] neg_hi:[1,0,0]
    v_pk_fma_f32 v[106:107], v[254:255], v[118:119], v[106:107] neg_lo:[1,0,0] neg_hi:[1,0,0]
    v_pk_mul_f32 v[116:117], v[248:249], v[116:117] neg_lo:[1,0] neg_hi:[1,0]
    v_pk_mul_f32 v[118:119], v[250:251], v[118:119] neg_lo:[1,0] neg_hi:[1,0]
    v_pk_fma_f32 v[116:117], v[252:253], v[112:113], v[116:117] neg_lo:[1,0,0] neg_hi:[1,0,0]
    v_pk_fma_f32 v[118:119], v[254:255], v[114:115], v[118:119] neg_lo:[1,0,0] neg_hi:[1,0,0]
    v_pk_mul_f32 v[184:185], v[176:177], v[208:209]
    v_pk_mul_f32 v[188:189], v[176:177], v[212:213]
    v_pk_mul_f32 v[186:187], v[178:179], v[210:211]
    v_pk_mul_f32 v[190:191], v[178:179], v[214:215]
    v_pk_fma_f32 v[184:185], v[180:181], v[212:213], v[184:185] neg_lo:[1,0,0] neg_hi:[1,0,0]
    v_pk_fma_f32 v[188:189], v[180:181], v[208:209], v[188:189]
    v_pk_fma_f32 v[186:187], v[182:183], v[214:215], v[186:187] neg_lo:[1,0,0] neg_hi:[1,0,0]
    v_pk_fma_f32 v[190:191], v[182:183], v[210:211], v[190:191]
    v_pk_mul_f32 v[112:113], v[248:249], v[120:121]
    v_pk_mul_f32 v[114:115], v[250:251], v[122:123]
    v_pk_fma_f32 v[112:113], v[252:253], v[124:125], v[112:113] neg_lo:[1,0,0] neg_hi:[1,0,0]
    v_pk_fma_f32 v[114:115], v[254:255], v[126:127], v[114:115] neg_lo:[1,0,0] neg_hi:[1,0,0]
    v_pk_mul_f32 v[124:125], v[248:249], v[124:125] neg_lo:[1,0] neg_hi:[1,0]
    v_pk_mul_f32 v[126:127], v[250:251], v[126:127] neg_lo:[1,0] neg_hi:[1,0]
    v_pk_fma_f32 v[124:125], v[252:253], v[120:121], v[124:125] neg_lo:[1,0,0] neg_hi:[1,0,0]
    v_pk_fma_f32 v[126:127], v[254:255], v[122:123], v[126:127] neg_lo:[1,0,0] neg_hi:[1,0,0]
    s_waitcnt vmcnt(0)
    s_mov_b32 s47, 200000
Lap_3:
    v_xor_b32 v12, s42, v226
    v_xor_b32 v13, s42, v230
    v_xor_b32 v14, s42, v234
    v_xor_b32 v15, s42, v238
    v_or3_b32 v12, v12, v13, v14
    v_or_b32 v12, v12, v15
    v_cmp_ne_u32 vcc, 0, v12
    s_nop 0
    s_cmp_eq_u64 vcc, 0
    s_cbranch_scc1 Laok_4
    s_sleep 1
    s_mov_b64 exec, s[56:57]
    buffer_load_dwordx3 v[224:226], v45, s[4:7], 0 offen offset:0 sc1
    s_mov_b64 exec, s[58:59]
    buffer_load_dwordx3 v[228:230], v45, s[4:7], 0 offen offset:1024 sc1
    s_mov_b64 exec, s[60:61]
    buffer_load_dwordx3 v[232:234], v45, s[4:7], 0 offen offset:2048 sc1
    s_mov_b64 exec, s[62:63]
    buffer_load_dwordx3 v[236:238], v45, s[4:7], 0 offen offset:3072 sc1
    s_mov_b64 exec, -1
    s_waitcnt vmcnt(0)
    s_sub_u32 s47, s47, 1
    s_cbranch_scc0 Lap_3
Laok_4:
    v_pk_mul_f32 v[4:5], v[56:57], v[224:225] op_sel:[0,0] op_sel_hi:[0,1]
    v_pk_mul_f32 v[6:7], v[58:59], v[228:229] op_sel:[0,0] op_sel_hi:[0,1]
    v_pk_fma_f32 v[4:5], v[56:57], v[224:225], v[4:5] op_sel:[1,1,0] op_sel_hi:[1,0,1] neg_lo:[1,0,0]
    v_pk_fma_f32 v[6:7], v[58:59], v[228:229], v[6:7] op_sel:[1,1,0] op_sel_hi:[1,0,1] neg_lo:[1,0,0]
    v_pk_fma_f32 v[4:5], v[60:61], v[232:233], v[4:5] op_sel:[0,0,0] op_sel_hi:[0,1,1]
    v_pk_fma_f32 v[6:7], v[62:63], v[236:237], v[6:7] op_sel:[0,0,0] op_sel_hi:[0,1,1]
    v_pk_fma_f32 v[4:5], v[60:61], v[232:233], v[4:5] op_sel:[1,1,0] op_sel_hi:[1,0,1] neg_lo:[1,0,0]
    v_pk_fma_f32 v[6:7], v[62:63], v[236:237], v[6:7] op_sel:[1,1,0] op_sel_hi:[1,0,1] neg_lo:[1,0,0]
    s_nop 0
    v_pk_add_f32 v[4:5], v[4:5], v[6:7]
    v_mov_b64 v[6:7], v[4:5]
    s_nop 1
    v_permlane32_swap_b32 v4, v6
    v_permlane32_swap_b32 v5, v7
    v_pk_add_f32 v[4:5], v[4:5], v[6:7]
    v_mov_b64 v[6:7], v[4:5]
    s_nop 1
    v_permlane16_swap_b32 v4, v6
    v_permlane16_swap_b32 v5, v7
    v_pk_add_f32 v[4:5], v[4:5], v[6:7]
    ds_bpermute_b32 v8, v28, v4 offset:0
    ds_bpermute_b32 v9, v28, v4 offset:4
    ds_bpermute_b32 v10, v28, v4 offset:8
    ds_bpermute_b32 v11, v28, v4 offset:12
    ds_bpermute_b32 v12, v28, v5 offset:0
    ds_bpermute_b32 v13, v28, v5 offset:4
    ds_bpermute_b32 v14, v28, v5 offset:8
    ds_bpermute_b32 v15, v28, v5 offset:12
    s_mov_b32 s43, 163840
    s_waitcnt lgkmcnt(0)
    v_pk_fma_f32 v[216:217], v[48:49], v[8:9], v[216:217]
    v_pk_fma_f32 v[220:221], v[48:49], v[12:13], v[220:221]
    v_pk_fma_f32 v[218:219], v[50:51], v[10:11], v[218:219]
    v_pk_fma_f32 v[222:223], v[50:51], v[14:15], v[222:223]
    v_pk_fma_f32 v[216:217], v[52:53], v[12:13], v[216:217] neg_lo:[1,0,0] neg_hi:[1,0,0]
    v_pk_fma_f32 v[220:221], v[52:53], v[8:9], v[220:221]
    v_pk_fma_f32 v[218:219], v[54:55], v[14:15], v[218:219] neg_lo:[1,0,0] neg_hi:[1,0,0]
    v_pk_fma_f32 v[222:223], v[54:55], v[10:11], v[222:223]
    v_pk_fma_f32 v[240:241], v[128:129], v[216:217], v[240:241]
    v_pk_fma_f32 v[68:69], v[128:129], v[220:221], v[68:69] neg_lo:[1,0,0] neg_hi:[1,0,0]
    v_pk_fma_f32 v[242:243], v[130:131], v[218:219], v[242:243]
    v_pk_fma_f32 v[70:71], v[130:131], v[222:223], v[70:71] neg_lo:[1,0,0] neg_hi:[1,0,0]
    v_pk_fma_f32 v[240:241], v[132:133], v[220:221], v[240:241] neg_lo:[1,0,0] neg_hi:[1,0,0]
    v_pk_fma_f32 v[68:69], v[132:133], v[216:217], v[68:69] neg_lo:[1,0,0] neg_hi:[1,0,0]
    v_pk_fma_f32 v[242:243], v[134:135], v[222:223], v[242:243] neg_lo:[1,0,0] neg_hi:[1,0,0]
    v_pk_fma_f32 v[70:71], v[134:135], v[218:219], v[70:71] neg_lo:[1,0,0] neg_hi:[1,0,0]
    v_cvt_pk_bf16_f32 v224, v240, v241
    v_cvt_pk_bf16_f32 v226, v68, v69
    v_cvt_pk_bf16_f32 v225, v242, v243
    v_cvt_pk_bf16_f32 v227, v70, v71
    v_pk_fma_f32 v[64:65], v[136:137], v[216:217], v[64:65]
    v_pk_fma_f32 v[76:77], v[136:137], v[220:221], v[76:77] neg_lo:[1,0,0] neg_hi:[1,0,0]
    v_permlane16_swap_b32 v224, v226
    v_permlane16_swap_b32 v225, v227
    buffer_store_dwordx4 v[224:227], v46, s[4:7], 0 offen offset:0 sc1
    v_pk_fma_f32 v[66:67], v[138:139], v[218:219], v[66:67]
    v_pk_fma_f32 v[78:79], v[138:139], v[222:223], v[78:79] neg_lo:[1,0,0] neg_hi:[1,0,0]
    v_pk_fma_f32 v[64:65], v[140:141], v[220:221], v[64:65] neg_lo:[1,0,0] neg_hi:[1,0,0]
    v_pk_fma_f32 v[76:77], v[140:141], v[216:217], v[76:77] neg_lo:[1,0,0] neg_hi:[1,0,0]
    v_pk_fma_f32 v[66:67], v[142:143], v[222:223], v[66:67] neg_lo:[1,0,0] neg_hi:[1,0,0]
    v_pk_fma_f32 v[78:79], v[142:143], v[218:219], v[78:79] neg_lo:[1,0,0] neg_hi:[1,0,0]
    v_cvt_pk_bf16_f32 v228, v64, v65
    v_cvt_pk_bf16_f32 v230, v76, v77
    v_cvt_pk_bf16_f32 v229, v66, v67
    v_cvt_pk_bf16_f32 v231, v78, v79
    v_pk_fma_f32 v[72:73], v[144:145], v[216:217], v[72:73]
    v_pk_fma_f32 v[84:85], v[144:145], v[220:221], v[84:85] neg_lo:[1,0,0] neg_hi:[1,0,0]
    v_permlane16_swap_b32 v228, v230
    v_permlane16_swap_b32 v229, v231
    buffer_store_dwordx4 v[228:231], v46, s[4:7], 0 offen offset:1024 sc1
    v_pk_fma_f32 v[74:75], v[146:147], v[218:219], v[74:75]
    v_pk_fma_f32 v[86:87], v[146:147], v[222:223], v[86:87] neg_lo:[1,0,0] neg_hi:[1,0,0]
    v_pk_fma_f32 v[72:73], v[148:149], v[220:221], v[72:73] neg_lo:[1,0,0] neg_hi:[1,0,0]
    v_pk_fma_f32 v[84:85], v[148:149], v[216:217], v[84:85] neg_lo:[1,0,0] neg_hi:[1,0,0]
    v_pk_fma_f32 v[74:75], v[150:151], v[222:223], v[74:75] neg_lo:[1,0,0] neg_hi:[1,0,0]
    v_pk_fma_f32 v[86:87], v[150:151], v[218:219], v[86:87] neg_lo:[1,0,0] neg_hi:[1,0,0]
    v_cvt_pk_bf16_f32 v232, v72, v73
    v_cvt_pk_bf16_f32 v234, v84, v85
    v_cvt_pk_bf16_f32 v233, v74, v75
    v_cvt_pk_bf16_f32 v235, v86, v87
    v_pk_fma_f32 v[80:81], v[152:153], v[216:217], v[80:81]
    v_pk_fma_f32 v[92:93], v[152:153], v[220:221], v[92:93] neg_lo:[1,0,0] neg_hi:[1,0,0]
    v_permlane16_swap_b32 v232, v234
    v_permlane16_swap_b32 v233, v235
    buffer_store_dwordx4 v[232:235], v46, s[4:7], 0 offen offset:2048 sc1
    v_pk_fma_f32 v[82:83], v[154:155], v[218:219], v[82:83]
    v_pk_fma_f32 v[94:95], v[154:155], v[222:223], v[94:95] neg_lo:[1,0,0] neg_hi:[1,0,0]
    v_pk_fma_f32 v[80:81], v[156:157], v[220:221], v[80:81] neg_lo:[1,0,0] neg_hi:[1,0,0]
    v_pk_fma_f32 v[92:93], v[156:157], v[216:217], v[92:93] neg_lo:[1,0,0] neg_hi:[1,0,0]
    v_pk_fma_f32 v[82:83], v[158:159], v[222:223], v[82:83] neg_lo:[1,0,0] neg_hi:[1,0,0]
    v_pk_fma_f32 v[94:95], v[158:159], v[218:219], v[94:95] neg_lo:[1,0,0] neg_hi:[1,0,0]
    v_cvt_pk_bf16_f32 v236, v80, v81
    v_cvt_pk_bf16_f32 v238, v92, v93
    v_cvt_pk_bf16_f32 v237, v82, v83
    v_cvt_pk_bf16_f32 v239, v94, v95
    v_pk_fma_f32 v[88:89], v[160:161], v[216:217], v[88:89]
    v_pk_fma_f32 v[100:101], v[160:161], v[220:221], v[100:101] neg_lo:[1,0,0] neg_hi:[1,0,0]
    v_permlane16_swap_b32 v236, v238
    v_permlane16_swap_b32 v237, v239
    buffer_store_dwordx4 v[236:239], v46, s[4:7], 0 offen offset:3072 sc1
    v_pk_fma_f32 v[90:91], v[162:163], v[218:219], v[90:91]
    v_pk_fma_f32 v[102:103], v[162:163], v[222:223], v[102:103] neg_lo:[1,0,0] neg_hi:[1,0,0]
    v_pk_fma_f32 v[88:89], v[164:165], v[220:221], v[88:89] neg_lo:[1,0,0] neg_hi:[1,0,0]
    v_pk_fma_f32 v[100:101], v[164:165], v[216:217], v[100:101] neg_lo:[1,0,0] neg_hi:[1,0,0]
    v_pk_fma_f32 v[90:91], v[166:167], v[222:223], v[90:91] neg_lo:[1,0,0] neg_hi:[1,0,0]
    v_pk_fma_f32 v[102:103], v[166:167], v[218:219], v[102:103] neg_lo:[1,0,0] neg_hi:[1,0,0]
    v_cvt_pk_bf16_f32 v192, v88, v89
    v_cvt_pk_bf16_f32 v194, v100, v101
    v_cvt_pk_bf16_f32 v193, v90, v91
    v_cvt_pk_bf16_f32 v195, v102, v103
    v_pk_fma_f32 v[96:97], v[168:169], v[216:217], v[96:97]
    v_pk_fma_f32 v[108:109], v[168:169], v[220:221], v[108:109] neg_lo:[1,0,0] neg_hi:[1,0,0]
    v_permlane16_swap_b32 v192, v194
    v_permlane16_swap_b32 v193, v195
    buffer_store_dwordx4 v[192:195], v46, s[4:7], s43 offen offset:0 sc1
    v_pk_fma_f32 v[98:99], v[170:171], v[218:219], v[98:99]
    v_pk_fma_f32 v[110:111], v[170:171], v[222:223], v[110:111] neg_lo:[1,0,0] neg_hi:[1,0,0]
    v_pk_fma_f32 v[96:97], v[172:173], v[220:221], v[96:97] neg_lo:[1,0,0] neg_hi:[1,0,0]
    v_pk_fma_f32 v[108:109], v[172:173], v[216:217], v[108:109] neg_lo:[1,0,0] neg_hi:[1,0,0]
    v_pk_fma_f32 v[98:99], v[174:175], v[222:223], v[98:99] neg_lo:[1,0,0] neg_hi:[1,0,0]
    v_pk_fma_f32 v[110:111], v[174:175], v[218:219], v[110:111] neg_lo:[1,0,0] neg_hi:[1,0,0]
    v_cvt_pk_bf16_f32 v196, v96, v97
    v_cvt_pk_bf16_f32 v198, v108, v109
    v_cvt_pk_bf16_f32 v197, v98, v99
    v_cvt_pk_bf16_f32 v199, v110, v111
    v_pk_fma_f32 v[104:105], v[176:177], v[216:217], v[104:105]
    v_pk_fma_f32 v[116:117], v[176:177], v[220:221], v[116:117] neg_lo:[1,0,0] neg_hi:[1,0,0]
    v_permlane16_swap_b32 v196, v198
    v_permlane16_swap_b32 v197, v199
    buffer_store_dwordx4 v[196:199], v46, s[4:7], s43 offen offset:1024 sc1
    v_pk_fma_f32 v[106:107], v[178:179], v[218:219], v[106:107]
    v_pk_fma_f32 v[118:119], v[178:179], v[222:223], v[118:119] neg_lo:[1,0,0] neg_hi:[1,0,0]
    v_pk_fma_f32 v[104:105], v[180:181], v[220:221], v[104:105] neg_lo:[1,0,0] neg_hi:[1,0,0]
    v_pk_fma_f32 v[116:117], v[180:181], v[216:217], v[116:117] neg_lo:[1,0,0] neg_hi:[1,0,0]
    v_pk_fma_f32 v[106:107], v[182:183], v[222:223], v[106:107] neg_lo:[1,0,0] neg_hi:[1,0,0]
    v_pk_fma_f32 v[118:119], v[182:183], v[218:219], v[118:119] neg_lo:[1,0,0] neg_hi:[1,0,0]
    v_cvt_pk_bf16_f32 v200, v104, v105
    v_cvt_pk_bf16_f32 v202, v116, v117
    v_cvt_pk_bf16_f32 v201, v106, v107
    v_cvt_pk_bf16_f32 v203, v118, v119
    v_pk_fma_f32 v[112:113], v[184:185], v[216:217], v[112:113]
    v_pk_fma_f32 v[124:125], v[184:185], v[220:221], v[124:125] neg_lo:[1,0,0] neg_hi:[1,0,0]
    v_permlane16_swap_b32 v200, v202
    v_permlane16_swap_b32 v201, v203
    buffer_store_dwordx4 v[200:203], v46, s[4:7], s43 offen offset:2048 sc1
    v_pk_fma_f32 v[114:115], v[186:187], v[218:219], v[114:115]
    v_pk_fma_f32 v[126:127], v[186:187], v[222:223], v[126:127] neg_lo:[1,0,0] neg_hi:[1,0,0]
    v_pk_fma_f32 v[112:113], v[188:189], v[220:221], v[112:113] neg_lo:[1,0,0] neg_hi:[1,0,0]
    v_pk_fma_f32 v[124:125], v[188:189], v[216:217], v[124:125] neg_lo:[1,0,0] neg_hi:[1,0,0]
    v_pk_fma_f32 v[114:115], v[190:191], v[222:223], v[114:115] neg_lo:[1,0,0] neg_hi:[1,0,0]
    v_pk_fma_f32 v[126:127], v[190:191], v[218:219], v[126:127] neg_lo:[1,0,0] neg_hi:[1,0,0]
    v_cvt_pk_bf16_f32 v204, v112, v113
    v_cvt_pk_bf16_f32 v206, v124, v125
    v_cvt_pk_bf16_f32 v205, v114, v115
    v_cvt_pk_bf16_f32 v207, v126, v127
    v_permlane16_swap_b32 v204, v206
    s_nop 0
    v_permlane16_swap_b32 v205, v207
    buffer_store_dwordx4 v[204:207], v46, s[4:7], s43 offen offset:3072 sc1
    s_barrier
    s_mov_b32 s40, 5
    s_lshl_b32 s40, s40, 7
    s_add_u32 m0, s101, 0
    s_nop 0
    buffer_load_dwordx4 v20, s[24:27], s40 offen  lds
    s_add_u32 m0, s101, 1024
    s_nop 0
    buffer_load_dwordx4 v21, s[24:27], s40 offen  lds
    s_add_u32 m0, s101, 2048
    s_nop 0
    buffer_load_dwordx4 v22, s[24:27], s40 offen  lds
    s_add_u32 m0, s101, 3072
    s_nop 0
    buffer_load_dwordx4 v23, s[24:27], s40 offen  lds
    s_add_u32 m0, s101, 4096
    s_nop 0
    buffer_load_dwordx4 v20, s[28:31], s40 offen  lds
    s_add_u32 m0, s101, 5120
    s_nop 0
    buffer_load_dwordx4 v21, s[28:31], s40 offen  lds
    s_add_u32 m0, s101, 6144
    s_nop 0
    buffer_load_dwordx4 v22, s[28:31], s40 offen  lds
    s_add_u32 m0, s101, 7168
    s_nop 0
    buffer_load_dwordx4 v23, s[28:31], s40 offen  lds
    s_waitcnt vmcnt(8)
    s_barrier
    s_cmp_lg_u32 s3, 0
    s_cbranch_scc1 Lwf_5
    s_mov_b64 exec, 1
    buffer_store_dword v34, v47, s[4:7], 0 offen sc1
    s_mov_b64 exec, -1
Lwf_5:
    s_mov_b32 s40, 6
    s_lshl_b32 s40, s40, 7
    s_add_u32 m0, s101, 32768
    s_nop 0
    buffer_load_dwordx4 v20, s[24:27], s40 offen  lds
    s_add_u32 m0, s101, 33792
    s_nop 0
    buffer_load_dwordx4 v21, s[24:27], s40 offen  lds
    s_add_u32 m0, s101, 34816
    s_nop 0
    buffer_load_dwordx4 v22, s[24:27], s40 offen  lds
    s_add_u32 m0, s101, 35840
    s_nop 0
    buffer_load_dwordx4 v23, s[24:27], s40 offen  lds
    s_add_u32 m0, s101, 36864
    s_nop 0
    buffer_load_dwordx4 v20, s[28:31], s40 offen  lds
    s_add_u32 m0, s101, 37888
    s_nop 0
    buffer_load_dwordx4 v21, s[28:31], s40 offen  lds
    s_add_u32 m0, s101, 38912
    s_nop 0
    buffer_load_dwordx4 v22, s[28:31], s40 offen  lds
    s_add_u32 m0, s101, 39936
    s_nop 0
    buffer_load_dwordx4 v23, s[28:31], s40 offen  lds
    s_mov_b32 s40, 7
    s_lshl_b32 s40, s40, 7
    s_add_u32 m0, s101, 65536
    s_nop 0
    buffer_load_dwordx4 v20, s[24:27], s40 offen  lds
    s_add_u32 m0, s101, 66560
    s_nop 0
    buffer_load_dwordx4 v21, s[24:27], s40 offen  lds
    s_add_u32 m0, s101, 67584
    s_nop 0
    buffer_load_dwordx4 v22, s[24:27], s40 offen  lds
    s_add_u32 m0, s101, 68608
    s_nop 0
    buffer_load_dwordx4 v23, s[24:27], s40 offen  lds
    s_add_u32 m0, s101, 69632
    s_nop 0
    buffer_load_dwordx4 v20, s[28:31], s40 offen  lds
    s_add_u32 m0, s101, 70656
    s_nop 0
    buffer_load_dwordx4 v21, s[28:31], s40 offen  lds
    s_add_u32 m0, s101, 71680
    s_nop 0
    buffer_load_dwordx4 v22, s[28:31], s40 offen  lds
    s_add_u32 m0, s101, 72704
    s_nop 0
    buffer_load_dwordx4 v23, s[28:31], s40 offen  lds
    s_waitcnt vmcnt(16)
    v_xor_b32 v12, 0, v16
    v_xor_b32 v13, 32, v16
    v_xor_b32 v14, 64, v16
    v_xor_b32 v15, 96, v16
    ds_read_b128 v[96:99], v12 offset:0
    ds_read_b128 v[100:103], v12 offset:2048
    ds_read_b128 v[104:107], v13 offset:0
    ds_read_b128 v[108:111], v13 offset:2048
    ds_read_b128 v[112:115], v14 offset:0
    ds_read_b128 v[116:119], v14 offset:2048
    ds_read_b128 v[120:123], v15 offset:0
    ds_read_b128 v[124:127], v15 offset:2048
    s_waitcnt lgkmcnt(0)
    s_mov_b32 s40, 8
    s_lshl_b32 s40, s40, 7
    s_add_u32 m0, s101, 0
    s_nop 0
    buffer_load_dwordx4 v20, s[24:27], s40 offen  lds
    s_add_u32 m0, s101, 1024
    s_nop 0
    buffer_load_dwordx4 v21, s[24:27], s40 offen  lds
    s_add_u32 m0, s101, 2048
    s_nop 0
    buffer_load_dwordx4 v22, s[24:27], s40 offen  lds
    s_add_u32 m0, s101, 3072
    s_nop 0
    buffer_load_dwordx4 v23, s[24:27], s40 offen  lds
    s_add_u32 m0, s101, 4096
    s_nop 0
    buffer_load_dwordx4 v20, s[28:31], s40 offen  lds
    s_add_u32 m0, s101, 5120
    s_nop 0
    buffer_load_dwordx4 v21, s[28:31], s40 offen  lds
    s_add_u32 m0, s101, 6144
    s_nop 0
    buffer_load_dwordx4 v22, s[28:31], s40 offen  lds
    s_add_u32 m0, s101, 7168
    s_nop 0
    buffer_load_dwordx4 v23, s[28:31], s40 offen  lds
    s_waitcnt vmcnt(16)
    v_xor_b32 v12, 0, v16
    v_xor_b32 v13, 32, v16
    v_xor_b32 v14, 64, v16
    v_xor_b32 v15, 96, v16
    ds_read_b128 v[128:131], v12 offset:32768
    ds_read_b128 v[132:135], v12 offset:34816
    ds_read_b128 v[136:139], v13 offset:32768
    ds_read_b128 v[140:143], v13 offset:34816
    ds_read_b128 v[144:147], v14 offset:32768
    ds_read_b128 v[148:151], v14 offset:34816
    ds_read_b128 v[152:155], v15 offset:32768
    ds_read_b128 v[156:159], v15 offset:34816
    s_barrier
    s_lshl_b32 s43, s37, 8
    s_or_b32 s43, s43, s41
    s_or_b32 s43, s43, s100
    s_cmp_lg_u32 s43, 543
    s_cbranch_scc1 Lep_6
    s_mov_b32 s43, 2560
    v_mov_b32 v6, s43
    v_mov_b32 v7, s42
    s_mov_b64 exec, 1
    buffer_store_dword v7, v6, s[4:7], 0 offen sc1
    s_mov_b64 exec, -1
Lep_6:
    s_waitcnt vmcnt(8)
    v_xor_b32 v12, 0, v16
    v_add_u32 v12, 65536, v12
    v_xor_b32 v13, 32, v16
    v_add_u32 v13, 65536, v13
    v_xor_b32 v14, 64, v16
    v_add_u32 v14, 65536, v14
    v_xor_b32 v15, 96, v16
    v_add_u32 v15, 65536, v15
    ds_read_b128 v[160:163], v12 offset:0
    ds_read_b128 v[164:167], v12 offset:2048
    ds_read_b128 v[168:171], v13 offset:0
    ds_read_b128 v[172:175], v13 offset:2048
    ds_read_b128 v[176:179], v14 offset:0
    ds_read_b128 v[180:183], v14 offset:2048
    ds_read_b128 v[184:187], v15 offset:0
    ds_read_b128 v[188:191], v15 offset:2048
    s_waitcnt lgkmcnt(0)
    s_mov_b32 s40, 4
    s_lshl_b32 s40, s40, 14
    s_add_u32 m0, s101, 65536
    s_nop 0
    buffer_load_dwordx4 v19, s[4:7], s40 offen offset:0 sc1 lds
    buffer_load_dwordx4 v19, s[4:7], s40 offen offset:1024 sc1 lds
    buffer_load_dwordx4 v19, s[4:7], s40 offen offset:2048 sc1 lds
    buffer_load_dwordx4 v19, s[4:7], s40 offen offset:3072 sc1 lds
    s_barrier
    s_mov_b32 s40, 9
    s_lshl_b32 s40, s40, 7
    s_add_u32 m0, s101, 32768
    s_nop 0
    buffer_load_dwordx4 v20, s[24:27], s40 offen  lds
    s_add_u32 m0, s101, 33792
    s_nop 0
    buffer_load_dwordx4 v21, s[24:27], s40 offen  lds
    s_add_u32 m0, s101, 34816
    s_nop 0
    buffer_load_dwordx4 v22, s[24:27], s40 offen  lds
    s_add_u32 m0, s101, 35840
    s_nop 0
    buffer_load_dwordx4 v23, s[24:27], s40 offen  lds
    s_add_u32 m0, s101, 36864
    s_nop 0
    buffer_load_dwordx4 v20, s[28:31], s40 offen  lds
    s_add_u32 m0, s101, 37888
    s_nop 0
    buffer_load_dwordx4 v21, s[28:31], s40 offen  lds
    s_add_u32 m0, s101, 38912
    s_nop 0
    buffer_load_dwordx4 v22, s[28:31], s40 offen  lds
    s_add_u32 m0, s101, 39936
    s_nop 0
    buffer_load_dwordx4 v23, s[28:31], s40 offen  lds
    s_waitcnt vmcnt(12)
    v_xor_b32 v12, 0, v16
    v_xor_b32 v13, 32, v16
    v_xor_b32 v14, 64, v16
    v_xor_b32 v15, 96, v16
    ds_read_b128 v[192:195], v12 offset:0
    ds_read_b128 v[196:199], v12 offset:2048
    ds_read_b128 v[200:203], v13 offset:0
    ds_read_b128 v[204:207], v13 offset:2048
    ds_read_b128 v[208:211], v14 offset:0
    ds_read_b128 v[212:215], v14 offset:2048
    ds_read_b128 v[216:219], v15 offset:0
    ds_read_b128 v[220:223], v15 offset:2048
    s_waitcnt lgkmcnt(0)
    s_barrier
    s_mov_b32 s40, 5
    s_lshl_b32 s40, s40, 14
    s_add_u32 m0, s101, 69632
    s_nop 0
    buffer_load_dwordx4 v19, s[4:7], s40 offen offset:0 sc1 lds
    buffer_load_dwordx4 v19, s[4:7], s40 offen offset:1024 sc1 lds
    buffer_load_dwordx4 v19, s[4:7], s40 offen offset:2048 sc1 lds
    buffer_load_dwordx4 v19, s[4:7], s40 offen offset:3072 sc1 lds
    s_mov_b32 s40, 6
    s_lshl_b32 s40, s40, 14
    s_add_u32 m0, s101, 0
    s_nop 0
    buffer_load_dwordx4 v19, s[4:7], s40 offen offset:0 sc1 lds
    buffer_load_dwordx4 v19, s[4:7], s40 offen offset:1024 sc1 lds
    buffer_load_dwordx4 v19, s[4:7], s40 offen offset:2048 sc1 lds
    buffer_load_dwordx4 v19, s[4:7], s40 offen offset:3072 sc1 lds
    s_barrier
    s_mov_b32 s40, 7
    s_lshl_b32 s40, s40, 14
    s_add_u32 m0, s101, 4096
    s_nop 0
    buffer_load_dwordx4 v19, s[4:7], s40 offen offset:0 sc1 lds
    buffer_load_dwordx4 v19, s[4:7], s40 offen offset:1024 sc1 lds
    buffer_load_dwordx4 v19, s[4:7], s40 offen offset:2048 sc1 lds
    buffer_load_dwordx4 v19, s[4:7], s40 offen offset:3072 sc1 lds
    s_waitcnt vmcnt(12)
    v_xor_b32 v12, 0, v16
    v_xor_b32 v13, 32, v16
    v_xor_b32 v14, 64, v16
    v_xor_b32 v15, 96, v16
    ds_read_b128 v[224:227], v12 offset:32768
    ds_read_b128 v[228:231], v12 offset:34816
    ds_read_b128 v[232:235], v13 offset:32768
    ds_read_b128 v[236:239], v13 offset:34816
    ds_read_b128 v[240:243], v14 offset:32768
    ds_read_b128 v[244:247], v14 offset:34816
    ds_read_b128 v[248:251], v15 offset:32768
    ds_read_b128 v[252:255], v15 offset:34816
    s_waitcnt lgkmcnt(0)
    s_barrier
    s_mov_b32 s40, 8
    s_lshl_b32 s40, s40, 14
    s_add_u32 m0, s101, 32768
    s_nop 0
    buffer_load_dwordx4 v19, s[4:7], s40 offen offset:0 sc1 lds
    buffer_load_dwordx4 v19, s[4:7], s40 offen offset:1024 sc1 lds
    buffer_load_dwordx4 v19, s[4:7], s40 offen offset:2048 sc1 lds
    buffer_load_dwordx4 v19, s[4:7], s40 offen offset:3072 sc1 lds
    s_mov_b32 s40, 9
    s_lshl_b32 s40, s40, 14
    s_add_u32 m0, s101, 36864
    s_nop 0
    buffer_load_dwordx4 v19, s[4:7], s40 offen offset:0 sc1 lds
    buffer_load_dwordx4 v19, s[4:7], s40 offen offset:1024 sc1 lds
    buffer_load_dwordx4 v19, s[4:7], s40 offen offset:2048 sc1 lds
    buffer_load_dwordx4 v19, s[4:7], s40 offen offset:3072 sc1 lds
    s_waitcnt vmcnt(16)
    s_barrier
    ds_read_b128 v[32:35], v17 offset:4096
    ds_read_b128 v[36:39], v17 offset:5120
    ds_read_b128 v[40:43], v17 offset:6144
    ds_read_b128 v[44:47], v17 offset:7168
    s_waitcnt lgkmcnt(0)
    v_mfma_f32_16x16x32_bf16 v[64:67], v[32:35], v[96:99], 0
    ds_read_b128 v[48:51], v17 offset:12288
    v_mfma_f32_16x16x32_bf16 v[68:71], v[32:35], v[100:103], 0
    ds_read_b128 v[52:55], v17 offset:13312
    v_mfma_f32_16x16x32_bf16 v[72:75], v[36:39], v[96:99], 0
    ds_read_b128 v[56:59], v17 offset:14336
    v_mfma_f32_16x16x32_bf16 v[76:79], v[36:39], v[100:103], 0
    ds_read_b128 v[60:63], v17 offset:15360
    v_mfma_f32_16x16x32_bf16 v[80:83], v[40:43], v[96:99], 0
    v_mfma_f32_16x16x32_bf16 v[84:87], v[40:43], v[100:103], 0
    v_mfma_f32_16x16x32_bf16 v[88:91], v[44:47], v[96:99], 0
    v_mfma_f32_16x16x32_bf16 v[92:95], v[44:47], v[100:103], 0
    s_waitcnt lgkmcnt(0)
    v_mfma_f32_16x16x32_bf16 v[64:67], v[48:51], v[104:107], v[64:67]
    ds_read_b128 v[32:35], v17 offset:20480
    v_mfma_f32_16x16x32_bf16 v[68:71], v[48:51], v[108:111], v[68:71]
    ds_read_b128 v[36:39], v17 offset:21504
    v_mfma_f32_16x16x32_bf16 v[72:75], v[52:55], v[104:107], v[72:75]
    ds_read_b128 v[40:43], v17 offset:22528
    v_mfma_f32_16x16x32_bf16 v[76:79], v[52:55], v[108:111], v[76:79]
    ds_read_b128 v[44:47], v17 offset:23552
    v_mfma_f32_16x16x32_bf16 v[80:83], v[56:59], v[104:107], v[80:83]
    v_mfma_f32_16x16x32_bf16 v[84:87], v[56:59], v[108:111], v[84:87]
    v_mfma_f32_16x16x32_bf16 v[88:91], v[60:63], v[104:107], v[88:91]
    v_mfma_f32_16x16x32_bf16 v[92:95], v[60:63], v[108:111], v[92:95]
    s_waitcnt lgkmcnt(0)
    v_mfma_f32_16x16x32_bf16 v[64:67], v[32:35], v[112:115], v[64:67]
    ds_read_b128 v[48:51], v17 offset:28672
    v_mfma_f32_16x16x32_bf16 v[68:71], v[32:35], v[116:119], v[68:71]
    ds_read_b128 v[52:55], v17 offset:29696
    v_mfma_f32_16x16x32_bf16 v[72:75], v[36:39], v[112:115], v[72:75]
    ds_read_b128 v[56:59], v17 offset:30720
    v_mfma_f32_16x16x32_bf16 v[76:79], v[36:39], v[116:119], v[76:79]
    ds_read_b128 v[60:63], v17 offset:31744
    v_mfma_f32_16x16x32_bf16 v[80:83], v[40:43], v[112:115], v[80:83]
    v_mfma_f32_16x16x32_bf16 v[84:87], v[40:43], v[116:119], v[84:87]
    v_mfma_f32_16x16x32_bf16 v[88:91], v[44:47], v[112:115], v[88:91]
    v_mfma_f32_16x16x32_bf16 v[92:95], v[44:47], v[116:119], v[92:95]
    s_waitcnt lgkmcnt(0)
    s_waitcnt vmcnt(12)
    s_barrier
    v_mfma_f32_16x16x32_bf16 v[64:67], v[48:51], v[120:123], v[64:67]
    ds_read_b128 v[32:35], v26 offset:0
    v_mfma_f32_16x16x32_bf16 v[68:71], v[48:51], v[124:127], v[68:71]
    ds_read_b128 v[36:39], v26 offset:1024
    v_mfma_f32_16x16x32_bf16 v[72:75], v[52:55], v[120:123], v[72:75]
    ds_read_b128 v[40:43], v26 offset:2048
    v_mfma_f32_16x16x32_bf16 v[76:79], v[52:55], v[124:127], v[76:79]
    ds_read_b128 v[44:47], v26 offset:3072
    v_mfma_f32_16x16x32_bf16 v[80:83], v[56:59], v[120:123], v[80:83]
    v_mfma_f32_16x16x32_bf16 v[84:87], v[56:59], v[124:127], v[84:87]
    v_mfma_f32_16x16x32_bf16 v[88:91], v[60:63], v[120:123], v[88:91]
    v_mfma_f32_16x16x32_bf16 v[92:95], v[60:63], v[124:127], v[92:95]
    s_waitcnt lgkmcnt(0)
    v_mfma_f32_16x16x32_bf16 v[64:67], v[32:35], v[128:131], v[64:67]
    ds_read_b128 v[48:51], v26 offset:8192
    v_mfma_f32_16x16x32_bf16 v[68:71], v[32:35], v[132:135], v[68:71]
    ds_read_b128 v[52:55], v26 offset:9216
    v_mfma_f32_16x16x32_bf16 v[72:75], v[36:39], v[128:131], v[72:75]
    ds_read_b128 v[56:59], v26 offset:10240
    v_mfma_f32_16x16x32_bf16 v[76:79], v[36:39], v[132:135], v[76:79]
    ds_read_b128 v[60:63], v26 offset:11264
    v_mfma_f32_16x16x32_bf16 v[80:83], v[40:43], v[128:131], v[80:83]
    v_mfma_f32_16x16x32_bf16 v[84:87], v[40:43], v[132:135], v[84:87]
Lhk_g_4:
    s_cbranch_execz Lhr_g
    v_mfma_f32_16x16x32_bf16 v[88:91], v[44:47], v[128:131], v[88:91]
    v_mfma_f32_16x16x32_bf16 v[92:95], v[44:47], v[132:135], v[92:95]
    s_waitcnt lgkmcnt(0)
    v_mfma_f32_16x16x32_bf16 v[64:67], v[48:51], v[136:139], v[64:67]
    ds_read_b128 v[32:35], v26 offset:16384
    v_mfma_f32_16x16x32_bf16 v[68:71], v[48:51], v[140:143], v[68:71]
    ds_read_b128 v[36:39], v26 offset:17408
    v_mfma_f32_16x16x32_bf16 v[72:75], v[52:55], v[136:139], v[72:75]
    ds_read_b128 v[40:43], v26 offset:18432
    v_mfma_f32_16x16x32_bf16 v[76:79], v[52:55], v[140:143], v[76:79]
    ds_read_b128 v[44:47], v26 offset:19456
    v_mfma_f32_16x16x32_bf16 v[80:83], v[56:59], v[136:139], v[80:83]
    v_mfma_f32_16x16x32_bf16 v[84:87], v[56:59], v[140:143], v[84:87]
    v_mfma_f32_16x16x32_bf16 v[88:91], v[60:63], v[136:139], v[88:91]
    v_mfma_f32_16x16x32_bf16 v[92:95], v[60:63], v[140:143], v[92:95]
    s_waitcnt lgkmcnt(0)
    v_mfma_f32_16x16x32_bf16 v[64:67], v[32:35], v[144:147], v[64:67]
    ds_read_b128 v[48:51], v26 offset:24576
    v_mfma_f32_16x16x32_bf16 v[68:71], v[32:35], v[148:151], v[68:71]
    ds_read_b128 v[52:55], v26 offset:25600
    v_mfma_f32_16x16x32_bf16 v[72:75], v[36:39], v[144:147], v[72:75]
    ds_read_b128 v[56:59], v26 offset:26624
    v_mfma_f32_16x16x32_bf16 v[76:79], v[36:39], v[148:151], v[76:79]
    ds_read_b128 v[60:63], v26 offset:27648
    v_mfma_f32_16x16x32_bf16 v[80:83], v[40:43], v[144:147], v[80:83]
    v_mfma_f32_16x16x32_bf16 v[84:87], v[40:43], v[148:151], v[84:87]
    v_mfma_f32_16x16x32_bf16 v[88:91], v[44:47], v[144:147], v[88:91]
    v_mfma_f32_16x16x32_bf16 v[92:95], v[44:47], v[148:151], v[92:95]
    s_waitcnt lgkmcnt(0)
    s_waitcnt vmcnt(8)
    s_barrier
    v_mfma_f32_16x16x32_bf16 v[64:67], v[48:51], v[152:155], v[64:67]
    ds_read_b128 v[32:35], v26 offset:4096
    v_mfma_f32_16x16x32_bf16 v[68:71], v[48:51], v[156:159], v[68:71]
    ds_read_b128 v[36:39], v26 offset:5120
    v_mfma_f32_16x16x32_bf16 v[72:75], v[52:55], v[152:155], v[72:75]
    ds_read_b128 v[40:43], v26 offset:6144
    v_mfma_f32_16x16x32_bf16 v[76:79], v[52:55], v[156:159], v[76:79]
    ds_read_b128 v[44:47], v26 offset:7168
    v_mfma_f32_16x16x32_bf16 v[80:83], v[56:59], v[152:155], v[80:83]
    v_mfma_f32_16x16x32_bf16 v[84:87], v[56:59], v[156:159], v[84:87]
    v_mfma_f32_16x16x32_bf16 v[88:91], v[60:63], v[152:155], v[88:91]
    v_mfma_f32_16x16x32_bf16 v[92:95], v[60:63], v[156:159], v[92:95]
    s_waitcnt lgkmcnt(0)
    v_mfma_f32_16x16x32_bf16 v[64:67], v[32:35], v[160:163], v[64:67]
    ds_read_b128 v[48:51], v26 offset:12288
    v_mfma_f32_16x16x32_bf16 v[68:71], v[32:35], v[164:167], v[68:71]
    ds_read_b128 v[52:55], v26 offset:13312
    v_mfma_f32_16x16x32_bf16 v[72:75], v[36:39], v[160:163], v[72:75]
    ds_read_b128 v[56:59], v26 offset:14336
    v_mfma_f32_16x16x32_bf16 v[76:79], v[36:39], v[164:167], v[76:79]
    ds_read_b128 v[60:63], v26 offset:15360
    v_mfma_f32_16x16x32_bf16 v[80:83], v[40:43], v[160:163], v[80:83]
    v_mfma_f32_16x16x32_bf16 v[84:87], v[40:43], v[164:167], v[84:87]
    v_mfma_f32_16x16x32_bf16 v[88:91], v[44:47], v[160:163], v[88:91]
    v_mfma_f32_16x16x32_bf16 v[92:95], v[44:47], v[164:167], v[92:95]
    s_waitcnt lgkmcnt(0)
    v_mfma_f32_16x16x32_bf16 v[64:67], v[48:51], v[168:171], v[64:67]
    ds_read_b128 v[32:35], v26 offset:20480
    v_mfma_f32_16x16x32_bf16 v[68:71], v[48:51], v[172:175], v[68:71]
    ds_read_b128 v[36:39], v26 offset:21504
    v_mfma_f32_16x16x32_bf16 v[72:75], v[52:55], v[168:171], v[72:75]
    ds_read_b128 v[40:43], v26 offset:22528
    v_mfma_f32_16x16x32_bf16 v[76:79], v[52:55], v[172:175], v[76:79]
    ds_read_b128 v[44:47], v26 offset:23552
    v_mfma_f32_16x16x32_bf16 v[80:83], v[56:59], v[168:171], v[80:83]
    v_mfma_f32_16x16x32_bf16 v[84:87], v[56:59], v[172:175], v[84:87]
    v_mfma_f32_16x16x32_bf16 v[88:91], v[60:63], v[168:171], v[88:91]
    v_mfma_f32_16x16x32_bf16 v[92:95], v[60:63], v[172:175], v[92:95]
    s_waitcnt lgkmcnt(0)
    v_mfma_f32_16x16x32_bf16 v[64:67], v[32:35], v[176:179], v[64:67]
    ds_read_b128 v[48:51], v26 offset:28672
    v_mfma_f32_16x16x32_bf16 v[68:71], v[32:35], v[180:183], v[68:71]
    ds_read_b128 v[52:55], v26 offset:29696
    v_mfma_f32_16x16x32_bf16 v[72:75], v[36:39], v[176:179], v[72:75]
    ds_read_b128 v[56:59], v26 offset:30720
    v_mfma_f32_16x16x32_bf16 v[76:79], v[36:39], v[180:183], v[76:79]
    ds_read_b128 v[60:63], v26 offset:31744
    v_mfma_f32_16x16x32_bf16 v[80:83], v[40:43], v[176:179], v[80:83]
    v_mfma_f32_16x16x32_bf16 v[84:87], v[40:43], v[180:183], v[84:87]
    v_mfma_f32_16x16x32_bf16 v[88:91], v[44:47], v[176:179], v[88:91]
    v_mfma_f32_16x16x32_bf16 v[92:95], v[44:47], v[180:183], v[92:95]
    s_waitcnt lgkmcnt(0)
    s_waitcnt vmcnt(0)
    s_barrier
    v_mfma_f32_16x16x32_bf16 v[64:67], v[48:51], v[184:187], v[64:67]
    ds_read_b128 v[32:35], v26 offset:32768
    ds_read_b128 v[96:99], v24 offset:32768
    v_mfma_f32_16x16x32_bf16 v[68:71], v[48:51], v[188:191], v[68:71]
    ds_read_b128 v[36:39], v26 offset:40960
    v_mfma_f32_16x16x32_bf16 v[72:75], v[52:55], v[184:187], v[72:75]
    ds_read_b128 v[40:43], v26 offset:49152
    ds_read_b128 v[100:103], v24 offset:33792
    v_mfma_f32_16x16x32_bf16 v[76:79], v[52:55], v[188:191], v[76:79]
    ds_read_b128 v[44:47], v26 offset:57344
    v_mfma_f32_16x16x32_bf16 v[80:83], v[56:59], v[184:187], v[80:83]
    v_mfma_f32_16x16x32_bf16 v[84:87], v[56:59], v[188:191], v[84:87]
    ds_read_b128 v[104:107], v24 offset:34816
    v_mfma_f32_16x16x32_bf16 v[88:91], v[60:63], v[184:187], v[88:91]
    v_mfma_f32_16x16x32_bf16 v[92:95], v[60:63], v[188:191], v[92:95]
    s_waitcnt lgkmcnt(1)
    v_mfma_f32_16x16x32_bf16 v[64:67], v[32:35], v[192:195], v[64:67]
    ds_read_b128 v[48:51], v26 offset:36864
    ds_read_b128 v[108:111], v24 offset:35840
    v_mfma_f32_16x16x32_bf16 v[68:71], v[32:35], v[196:199], v[68:71]
    ds_read_b128 v[52:55], v26 offset:45056
    v_mfma_f32_16x16x32_bf16 v[64:67], v[36:39], v[200:203], v[64:67]
    ds_read_b128 v[56:59], v26 offset:53248
    ds_read_b128 v[112:115], v24 offset:36864
    v_mfma_f32_16x16x32_bf16 v[68:71], v[36:39], v[204:207], v[68:71]
    ds_read_b128 v[60:63], v26 offset:61440
    v_mfma_f32_16x16x32_bf16 v[64:67], v[40:43], v[208:211], v[64:67]
    v_mfma_f32_16x16x32_bf16 v[68:71], v[40:43], v[212:215], v[68:71]
    ds_read_b128 v[116:119], v24 offset:37888
    v_mfma_f32_16x16x32_bf16 v[64:67], v[44:47], v[216:219], v[64:67]
    v_mfma_f32_16x16x32_bf16 v[68:71], v[44:47], v[220:223], v[68:71]
    s_waitcnt lgkmcnt(1)
    v_mfma_f32_16x16x32_bf16 v[64:67], v[48:51], v[224:227], v[64:67]
    ds_read_b128 v[32:35], v26 offset:33792
    ds_read_b128 v[120:123], v24 offset:38912
    v_mfma_f32_16x16x32_bf16 v[68:71], v[48:51], v[228:231], v[68:71]
    ds_read_b128 v[36:39], v26 offset:41984
    v_mfma_f32_16x16x32_bf16 v[64:67], v[52:55], v[232:235], v[64:67]
    ds_read_b128 v[40:43], v26 offset:50176
    v_mfma_f32_16x16x32_bf16 v[68:71], v[52:55], v[236:239], v[68:71]
    ds_read_b128 v[44:47], v26 offset:58368
    v_mfma_f32_16x16x32_bf16 v[64:67], v[56:59], v[240:243], v[64:67]
    ds_read_b128 v[124:127], v24 offset:39936
    v_mfma_f32_16x16x32_bf16 v[68:71], v[56:59], v[244:247], v[68:71]
    v_mfma_f32_16x16x32_bf16 v[64:67], v[60:63], v[248:251], v[64:67]
    v_mfma_f32_16x16x32_bf16 v[68:71], v[60:63], v[252:255], v[68:71]
    s_waitcnt lgkmcnt(1)
    v_mfma_f32_16x16x32_bf16 v[72:75], v[32:35], v[192:195], v[72:75]
    ds_read_b128 v[48:51], v26 offset:37888
    v_mfma_f32_16x16x32_bf16 v[76:79], v[32:35], v[196:199], v[76:79]
    ds_read_b128 v[52:55], v26 offset:46080
    v_mfma_f32_16x16x32_bf16 v[72:75], v[36:39], v[200:203], v[72:75]
    ds_read_b128 v[56:59], v26 offset:54272
    s_waitcnt lgkmcnt(3)
    v_add_f32_dpp v96, v64, v96 quad_perm:[0,1,2,3] row_mask:0xf bank_mask:0x3
    v_mfma_f32_16x16x32_bf16 v[76:79], v[36:39], v[204:207], v[76:79]
    ds_read_b128 v[60:63], v26 offset:62464
    v_add_f32_dpp v98, v64, v98 row_ror:8 row_mask:0xf bank_mask:0x3
    v_mfma_f32_16x16x32_bf16 v[72:75], v[40:43], v[208:211], v[72:75]
    v_add_f32_dpp v97, v68, v97 quad_perm:[0,1,2,3] row_mask:0xf bank_mask:0x3
    v_add_f32_dpp v99, v68, v99 row_ror:8 row_mask:0xf bank_mask:0x3
    v_mfma_f32_16x16x32_bf16 v[76:79], v[40:43], v[212:215], v[76:79]
    v_add_f32_dpp v96, v65, v96 row_ror:8 row_mask:0xf bank_mask:0xc
    v_mfma_f32_16x16x32_bf16 v[72:75], v[44:47], v[216:219], v[72:75]
    v_add_f32_dpp v98, v65, v98 quad_perm:[0,1,2,3] row_mask:0xf bank_mask:0xc
    v_add_f32_dpp v97, v69, v97 row_ror:8 row_mask:0xf bank_mask:0xc
    v_mfma_f32_16x16x32_bf16 v[76:79], v[44:47], v[220:223], v[76:79]
    v_add_f32_dpp v99, v69, v99 quad_perm:[0,1,2,3] row_mask:0xf bank_mask:0xc
    s_waitcnt lgkmcnt(0)
    v_mfma_f32_16x16x32_bf16 v[72:75], v[48:51], v[224:227], v[72:75]
    ds_read_b128 v[32:35], v26 offset:34816
    s_mov_b32 s43, 0
    buffer_store_dwordx4 v[96:99], v25, s[32:35], s43 offen sc1
    v_add_f32_dpp v100, v66, v100 quad_perm:[0,1,2,3] row_mask:0xf bank_mask:0x3
    v_mfma_f32_16x16x32_bf16 v[76:79], v[48:51], v[228:231], v[76:79]
    ds_read_b128 v[36:39], v26 offset:43008
    v_add_f32_dpp v102, v66, v102 row_ror:8 row_mask:0xf bank_mask:0x3
    v_mfma_f32_16x16x32_bf16 v[72:75], v[52:55], v[232:235], v[72:75]
    ds_read_b128 v[40:43], v26 offset:51200
    v_add_f32_dpp v101, v70, v101 quad_perm:[0,1,2,3] row_mask:0xf bank_mask:0x3
    v_mfma_f32_16x16x32_bf16 v[76:79], v[52:55], v[236:239], v[76:79]
    ds_read_b128 v[44:47], v26 offset:59392
    v_add_f32_dpp v103, v70, v103 row_ror:8 row_mask:0xf bank_mask:0x3
    v_mfma_f32_16x16x32_bf16 v[72:75], v[56:59], v[240:243], v[72:75]
    v_add_f32_dpp v100, v67, v100 row_ror:8 row_mask:0xf bank_mask:0xc
    v_add_f32_dpp v102, v67, v102 quad_perm:[0,1,2,3] row_mask:0xf bank_mask:0xc
    v_mfma_f32_16x16x32_bf16 v[76:79], v[56:59], v[244:247], v[76:79]
    v_add_f32_dpp v101, v71, v101 row_ror:8 row_mask:0xf bank_mask:0xc
    v_mfma_f32_16x16x32_bf16 v[72:75], v[60:63], v[248:251], v[72:75]
    v_add_f32_dpp v103, v71, v103 quad_perm:[0,1,2,3] row_mask:0xf bank_mask:0xc
    v_mfma_f32_16x16x32_bf16 v[76:79], v[60:63], v[252:255], v[76:79]
    s_mov_b32 s43, 81920
    buffer_store_dwordx4 v[100:103], v25, s[32:35], s43 offen sc1
    s_waitcnt lgkmcnt(0)
    v_mfma_f32_16x16x32_bf16 v[80:83], v[32:35], v[192:195], v[80:83]
    ds_read_b128 v[48:51], v26 offset:38912
    v_mfma_f32_16x16x32_bf16 v[84:87], v[32:35], v[196:199], v[84:87]
    ds_read_b128 v[52:55], v26 offset:47104
    v_mfma_f32_16x16x32_bf16 v[80:83], v[36:39], v[200:203], v[80:83]
    ds_read_b128 v[56:59], v26 offset:55296
    v_add_f32_dpp v104, v72, v104 quad_perm:[0,1,2,3] row_mask:0xf bank_mask:0x3
    v_mfma_f32_16x16x32_bf16 v[84:87], v[36:39], v[204:207], v[84:87]
    ds_read_b128 v[60:63], v26 offset:63488
    v_add_f32_dpp v106, v72, v106 row_ror:8 row_mask:0xf bank_mask:0x3
    v_mfma_f32_16x16x32_bf16 v[80:83], v[40:43], v[208:211], v[80:83]
    v_add_f32_dpp v105, v76, v105 quad_perm:[0,1,2,3] row_mask:0xf bank_mask:0x3
    v_add_f32_dpp v107, v76, v107 row_ror:8 row_mask:0xf bank_mask:0x3
    v_mfma_f32_16x16x32_bf16 v[84:87], v[40:43], v[212:215], v[84:87]
    v_add_f32_dpp v104, v73, v104 row_ror:8 row_mask:0xf bank_mask:0xc
    v_mfma_f32_16x16x32_bf16 v[80:83], v[44:47], v[216:219], v[80:83]
    v_add_f32_dpp v106, v73, v106 quad_perm:[0,1,2,3] row_mask:0xf bank_mask:0xc
    v_add_f32_dpp v105, v77, v105 row_ror:8 row_mask:0xf bank_mask:0xc
    v_mfma_f32_16x16x32_bf16 v[84:87], v[44:47], v[220:223], v[84:87]
    v_add_f32_dpp v107, v77, v107 quad_perm:[0,1,2,3] row_mask:0xf bank_mask:0xc
    s_waitcnt lgkmcnt(0)
    v_mfma_f32_16x16x32_bf16 v[80:83], v[48:51], v[224:227], v[80:83]
    ds_read_b128 v[32:35], v26 offset:35840
    s_mov_b32 s43, 5120
    buffer_store_dwordx4 v[104:107], v25, s[32:35], s43 offen sc1
    v_add_f32_dpp v108, v74, v108 quad_perm:[0,1,2,3] row_mask:0xf bank_mask:0x3
    v_mfma_f32_16x16x32_bf16 v[84:87], v[48:51], v[228:231], v[84:87]
    ds_read_b128 v[36:39], v26 offset:44032
    v_add_f32_dpp v110, v74, v110 row_ror:8 row_mask:0xf bank_mask:0x3
    v_mfma_f32_16x16x32_bf16 v[80:83], v[52:55], v[232:235], v[80:83]
    ds_read_b128 v[40:43], v26 offset:52224
    v_add_f32_dpp v109, v78, v109 quad_perm:[0,1,2,3] row_mask:0xf bank_mask:0x3
    v_mfma_f32_16x16x32_bf16 v[84:87], v[52:55], v[236:239], v[84:87]
    ds_read_b128 v[44:47], v26 offset:60416
    v_add_f32_dpp v111, v78, v111 row_ror:8 row_mask:0xf bank_mask:0x3
    v_mfma_f32_16x16x32_bf16 v[80:83], v[56:59], v[240:243], v[80:83]
    v_add_f32_dpp v108, v75, v108 row_ror:8 row_mask:0xf bank_mask:0xc
    v_add_f32_dpp v110, v75, v110 quad_perm:[0,1,2,3] row_mask:0xf bank_mask:0xc
    v_mfma_f32_16x16x32_bf16 v[84:87], v[56:59], v[244:247], v[84:87]
    v_add_f32_dpp v109, v79, v109 row_ror:8 row_mask:0xf bank_mask:0xc
    v_mfma_f32_16x16x32_bf16 v[80:83], v[60:63], v[248:251], v[80:83]
    v_add_f32_dpp v111, v79, v111 quad_perm:[0,1,2,3] row_mask:0xf bank_mask:0xc
    v_mfma_f32_16x16x32_bf16 v[84:87], v[60:63], v[252:255], v[84:87]
    s_mov_b32 s43, 87040
    buffer_store_dwordx4 v[108:111], v25, s[32:35], s43 offen sc1
    s_waitcnt lgkmcnt(0)
    v_mfma_f32_16x16x32_bf16 v[88:91], v[32:35], v[192:195], v[88:91]
    ds_read_b128 v[48:51], v26 offset:39936
    v_mfma_f32_16x16x32_bf16 v[92:95], v[32:35], v[196:199], v[92:95]
    ds_read_b128 v[52:55], v26 offset:48128
    v_mfma_f32_16x16x32_bf16 v[88:91], v[36:39], v[200:203], v[88:91]
    ds_read_b128 v[56:59], v26 offset:56320
    v_add_f32_dpp v112, v80, v112 quad_perm:[0,1,2,3] row_mask:0xf bank_mask:0x3
    v_mfma_f32_16x16x32_bf16 v[92:95], v[36:39], v[204:207], v[92:95]
    ds_read_b128 v[60:63], v26 offset:64512
    v_add_f32_dpp v114, v80, v114 row_ror:8 row_mask:0xf bank_mask:0x3
    v_mfma_f32_16x16x32_bf16 v[88:91], v[40:43], v[208:211], v[88:91]
    v_add_f32_dpp v113, v84, v113 quad_perm:[0,1,2,3] row_mask:0xf bank_mask:0x3
    v_add_f32_dpp v115, v84, v115 row_ror:8 row_mask:0xf bank_mask:0x3
    v_mfma_f32_16x16x32_bf16 v[92:95], v[40:43], v[212:215], v[92:95]
    v_add_f32_dpp v112, v81, v112 row_ror:8 row_mask:0xf bank_mask:0xc
    v_mfma_f32_16x16x32_bf16 v[88:91], v[44:47], v[216:219], v[88:91]
    v_add_f32_dpp v114, v81, v114 quad_perm:[0,1,2,3] row_mask:0xf bank_mask:0xc
    v_add_f32_dpp v113, v85, v113 row_ror:8 row_mask:0xf bank_mask:0xc
    v_mfma_f32_16x16x32_bf16 v[92:95], v[44:47], v[220:223], v[92:95]
    v_add_f32_dpp v115, v85, v115 quad_perm:[0,1,2,3] row_mask:0xf bank_mask:0xc
    s_waitcnt lgkmcnt(0)
    v_mfma_f32_16x16x32_bf16 v[88:91], v[48:51], v[224:227], v[88:91]
    s_mov_b32 s43, 10240
    buffer_store_dwordx4 v[112:115], v25, s[32:35], s43 offen sc1
    v_add_f32_dpp v116, v82, v116 quad_perm:[0,1,2,3] row_mask:0xf bank_mask:0x3
    v_mfma_f32_16x16x32_bf16 v[92:95], v[48:51], v[228:231], v[92:95]
    v_add_f32_dpp v118, v82, v118 row_ror:8 row_mask:0xf bank_mask:0x3
    v_mfma_f32_16x16x32_bf16 v[88:91], v[52:55], v[232:235], v[88:91]
    v_add_f32_dpp v117, v86, v117 quad_perm:[0,1,2,3] row_mask:0xf bank_mask:0x3
    v_mfma_f32_16x16x32_bf16 v[92:95], v[52:55], v[236:239], v[92:95]
    v_add_f32_dpp v119, v86, v119 row_ror:8 row_mask:0xf bank_mask:0x3
    v_mfma_f32_16x16x32_bf16 v[88:91], v[56:59], v[240:243], v[88:91]
    v_add_f32_dpp v116, v83, v116 row_ror:8 row_mask:0xf bank_mask:0xc
    v_add_f32_dpp v118, v83, v118 quad_perm:[0,1,2,3] row_mask:0xf bank_mask:0xc
    v_mfma_f32_16x16x32_bf16 v[92:95], v[56:59], v[244:247], v[92:95]
    v_add_f32_dpp v117, v87, v117 row_ror:8 row_mask:0xf bank_mask:0xc
    v_mfma_f32_16x16x32_bf16 v[88:91], v[60:63], v[248:251], v[88:91]
    v_add_f32_dpp v119, v87, v119 quad_perm:[0,1,2,3] row_mask:0xf bank_mask:0xc
    v_mfma_f32_16x16x32_bf16 v[92:95], v[60:63], v[252:255], v[92:95]
    s_mov_b32 s43, 92160
    buffer_store_dwordx4 v[116:119], v25, s[32:35], s43 offen sc1
    s_nop 3
    v_add_f32_dpp v120, v88, v120 quad_perm:[0,1,2,3] row_mask:0xf bank_mask:0x3
    v_add_f32_dpp v122, v88, v122 row_ror:8 row_mask:0xf bank_mask:0x3
    v_add_f32_dpp v121, v92, v121 quad_perm:[0,1,2,3] row_mask:0xf bank_mask:0x3
    v_add_f32_dpp v123, v92, v123 row_ror:8 row_mask:0xf bank_mask:0x3
    v_add_f32_dpp v120, v89, v120 row_ror:8 row_mask:0xf bank_mask:0xc
    v_add_f32_dpp v122, v89, v122 quad_perm:[0,1,2,3] row_mask:0xf bank_mask:0xc
    v_add_f32_dpp v121, v93, v121 row_ror:8 row_mask:0xf bank_mask:0xc
    v_add_f32_dpp v123, v93, v123 quad_perm:[0,1,2,3] row_mask:0xf bank_mask:0xc
    s_mov_b32 s43, 15360
    buffer_store_dwordx4 v[120:123], v25, s[32:35], s43 offen sc1
    v_add_f32_dpp v124, v90, v124 quad_perm:[0,1,2,3] row_mask:0xf bank_mask:0x3
    v_add_f32_dpp v126, v90, v126 row_ror:8 row_mask:0xf bank_mask:0x3
    v_add_f32_dpp v125, v94, v125 quad_perm:[0,1,2,3] row_mask:0xf bank_mask:0x3
    v_add_f32_dpp v127, v94, v127 row_ror:8 row_mask:0xf bank_mask:0x3
    v_add_f32_dpp v124, v91, v124 row_ror:8 row_mask:0xf bank_mask:0xc
    v_add_f32_dpp v126, v91, v126 quad_perm:[0,1,2,3] row_mask:0xf bank_mask:0xc
    v_add_f32_dpp v125, v95, v125 row_ror:8 row_mask:0xf bank_mask:0xc
    v_add_f32_dpp v127, v95, v127 quad_perm:[0,1,2,3] row_mask:0xf bank_mask:0xc
    s_mov_b32 s43, 97280
    buffer_store_dwordx4 v[124:127], v25, s[32:35], s43 offen sc1
    s_endpgm
.p2align 12
L_conv:
    s_mul_i32 s36, s44, 10
    s_add_u32 s36, s36, s45
    s_sub_u32 s36, s36, 21
    s_lshr_b32 s37, s36, 3
    s_and_b32 s38, s36, 7
    s_movk_i32 s46, 1280
    s_lshl_b32 s43, s37, 9
    v_lshl_add_u32 v6, v2, 5, s43
    s_lshl_b32 s43, s38, 8
    s_lshl_b32 s47, s3, 5
    s_add_u32 s40, s43, s47
    v_lshrrev_b32 v20, 3, v1
    v_and_b32 v4, 7, v1
    v_add_u32 v7, s40, v20
    v_mul_lo_u32 v7, v7, s46
    s_lshl_b32 s43, s37, 7
    v_lshl_add_u32 v8, v4, 4, s43
    v_add_u32 v7, v7, v8
    s_cmp_eq_u32 s40, 0
    s_cselect_b32 s43, 64, 40
    v_cmp_gt_u32 vcc, s43, v1
    v_subrev_u32 v8, 10240, v7
    v_mov_b32 v9, 0x7fff0000
    v_cndmask_b32 v8, v8, v9, vcc
    s_mul_i32 s39, s3, 10368
    s_add_u32 s39, s39, 66048
    s_mul_i32 s100, s3, 4160
    s_add_u32 s100, s100, 32768
    v_mov_b32 v16, 0
    v_mov_b32 v17, 0
    v_mov_b32 v18, 0
    v_mov_b32 v19, 0
    v_mov_b32 v14, s100
    ds_write_b128 v14, v[16:19]
    ds_write_b128 v14, v[16:19] offset:16
    s_waitcnt lgkmcnt(0)
    s_lshl_b32 s43, s37, 8
    s_load_dword s42, s[82:83], s43
    s_mov_b32 s16, s50
    s_and_b32 s17, s51, 0xffff
    s_mov_b32 s18, 2621440
    s_mov_b32 s19, 0x00020000
    s_mov_b32 s20, s52
    s_and_b32 s21, s53, 0xffff
    s_mov_b32 s22, 2621440
    s_mov_b32 s23, 0x00020000
    s_mov_b32 m0, s39
    s_nop 0
    buffer_load_dwordx4 v8, s[16:19], 0 offen  lds
    s_mov_b32 s47, 0
    s_add_u32 m0, s39, 1152
    s_nop 0
    buffer_load_dwordx4 v7, s[16:19], s47 offen  lds
    s_add_u32 m0, s39, 5760
    s_nop 0
    buffer_load_dwordx4 v7, s[20:23], s47 offen  lds
    s_mov_b32 s47, 10240
    s_add_u32 m0, s39, 2304
    s_nop 0
    buffer_load_dwordx4 v7, s[16:19], s47 offen  lds
    s_add_u32 m0, s39, 6912
    s_nop 0
    buffer_load_dwordx4 v7, s[20:23], s47 offen  lds
    s_mov_b32 s47, 20480
    s_add_u32 m0, s39, 3456
    s_nop 0
    buffer_load_dwordx4 v7, s[16:19], s47 offen  lds
    s_add_u32 m0, s39, 8064
    s_nop 0
    buffer_load_dwordx4 v7, s[20:23], s47 offen  lds
    s_mov_b32 s47, 30720
    s_add_u32 m0, s39, 4608
    s_nop 0
    buffer_load_dwordx4 v7, s[16:19], s47 offen  lds
    s_add_u32 m0, s39, 9216
    s_nop 0
    buffer_load_dwordx4 v7, s[20:23], s47 offen  lds
    global_load_dwordx4 v[104:107], v6, s[54:55] offset:0
    global_load_dwordx4 v[108:111], v6, s[54:55] offset:16
    s_mov_b32 s4, s82
    s_and_b32 s5, s83, 0xffff
    s_mov_b32 s6, 268435456
    s_mov_b32 s7, 0x00020000
    s_mov_b32 s24, s56
    s_and_b32 s25, s57, 0xffff
    s_mov_b32 s26, 2621440
    s_mov_b32 s27, 0x00020000
    s_lshl_b32 s43, s36, 3
    s_add_u32 s43, s43, s3
    s_lshl_b32 s47, s43, 12
    v_lshl_add_u32 v11, v1, 4, s47
    s_lshl_b32 s43, s43, 1
    v_mov_b32 v12, s43
    s_and_b32 s41, s3, 3
    v_mul_u32_u24 v5, 1152, v3
    v_lshl_add_u32 v5, v2, 3, v5
    s_mul_i32 s43, s3, 9360
    s_add_u32 s43, s43, 66048
    v_add_u32 v10, s43, v5
    v_add_u32 v5, s39, v5
    s_sub_u32 s43, 7, s3
    v_xor_b32 v21, s43, v4
    v_sub_u32 v15, 3, v3
    v_lshl_add_u32 v15, v21, 2, v15
    v_lshlrev_b32 v15, 2, v15
    v_lshl_add_u32 v15, v2, 11, v15
    s_lshl_b32 s43, s3, 1
    s_and_b32 s43, s43, 7
    v_xor_b32 v21, s43, v4
    v_lshlrev_b32 v21, 4, v21
    v_lshl_add_u32 v21, v20, 7, v21
    s_lshl_b32 s43, s3, 12
    v_add_u32 v21, s43, v21
    v_xor_b32 v22, 16, v21
    s_lshl_b32 s43, s37, 18
    s_lshl_b32 s47, s3, 15
    s_add_u32 s43, s43, s47
    s_sub_u32 s47, 7, s38
    s_lshl_b32 s47, s47, 7
    s_add_u32 s43, s43, s47
    s_add_u32 s43, s43, 8388608
    v_lshl_add_u32 v23, v20, 10, s43
    v_lshl_add_u32 v23, v4, 4, v23
    s_lshl_b32 s43, s37, 13
    s_lshl_b32 s47, s3, 10
    s_add_u32 s47, s47, s43
    s_lshl_b32 s43, s38, 7
    s_add_u32 s47, s47, s43
    s_add_u32 s47, s47, 393216
    v_lshl_add_u32 v24, v1, 2, s47
    s_waitcnt lgkmcnt(0)
    s_add_u32 s42, s42, 2654435769
    s_waitcnt vmcnt(0)
    ds_read_b64 v[64:65], v5 offset:640
    ds_read_b64 v[66:67], v5 offset:768
    ds_read_b64 v[68:69], v5 offset:896
    ds_read_b64 v[70:71], v5 offset:1152
    ds_read_b64 v[86:87], v5 offset:5760
    ds_read_b64 v[72:73], v5 offset:1280
    ds_read_b64 v[88:89], v5 offset:5888
    ds_read_b64 v[74:75], v5 offset:1408
    ds_read_b64 v[90:91], v5 offset:6016
    ds_read_b64 v[76:77], v5 offset:1536
    ds_read_b64 v[92:93], v5 offset:6144
    ds_read_b64 v[78:79], v5 offset:1664
    ds_read_b64 v[94:95], v5 offset:6272
    ds_read_b64 v[80:81], v5 offset:1792
    ds_read_b64 v[96:97], v5 offset:6400
    ds_read_b64 v[82:83], v5 offset:1920
    ds_read_b64 v[98:99], v5 offset:6528
    ds_read_b64 v[84:85], v5 offset:2048
    ds_read_b64 v[100:101], v5 offset:6656
    v_lshlrev_b32 v112, 16, v104
    v_and_b32 v116, 0xffff0000, v104
    v_lshlrev_b32 v120, 16, v105
    v_and_b32 v124, 0xffff0000, v105
    v_lshlrev_b32 v113, 16, v106
    v_and_b32 v117, 0xffff0000, v106
    v_lshlrev_b32 v121, 16, v107
    v_and_b32 v125, 0xffff0000, v107
    v_lshlrev_b32 v114, 16, v108
    v_and_b32 v118, 0xffff0000, v108
    v_lshlrev_b32 v122, 16, v109
    v_and_b32 v126, 0xffff0000, v109
    v_lshlrev_b32 v115, 16, v110
    v_and_b32 v119, 0xffff0000, v110
    v_lshlrev_b32 v123, 16, v111
    v_and_b32 v127, 0xffff0000, v111
    s_waitcnt lgkmcnt(15)
    v_lshlrev_b32 v128, 16, v64
    v_and_b32 v129, 0xffff0000, v64
    v_lshlrev_b32 v130, 16, v65
    v_and_b32 v131, 0xffff0000, v65
    v_lshlrev_b32 v132, 16, v66
    v_and_b32 v133, 0xffff0000, v66
    v_lshlrev_b32 v134, 16, v67
    v_and_b32 v135, 0xffff0000, v67
    v_lshlrev_b32 v136, 16, v68
    v_and_b32 v137, 0xffff0000, v68
    v_lshlrev_b32 v138, 16, v69
    v_and_b32 v139, 0xffff0000, v69
    v_lshlrev_b32 v140, 16, v70
    v_and_b32 v141, 0xffff0000, v70
    v_lshlrev_b32 v142, 16, v71
    v_and_b32 v143, 0xffff0000, v71
    v_pk_mul_f32 v[144:145], v[112:113], v[140:141]
    v_pk_mul_f32 v[146:147], v[114:115], v[142:143]
    v_pk_fma_f32 v[144:145], v[116:117], v[136:137], v[144:145]
    v_pk_fma_f32 v[146:147], v[118:119], v[138:139], v[146:147]
    v_pk_fma_f32 v[144:145], v[120:121], v[132:133], v[144:145]
    v_pk_fma_f32 v[146:147], v[122:123], v[134:135], v[146:147]
    v_pk_fma_f32 v[144:145], v[124:125], v[128:129], v[144:145]
    v_pk_fma_f32 v[146:147], v[126:127], v[130:131], v[146:147]
    s_waitcnt lgkmcnt(14)
    v_lshlrev_b32 v160, 16, v86
    v_and_b32 v161, 0xffff0000, v86
    v_lshlrev_b32 v162, 16, v87
    v_and_b32 v163, 0xffff0000, v87
    v_pk_mul_f32 v[144:145], v[144:145], v[160:161]
    v_pk_mul_f32 v[146:147], v[146:147], v[162:163]
    s_waitcnt lgkmcnt(13)
    v_lshlrev_b32 v128, 16, v72
    v_and_b32 v129, 0xffff0000, v72
    v_lshlrev_b32 v130, 16, v73
    v_and_b32 v131, 0xffff0000, v73
    v_pk_mul_f32 v[148:149], v[112:113], v[128:129]
    v_pk_mul_f32 v[150:151], v[114:115], v[130:131]
    v_pk_fma_f32 v[148:149], v[116:117], v[140:141], v[148:149]
    v_pk_fma_f32 v[150:151], v[118:119], v[142:143], v[150:151]
    v_pk_fma_f32 v[148:149], v[120:121], v[136:137], v[148:149]
    v_pk_fma_f32 v[150:151], v[122:123], v[138:139], v[150:151]
    v_pk_fma_f32 v[148:149], v[124:125], v[132:133], v[148:149]
    v_pk_fma_f32 v[150:151], v[126:127], v[134:135], v[150:151]
    s_waitcnt lgkmcnt(12)
    v_lshlrev_b32 v160, 16, v88
    v_and_b32 v161, 0xffff0000, v88
    v_lshlrev_b32 v162, 16, v89
    v_and_b32 v163, 0xffff0000, v89
    v_pk_mul_f32 v[148:149], v[148:149], v[160:161]
    v_pk_mul_f32 v[150:151], v[150:151], v[162:163]
    s_waitcnt lgkmcnt(11)
    v_lshlrev_b32 v132, 16, v74
    v_and_b32 v133, 0xffff0000, v74
    v_lshlrev_b32 v134, 16, v75
    v_and_b32 v135, 0xffff0000, v75
    v_pk_mul_f32 v[152:153], v[112:113], v[132:133]
    v_pk_mul_f32 v[154:155], v[114:115], v[134:135]
    v_pk_fma_f32 v[152:153], v[116:117], v[128:129], v[152:153]
    v_pk_fma_f32 v[154:155], v[118:119], v[130:131], v[154:155]
    v_pk_fma_f32 v[152:153], v[120:121], v[140:141], v[152:153]
    v_pk_fma_f32 v[154:155], v[122:123], v[142:143], v[154:155]
    v_pk_fma_f32 v[152:153], v[124:125], v[136:137], v[152:153]
    v_pk_fma_f32 v[154:155], v[126:127], v[138:139], v[154:155]
    s_waitcnt lgkmcnt(10)
    v_lshlrev_b32 v160, 16, v90
    v_and_b32 v161, 0xffff0000, v90
    v_lshlrev_b32 v162, 16, v91
    v_and_b32 v163, 0xffff0000, v91
    v_pk_mul_f32 v[152:153], v[152:153], v[160:161]
    v_pk_mul_f32 v[154:155], v[154:155], v[162:163]
    s_waitcnt lgkmcnt(9)
    v_lshlrev_b32 v136, 16, v76
    v_and_b32 v137, 0xffff0000, v76
    v_lshlrev_b32 v138, 16, v77
    v_and_b32 v139, 0xffff0000, v77
    v_pk_mul_f32 v[156:157], v[112:113], v[136:137]
    v_pk_mul_f32 v[158:159], v[114:115], v[138:139]
    v_pk_fma_f32 v[156:157], v[116:117], v[132:133], v[156:157]
    v_pk_fma_f32 v[158:159], v[118:119], v[134:135], v[158:159]
    v_pk_fma_f32 v[156:157], v[120:121], v[128:129], v[156:157]
    v_pk_fma_f32 v[158:159], v[122:123], v[130:131], v[158:159]
    v_pk_fma_f32 v[156:157], v[124:125], v[140:141], v[156:157]
    v_pk_fma_f32 v[158:159], v[126:127], v[142:143], v[158:159]
    s_waitcnt lgkmcnt(8)
    v_lshlrev_b32 v160, 16, v92
    v_and_b32 v161, 0xffff0000, v92
    v_lshlrev_b32 v162, 16, v93
    v_and_b32 v163, 0xffff0000, v93
    v_pk_mul_f32 v[156:157], v[156:157], v[160:161]
    v_pk_mul_f32 v[158:159], v[158:159], v[162:163]
    s_waitcnt lgkmcnt(7)
    v_lshlrev_b32 v140, 16, v78
    v_and_b32 v141, 0xffff0000, v78
    v_lshlrev_b32 v142, 16, v79
    v_and_b32 v143, 0xffff0000, v79
    v_pk_mul_f32 v[168:169], v[112:113], v[140:141]
    v_pk_mul_f32 v[170:171], v[114:115], v[142:143]
    v_pk_fma_f32 v[168:169], v[116:117], v[136:137], v[168:169]
    v_pk_fma_f32 v[170:171], v[118:119], v[138:139], v[170:171]
    v_pk_fma_f32 v[168:169], v[120:121], v[132:133], v[168:169]
    v_pk_fma_f32 v[170:171], v[122:123], v[134:135], v[170:171]
    v_pk_fma_f32 v[168:169], v[124:125], v[128:129], v[168:169]
    v_pk_fma_f32 v[170:171], v[126:127], v[130:131], v[170:171]
    s_waitcnt lgkmcnt(6)
    v_lshlrev_b32 v160, 16, v94
    v_and_b32 v161, 0xffff0000, v94
    v_lshlrev_b32 v162, 16, v95
    v_and_b32 v163, 0xffff0000, v95
    v_pk_mul_f32 v[168:169], v[168:169], v[160:161]
    v_pk_mul_f32 v[170:171], v[170:171], v[162:163]
    v_cvt_pk_bf16_f32 v176, v168, v144
    v_cvt_pk_bf16_f32 v177, v169, v145
    v_cvt_pk_bf16_f32 v178, v170, v146
    v_cvt_pk_bf16_f32 v179, v171, v147
    s_waitcnt lgkmcnt(5)
    v_lshlrev_b32 v128, 16, v80
    v_and_b32 v129, 0xffff0000, v80
    v_lshlrev_b32 v130, 16, v81
    v_and_b32 v131, 0xffff0000, v81
    v_pk_mul_f32 v[168:169], v[112:113], v[128:129]
    v_pk_mul_f32 v[170:171], v[114:115], v[130:131]
    v_pk_fma_f32 v[168:169], v[116:117], v[140:141], v[168:169]
    v_pk_fma_f32 v[170:171], v[118:119], v[142:143], v[170:171]
    v_pk_fma_f32 v[168:169], v[120:121], v[136:137], v[168:169]
    v_pk_fma_f32 v[170:171], v[122:123], v[138:139], v[170:171]
    v_pk_fma_f32 v[168:169], v[124:125], v[132:133], v[168:169]
    v_pk_fma_f32 v[170:171], v[126:127], v[134:135], v[170:171]
    s_waitcnt lgkmcnt(4)
    v_lshlrev_b32 v160, 16, v96
    v_and_b32 v161, 0xffff0000, v96
    v_lshlrev_b32 v162, 16, v97
    v_and_b32 v163, 0xffff0000, v97
    v_pk_mul_f32 v[168:169], v[168:169], v[160:161]
    v_pk_mul_f32 v[170:171], v[170:171], v[162:163]
    v_cvt_pk_bf16_f32 v180, v168, v148
    v_cvt_pk_bf16_f32 v181, v169, v149
    v_cvt_pk_bf16_f32 v182, v170, v150
    v_cvt_pk_bf16_f32 v183, v171, v151
    s_waitcnt lgkmcnt(3)
    v_lshlrev_b32 v132, 16, v82
    v_and_b32 v133, 0xffff0000, v82
    v_lshlrev_b32 v134, 16, v83
    v_and_b32 v135, 0xffff0000, v83
    v_pk_mul_f32 v[168:169], v[112:113], v[132:133]
    v_pk_mul_f32 v[170:171], v[114:115], v[134:135]
    v_pk_fma_f32 v[168:169], v[116:117], v[128:129], v[168:169]
    v_pk_fma_f32 v[170:171], v[118:119], v[130:131], v[170:171]
    v_pk_fma_f32 v[168:169], v[120:121], v[140:141], v[168:169]
    v_pk_fma_f32 v[170:171], v[122:123], v[142:143], v[170:171]
    v_pk_fma_f32 v[168:169], v[124:125], v[136:137], v[168:169]
    v_pk_fma_f32 v[170:171], v[126:127], v[138:139], v[170:171]
    s_waitcnt lgkmcnt(2)
    v_lshlrev_b32 v160, 16, v98
    v_and_b32 v161, 0xffff0000, v98
    v_lshlrev_b32 v162, 16, v99
    v_and_b32 v163, 0xffff0000, v99
    v_pk_mul_f32 v[168:169], v[168:169], v[160:161]
    v_pk_mul_f32 v[170:171], v[170:171], v[162:163]
    v_cvt_pk_bf16_f32 v184, v168, v152
    v_cvt_pk_bf16_f32 v185, v169, v153
    v_cvt_pk_bf16_f32 v186, v170, v154
    v_cvt_pk_bf16_f32 v187, v171, v155
    s_waitcnt lgkmcnt(1)
    v_lshlrev_b32 v136, 16, v84
    v_and_b32 v137, 0xffff0000, v84
    v_lshlrev_b32 v138, 16, v85
    v_and_b32 v139, 0xffff0000, v85
    v_pk_mul_f32 v[168:169], v[112:113], v[136:137]
    v_pk_mul_f32 v[170:171], v[114:115], v[138:139]
    v_pk_fma_f32 v[168:169], v[116:117], v[132:133], v[168:169]
    v_pk_fma_f32 v[170:171], v[118:119], v[134:135], v[170:171]
    v_pk_fma_f32 v[168:169], v[120:121], v[128:129], v[168:169]
    v_pk_fma_f32 v[170:171], v[122:123], v[130:131], v[170:171]
    v_pk_fma_f32 v[168:169], v[124:125], v[140:141], v[168:169]
    v_pk_fma_f32 v[170:171], v[126:127], v[142:143], v[170:171]
    s_waitcnt lgkmcnt(0)
    v_lshlrev_b32 v160, 16, v100
    v_and_b32 v161, 0xffff0000, v100
    v_lshlrev_b32 v162, 16, v101
    v_and_b32 v163, 0xffff0000, v101
    v_pk_mul_f32 v[168:169], v[168:169], v[160:161]
    v_pk_mul_f32 v[170:171], v[170:171], v[162:163]
    v_cvt_pk_bf16_f32 v188, v168, v156
    v_cvt_pk_bf16_f32 v189, v169, v157
    v_cvt_pk_bf16_f32 v190, v170, v158
    v_cvt_pk_bf16_f32 v191, v171, v159
    s_cmp_ge_u32 s3, 4
    s_cbranch_scc1 Lct_7
    s_sub_u32 s43, s45, 21
    s_lshl_b32 s43, s43, 2
    s_add_u32 s43, s43, s3
    s_cmp_ge_u32 s43, 36
    s_cbranch_scc1 Lct_7
    s_mul_i32 s47, s43, 3641
    s_lshr_b32 s47, s47, 16
    s_mul_i32 s0, s47, 18
    s_sub_u32 s43, s43, s0
    s_and_b32 s0, s44, 1
    s_mul_i32 s0, s0, 5
    s_add_u32 s0, s0, s43
    s_cmp_lt_u32 s43, 13
    s_cselect_b32 s1, 8, 13
    s_cselect_b64 s[28:29], s[66:67], s[68:69]
    s_sub_u32 s0, s0, s1
    s_lshr_b32 s1, s44, 1
    s_lshl_b32 s1, s1, 3
    s_add_u32 s1, s1, s43
    s_cmp_lt_u32 s43, 8
    s_cselect_b32 s43, s1, s0
    s_cselect_b64 s[28:29], s[60:61], s[28:29]
    s_mov_b32 s30, 819200
    s_cselect_b32 s30, 2621440, s30
    s_mov_b32 s31, 0x00020000
    s_mul_i32 s43, s43, 81920
    s_lshl_b32 s47, s47, 7
    s_add_u32 s43, s43, s47
    v_mul_u32_u24 v43, 1280, v1
    v_add_u32 v43, s43, v43
    buffer_load_dword v44, v43, s[28:31], 0 offen offset:768
Lct_7:
    s_cmp_ge_u32 s3, 4
    s_cbranch_scc1 Lct_8
    s_sub_u32 s43, s45, 21
    s_lshl_b32 s43, s43, 2
    s_add_u32 s43, s43, s3
    s_cmp_ge_u32 s43, 36
    s_cbranch_scc1 Lct_8
    s_mul_i32 s47, s43, 3641
    s_lshr_b32 s47, s47, 16
    s_mul_i32 s0, s47, 18
    s_sub_u32 s43, s43, s0
    s_and_b32 s0, s44, 1
    s_mul_i32 s0, s0, 5
    s_add_u32 s0, s0, s43
    s_cmp_lt_u32 s43, 13
    s_cselect_b32 s1, 8, 13
    s_cselect_b64 s[28:29], s[66:67], s[68:69]
    s_sub_u32 s0, s0, s1
    s_lshr_b32 s1, s44, 1
    s_lshl_b32 s1, s1, 3
    s_add_u32 s1, s1, s43
    s_cmp_lt_u32 s43, 8
    s_cselect_b32 s43, s1, s0
    s_cselect_b64 s[28:29], s[60:61], s[28:29]
    s_mov_b32 s30, 819200
    s_cselect_b32 s30, 2621440, s30
    s_mov_b32 s31, 0x00020000
    s_mul_i32 s43, s43, 81920
    s_lshl_b32 s47, s47, 7
    s_add_u32 s43, s43, s47
    v_mul_u32_u24 v43, 1280, v1
    v_add_u32 v43, s43, v43
    buffer_load_dword v44, v43, s[28:31], 0 offen offset:1024
Lct_8:
    ds_write_b32 v15, v176 offset:0
    ds_write_b32 v15, v177 offset:512
    ds_write_b32 v15, v178 offset:1024
    ds_write_b32 v15, v179 offset:1536
    ds_write_b32 v15, v180 offset:128
    ds_write_b32 v15, v181 offset:640
    ds_write_b32 v15, v182 offset:1152
    ds_write_b32 v15, v183 offset:1664
    ds_write_b32 v15, v184 offset:256
    ds_write_b32 v15, v185 offset:768
    ds_write_b32 v15, v186 offset:1280
    ds_write_b32 v15, v187 offset:1792
    ds_write_b32 v15, v188 offset:384
    ds_write_b32 v15, v189 offset:896
    ds_write_b32 v15, v190 offset:1408
    ds_write_b32 v15, v191 offset:1920
    s_mov_b64 exec, 0
    s_cmp_eq_u32 s3, 0
    s_cbranch_scc1 Lhk_m_0
    s_cmp_eq_u32 s3, 1
    s_cbranch_scc1 Lhk_m_1
    s_cmp_eq_u32 s3, 2
    s_cbranch_scc1 Lhk_m_2
    s_cmp_eq_u32 s3, 3
    s_cbranch_scc1 Lhk_m_3
Lhr_m:
    s_mov_b64 exec, -1
    s_waitcnt lgkmcnt(0)
    s_barrier
    ds_read_b128 v[64:67], v21 offset:0
    ds_read_b128 v[68:71], v21 offset:1024
    ds_read_b128 v[72:75], v22 offset:2048
    ds_read_b128 v[76:79], v22 offset:3072
    s_waitcnt lgkmcnt(3)
    s_mov_b32 s43, 0
    buffer_store_dwordx4 v[64:67], v23, s[4:7], s43 offen sc1
    s_waitcnt lgkmcnt(2)
    s_mov_b32 s43, 8192
    buffer_store_dwordx4 v[68:71], v23, s[4:7], s43 offen sc1
    s_waitcnt lgkmcnt(1)
    s_mov_b32 s43, 16384
    buffer_store_dwordx4 v[72:75], v23, s[4:7], s43 offen sc1
    s_waitcnt lgkmcnt(0)
    s_mov_b32 s43, 24576
    buffer_store_dwordx4 v[76:79], v23, s[4:7], s43 offen sc1
    ds_write_b64 v10, v[16:17] offset:1024
    ds_write_b64 v10, v[16:17] offset:5752
    v_mov_b32 v4, s42
    s_waitcnt vmcnt(0)
    s_mov_b64 exec, 1
    buffer_store_dword v4, v24, s[4:7], 0 offen sc1
    s_mov_b64 exec, -1
    s_cmp_ge_u32 s3, 4
    s_cbranch_scc1 L_cl
    s_mul_i32 s100, s3, 8320
    s_add_u32 s100, s100, 32768
    s_mul_i32 s101, s3, 18720
    s_add_u32 s101, s101, 66048
    v_lshrrev_b32 v7, 2, v2
    v_and_b32 v8, 3, v2
    v_add_u32 v7, v7, v8
    v_lshlrev_b32 v7, 3, v7
    v_lshl_add_u32 v7, v3, 6, v7
    v_add_u32 v7, s100, v7
    v_and_b32 v13, 1, v1
    s_lshl_b32 s43, s36, 2
    s_add_u32 s43, s43, s3
    s_lshl_b32 s47, s43, 13
    v_lshl_add_u32 v11, v1, 4, s47
    s_lshl_b32 s43, s43, 2
    v_mov_b32 v12, s43
    s_movk_i32 s40, 4096
    s_add_u32 m0, s100, 32
    s_nop 0
    buffer_load_dwordx4 v11, s[24:27], 0 offen offset:0 nt lds
    buffer_load_dwordx4 v11, s[24:27], 0 offen offset:1024 nt lds
    buffer_load_dwordx4 v11, s[24:27], 0 offen offset:2048 nt lds
    buffer_load_dwordx4 v11, s[24:27], 0 offen offset:3072 nt lds
    s_add_u32 m0, s100, 4192
    s_nop 0
    buffer_load_dwordx4 v11, s[24:27], s40 offen offset:0 nt lds
    buffer_load_dwordx4 v11, s[24:27], s40 offen offset:1024 nt lds
    buffer_load_dwordx4 v11, s[24:27], s40 offen offset:2048 nt lds
    buffer_load_dwordx4 v11, s[24:27], s40 offen offset:3072 nt lds
    global_load_dword v15, v12, s[58:59]
    v_mul_u32_u24 v14, 4160, v13
    v_add_u32 v14, s100, v14
    s_waitcnt vmcnt(0)
    ds_read_u16 v4, v14 offset:32
    v_lshlrev_b32 v5, 16, v15
    v_and_b32 v15, 0xffff0000, v15
    v_cmp_eq_u32 vcc, 1, v13
    s_nop 1
    v_cndmask_b32 v5, v5, v15, vcc
    s_waitcnt lgkmcnt(0)
    v_lshlrev_b32 v4, 16, v4
    v_add_f32 v4, v4, v5
    v_cvt_pk_bf16_f32 v4, v4, v4
    ds_write_b16 v14, v4 offset:32
    v_lshlrev_b32 v8, 3, v2
    v_sub_u32 v8, 120, v8
    v_lshl_add_u32 v8, v3, 4, v8
    v_add_u32 v8, s101, v8
    v_sub_u32 v9, 1, v13
    v_mul_u32_u24 v9, 4728, v9
    v_add_u32 v8, v8, v9
    s_mul_i32 s43, s3, 16448
    v_lshl_add_u32 v9, v1, 4, s43
    v_mul_u32_u24 v6, 8224, v13
    v_add_u32 v6, s43, v6
    s_lshl_b32 s43, s36, 2
    s_add_u32 s43, s43, s3
    s_lshl_b32 s43, s43, 13
    s_add_u32 s43, s43, 8388608
    v_lshl_add_u32 v11, v1, 4, s43
    s_movk_i32 s40, 4096
    v_mov_b64 v[68:69], 0
    v_mov_b64 v[74:75], 0
    v_mov_b64 v[80:81], 0
    v_mov_b64 v[86:87], 0
    v_mov_b64 v[92:93], 0
    v_mov_b64 v[98:99], 0
    v_mov_b64 v[104:105], 0
    v_mov_b64 v[110:111], 0
    s_waitcnt lgkmcnt(0)
    s_barrier
    s_add_u32 m0, s101, 0
    s_nop 0
    buffer_load_dwordx4 v11, s[4:7], 0 offen offset:0 sc1 lds
    s_add_u32 m0, s101, 4728
    s_nop 0
    buffer_load_dwordx4 v11, s[4:7], 0 offen offset:0 sc1 lds
    s_add_u32 m0, s101, 128
    s_nop 0
    buffer_load_dwordx4 v11, s[4:7], 0 offen offset:1024 sc1 lds
    s_add_u32 m0, s101, 4856
    s_nop 0
    buffer_load_dwordx4 v11, s[4:7], 0 offen offset:1024 sc1 lds
    s_add_u32 m0, s101, 256
    s_nop 0
    buffer_load_dwordx4 v11, s[4:7], 0 offen offset:2048 sc1 lds
    s_add_u32 m0, s101, 4984
    s_nop 0
    buffer_load_dwordx4 v11, s[4:7], 0 offen offset:2048 sc1 lds
    s_add_u32 m0, s101, 384
    s_nop 0
    buffer_load_dwordx4 v11, s[4:7], 0 offen offset:3072 sc1 lds
    s_add_u32 m0, s101, 5112
    s_nop 0
    buffer_load_dwordx4 v11, s[4:7], 0 offen offset:3072 sc1 lds
    ds_read_b64_tr_b16 v[128:129], v7 offset:8
    ds_read_b64_tr_b16 v[130:131], v7 offset:40
    ds_read_b64_tr_b16 v[132:133], v7 offset:264
    ds_read_b64_tr_b16 v[134:135], v7 offset:296
    ds_read_b64_tr_b16 v[136:137], v7 offset:520
    ds_read_b64_tr_b16 v[138:139], v7 offset:552
    ds_read_b64_tr_b16 v[140:141], v7 offset:776
    ds_read_b64_tr_b16 v[142:143], v7 offset:808
    ds_read_b64_tr_b16 v[144:145], v7 offset:1032
    ds_read_b64_tr_b16 v[146:147], v7 offset:1064
    ds_read_b64_tr_b16 v[148:149], v7 offset:1288
    ds_read_b64_tr_b16 v[150:151], v7 offset:1320
    ds_read_b64_tr_b16 v[152:153], v7 offset:1544
    ds_read_b64_tr_b16 v[154:155], v7 offset:1576
    ds_read_b64_tr_b16 v[156:157], v7 offset:1800
    ds_read_b64_tr_b16 v[158:159], v7 offset:1832
    ds_read_b64_tr_b16 v[160:161], v7 offset:2056
    ds_read_b64_tr_b16 v[162:163], v7 offset:2088
    ds_read_b64_tr_b16 v[164:165], v7 offset:2312
    ds_read_b64_tr_b16 v[166:167], v7 offset:2344
    ds_read_b64_tr_b16 v[168:169], v7 offset:2568
    ds_read_b64_tr_b16 v[170:171], v7 offset:2600
    ds_read_b64_tr_b16 v[172:173], v7 offset:2824
    ds_read_b64_tr_b16 v[174:175], v7 offset:2856
    ds_read_b64_tr_b16 v[176:177], v7 offset:3080
    ds_read_b64_tr_b16 v[178:179], v7 offset:3112
    ds_read_b64_tr_b16 v[180:181], v7 offset:3336
    ds_read_b64_tr_b16 v[182:183], v7 offset:3368
    ds_read_b64_tr_b16 v[184:185], v7 offset:3592
    ds_read_b64_tr_b16 v[186:187], v7 offset:3624
    ds_read_b64_tr_b16 v[188:189], v7 offset:3848
    ds_read_b64_tr_b16 v[190:191], v7 offset:3880
    s_add_u32 m0, s101, 9360
    s_nop 0
    buffer_load_dwordx4 v11, s[4:7], s40 offen offset:0 sc1 lds
    s_add_u32 m0, s101, 14088
    s_nop 0
    buffer_load_dwordx4 v11, s[4:7], s40 offen offset:0 sc1 lds
    s_add_u32 m0, s101, 9488
    s_nop 0
    buffer_load_dwordx4 v11, s[4:7], s40 offen offset:1024 sc1 lds
    s_add_u32 m0, s101, 14216
    s_nop 0
    buffer_load_dwordx4 v11, s[4:7], s40 offen offset:1024 sc1 lds
    s_add_u32 m0, s101, 9616
    s_nop 0
    buffer_load_dwordx4 v11, s[4:7], s40 offen offset:2048 sc1 lds
    s_add_u32 m0, s101, 14344
    s_nop 0
    buffer_load_dwordx4 v11, s[4:7], s40 offen offset:2048 sc1 lds
    s_add_u32 m0, s101, 9744
    s_nop 0
    buffer_load_dwordx4 v11, s[4:7], s40 offen offset:3072 sc1 lds
    s_add_u32 m0, s101, 14472
    s_nop 0
    buffer_load_dwordx4 v11, s[4:7], s40 offen offset:3072 sc1 lds
    ds_read_b64_tr_b16 v[192:193], v7 offset:4168
    ds_read_b64_tr_b16 v[194:195], v7 offset:4200
    ds_read_b64_tr_b16 v[196:197], v7 offset:4424
    ds_read_b64_tr_b16 v[198:199], v7 offset:4456
    ds_read_b64_tr_b16 v[200:201], v7 offset:4680
    ds_read_b64_tr_b16 v[202:203], v7 offset:4712
    ds_read_b64_tr_b16 v[204:205], v7 offset:4936
    ds_read_b64_tr_b16 v[206:207], v7 offset:4968
    ds_read_b64_tr_b16 v[208:209], v7 offset:5192
    ds_read_b64_tr_b16 v[210:211], v7 offset:5224
    ds_read_b64_tr_b16 v[212:213], v7 offset:5448
    ds_read_b64_tr_b16 v[214:215], v7 offset:5480
    ds_read_b64_tr_b16 v[216:217], v7 offset:5704
    ds_read_b64_tr_b16 v[218:219], v7 offset:5736
    ds_read_b64_tr_b16 v[220:221], v7 offset:5960
    ds_read_b64_tr_b16 v[222:223], v7 offset:5992
    ds_read_b64_tr_b16 v[224:225], v7 offset:6216
    ds_read_b64_tr_b16 v[226:227], v7 offset:6248
    ds_read_b64_tr_b16 v[228:229], v7 offset:6472
    ds_read_b64_tr_b16 v[230:231], v7 offset:6504
Lhk_m_0:
    s_cbranch_execz Lhr_m
    ds_read_b64_tr_b16 v[232:233], v7 offset:6728
    ds_read_b64_tr_b16 v[234:235], v7 offset:6760
    ds_read_b64_tr_b16 v[236:237], v7 offset:6984
    ds_read_b64_tr_b16 v[238:239], v7 offset:7016
    ds_read_b64_tr_b16 v[240:241], v7 offset:7240
    ds_read_b64_tr_b16 v[242:243], v7 offset:7272
    ds_read_b64_tr_b16 v[244:245], v7 offset:7496
    ds_read_b64_tr_b16 v[246:247], v7 offset:7528
    ds_read_b64_tr_b16 v[248:249], v7 offset:7752
    ds_read_b64_tr_b16 v[250:251], v7 offset:7784
    ds_read_b64_tr_b16 v[252:253], v7 offset:8008
    ds_read_b64_tr_b16 v[254:255], v7 offset:8040
    s_waitcnt vmcnt(8)
    s_waitcnt lgkmcnt(0)
    s_barrier
    ds_read_b128 v[20:23], v8 offset:960
    ds_read_b128 v[24:27], v8 offset:896
    ds_read_b128 v[28:31], v8 offset:832
    ds_read_b128 v[32:35], v8 offset:768
    ds_read_b128 v[36:39], v8 offset:704
    ds_read_b128 v[40:43], v8 offset:640
    s_waitcnt lgkmcnt(5)
    v_mfma_f32_16x16x32_bf16 v[64:67], v[148:151], v[20:23], 0
    ds_read_b128 v[44:47], v8 offset:1728
    v_mfma_f32_16x16x32_bf16 v[76:79], v[156:159], v[20:23], 0
    s_waitcnt lgkmcnt(5)
    v_mfma_f32_16x16x32_bf16 v[64:67], v[144:147], v[24:27], v[64:67]
    ds_read_b128 v[48:51], v8 offset:576
    v_mfma_f32_16x16x32_bf16 v[76:79], v[152:155], v[24:27], v[76:79]
    s_waitcnt lgkmcnt(5)
    v_mfma_f32_16x16x32_bf16 v[64:67], v[140:143], v[28:31], v[64:67]
    ds_read_b128 v[52:55], v8 offset:1664
    v_mfma_f32_16x16x32_bf16 v[76:79], v[148:151], v[28:31], v[76:79]
    s_waitcnt lgkmcnt(5)
    v_mfma_f32_16x16x32_bf16 v[64:67], v[136:139], v[32:35], v[64:67]
    ds_read_b128 v[56:59], v8 offset:512
    v_mfma_f32_16x16x32_bf16 v[76:79], v[144:147], v[32:35], v[76:79]
    s_waitcnt lgkmcnt(5)
    v_mfma_f32_16x16x32_bf16 v[64:67], v[132:135], v[36:39], v[64:67]
    ds_read_b128 v[60:63], v8 offset:2112
    v_mfma_f32_16x16x32_bf16 v[76:79], v[140:143], v[36:39], v[76:79]
    s_waitcnt lgkmcnt(5)
    v_mfma_f32_16x16x32_bf16 v[64:67], v[128:131], v[40:43], v[64:67]
    ds_read_b128 v[20:23], v8 offset:2048
    v_mfma_f32_16x16x32_bf16 v[76:79], v[136:139], v[40:43], v[76:79]
    s_waitcnt lgkmcnt(4)
    v_mfma_f32_16x16x32_bf16 v[82:85], v[132:135], v[44:47], 0
    ds_read_b128 v[24:27], v8 offset:1984
    v_mfma_f32_16x16x32_bf16 v[76:79], v[132:135], v[48:51], v[76:79]
    ds_read_b128 v[28:31], v8 offset:1920
    s_waitcnt lgkmcnt(4)
    v_mfma_f32_16x16x32_bf16 v[82:85], v[128:131], v[52:55], v[82:85]
    ds_read_b128 v[32:35], v8 offset:1856
    v_mfma_f32_16x16x32_bf16 v[76:79], v[128:131], v[56:59], v[76:79]
    ds_read_b128 v[36:39], v8 offset:1792
    s_waitcnt lgkmcnt(5)
    v_mfma_f32_16x16x32_bf16 v[70:73], v[148:151], v[60:63], 0
    ds_read_b128 v[40:43], v8 offset:3264
    v_mfma_f32_16x16x32_bf16 v[82:85], v[156:159], v[60:63], v[82:85]
    s_waitcnt lgkmcnt(5)
    v_mfma_f32_16x16x32_bf16 v[70:73], v[144:147], v[20:23], v[70:73]
    ds_read_b128 v[44:47], v8 offset:3200
    v_mfma_f32_16x16x32_bf16 v[82:85], v[152:155], v[20:23], v[82:85]
    s_waitcnt lgkmcnt(5)
    v_mfma_f32_16x16x32_bf16 v[70:73], v[140:143], v[24:27], v[70:73]
    ds_read_b128 v[48:51], v8 offset:3136
    v_mfma_f32_16x16x32_bf16 v[82:85], v[148:151], v[24:27], v[82:85]
    s_waitcnt lgkmcnt(5)
    v_mfma_f32_16x16x32_bf16 v[70:73], v[136:139], v[28:31], v[70:73]
    ds_read_b128 v[52:55], v8 offset:3072
    v_mfma_f32_16x16x32_bf16 v[82:85], v[144:147], v[28:31], v[82:85]
    s_waitcnt lgkmcnt(5)
    v_mfma_f32_16x16x32_bf16 v[70:73], v[132:135], v[32:35], v[70:73]
    ds_read_b128 v[56:59], v8 offset:3008
    v_mfma_f32_16x16x32_bf16 v[82:85], v[140:143], v[32:35], v[82:85]
    s_waitcnt lgkmcnt(5)
    v_mfma_f32_16x16x32_bf16 v[70:73], v[128:131], v[36:39], v[70:73]
    ds_read_b128 v[60:63], v8 offset:2944
    v_mfma_f32_16x16x32_bf16 v[82:85], v[136:139], v[36:39], v[82:85]
    s_waitcnt lgkmcnt(5)
    v_mfma_f32_16x16x32_bf16 v[66:69], v[148:151], v[40:43], v[66:69]
    ds_read_b128 v[20:23], v8 offset:4032
    v_mfma_f32_16x16x32_bf16 v[78:81], v[156:159], v[40:43], v[78:81]
    s_waitcnt lgkmcnt(5)
    v_mfma_f32_16x16x32_bf16 v[66:69], v[144:147], v[44:47], v[66:69]
    ds_read_b128 v[24:27], v8 offset:2880
    v_mfma_f32_16x16x32_bf16 v[78:81], v[152:155], v[44:47], v[78:81]
    s_waitcnt lgkmcnt(5)
    v_mfma_f32_16x16x32_bf16 v[66:69], v[140:143], v[48:51], v[66:69]
    ds_read_b128 v[28:31], v8 offset:3968
    v_mfma_f32_16x16x32_bf16 v[78:81], v[148:151], v[48:51], v[78:81]
    s_waitcnt lgkmcnt(5)
    v_mfma_f32_16x16x32_bf16 v[66:69], v[136:139], v[52:55], v[66:69]
    ds_read_b128 v[32:35], v8 offset:2816
    v_mfma_f32_16x16x32_bf16 v[78:81], v[144:147], v[52:55], v[78:81]
    s_waitcnt lgkmcnt(5)
    v_mfma_f32_16x16x32_bf16 v[66:69], v[132:135], v[56:59], v[66:69]
    ds_read_b128 v[36:39], v8 offset:4416
    v_mfma_f32_16x16x32_bf16 v[78:81], v[140:143], v[56:59], v[78:81]
    s_waitcnt lgkmcnt(5)
    v_mfma_f32_16x16x32_bf16 v[66:69], v[128:131], v[60:63], v[66:69]
    ds_read_b128 v[40:43], v8 offset:4352
    v_mfma_f32_16x16x32_bf16 v[78:81], v[136:139], v[60:63], v[78:81]
    s_waitcnt lgkmcnt(4)
    v_mfma_f32_16x16x32_bf16 v[84:87], v[132:135], v[20:23], v[84:87]
    ds_read_b128 v[44:47], v8 offset:4288
    v_mfma_f32_16x16x32_bf16 v[78:81], v[132:135], v[24:27], v[78:81]
    ds_read_b128 v[48:51], v8 offset:4224
    s_waitcnt lgkmcnt(4)
    v_mfma_f32_16x16x32_bf16 v[84:87], v[128:131], v[28:31], v[84:87]
    ds_read_b128 v[52:55], v8 offset:4160
    v_mfma_f32_16x16x32_bf16 v[78:81], v[128:131], v[32:35], v[78:81]
    ds_read_b128 v[56:59], v8 offset:4096
    s_waitcnt lgkmcnt(5)
    v_mfma_f32_16x16x32_bf16 v[72:75], v[148:151], v[36:39], v[72:75]
    s_waitcnt vmcnt(0)
    ds_read_b128 v[60:63], v8 offset:10320
    v_mfma_f32_16x16x32_bf16 v[84:87], v[156:159], v[36:39], v[84:87]
    s_waitcnt lgkmcnt(5)
    v_mfma_f32_16x16x32_bf16 v[72:75], v[144:147], v[40:43], v[72:75]
    ds_read_b128 v[20:23], v8 offset:10256
    v_mfma_f32_16x16x32_bf16 v[84:87], v[152:155], v[40:43], v[84:87]
    s_waitcnt lgkmcnt(5)
    v_mfma_f32_16x16x32_bf16 v[72:75], v[140:143], v[44:47], v[72:75]
    ds_read_b128 v[24:27], v8 offset:10192
    v_mfma_f32_16x16x32_bf16 v[84:87], v[148:151], v[44:47], v[84:87]
    s_waitcnt lgkmcnt(5)
    v_mfma_f32_16x16x32_bf16 v[72:75], v[136:139], v[48:51], v[72:75]
    ds_read_b128 v[28:31], v8 offset:10128
    v_mfma_f32_16x16x32_bf16 v[84:87], v[144:147], v[48:51], v[84:87]
    s_waitcnt lgkmcnt(5)
    v_mfma_f32_16x16x32_bf16 v[72:75], v[132:135], v[52:55], v[72:75]
    ds_read_b128 v[32:35], v8 offset:10064
    v_mfma_f32_16x16x32_bf16 v[84:87], v[140:143], v[52:55], v[84:87]
    s_waitcnt lgkmcnt(5)
    v_mfma_f32_16x16x32_bf16 v[72:75], v[128:131], v[56:59], v[72:75]
    ds_read_b128 v[36:39], v8 offset:10000
    v_mfma_f32_16x16x32_bf16 v[84:87], v[136:139], v[56:59], v[84:87]
    s_waitcnt lgkmcnt(5)
    v_mfma_f32_16x16x32_bf16 v[88:91], v[212:215], v[60:63], 0
    ds_read_b128 v[40:43], v8 offset:11088
    v_mfma_f32_16x16x32_bf16 v[100:103], v[220:223], v[60:63], 0
    s_waitcnt lgkmcnt(5)
    v_mfma_f32_16x16x32_bf16 v[88:91], v[208:211], v[20:23], v[88:91]
    ds_read_b128 v[44:47], v8 offset:9936
    v_mfma_f32_16x16x32_bf16 v[100:103], v[216:219], v[20:23], v[100:103]
    s_waitcnt lgkmcnt(5)
    v_mfma_f32_16x16x32_bf16 v[88:91], v[204:207], v[24:27], v[88:91]
    ds_read_b128 v[48:51], v8 offset:11024
    v_mfma_f32_16x16x32_bf16 v[100:103], v[212:215], v[24:27], v[100:103]
    v_add_f32 v65, v65, v70
    v_add_f32 v66, v66, v71
    s_waitcnt lgkmcnt(5)
    v_mfma_f32_16x16x32_bf16 v[88:91], v[200:203], v[28:31], v[88:91]
    ds_read_b128 v[52:55], v8 offset:9872
    v_mfma_f32_16x16x32_bf16 v[100:103], v[208:211], v[28:31], v[100:103]
    v_add_f32 v67, v67, v72
    v_add_f32 v73, v73, v68
    s_waitcnt lgkmcnt(5)
    v_mfma_f32_16x16x32_bf16 v[88:91], v[196:199], v[32:35], v[88:91]
    ds_read_b128 v[56:59], v8 offset:11472
    v_mfma_f32_16x16x32_bf16 v[100:103], v[204:207], v[32:35], v[100:103]
    v_add_f32 v74, v74, v69
    v_cvt_pk_bf16_f32 v112, v64, v65
    s_waitcnt lgkmcnt(5)
    v_mfma_f32_16x16x32_bf16 v[88:91], v[192:195], v[36:39], v[88:91]
    ds_read_b128 v[60:63], v8 offset:11408
    v_mfma_f32_16x16x32_bf16 v[100:103], v[200:203], v[36:39], v[100:103]
    v_cvt_pk_bf16_f32 v113, v66, v67
    v_cvt_pk_bf16_f32 v114, v73, v74
    s_waitcnt lgkmcnt(4)
    v_mfma_f32_16x16x32_bf16 v[106:109], v[196:199], v[40:43], 0
    ds_read_b128 v[20:23], v8 offset:11344
    v_mfma_f32_16x16x32_bf16 v[100:103], v[196:199], v[44:47], v[100:103]
    ds_read_b128 v[24:27], v8 offset:11280
    s_waitcnt lgkmcnt(4)
    v_mfma_f32_16x16x32_bf16 v[106:109], v[192:195], v[48:51], v[106:109]
    ds_read_b128 v[28:31], v8 offset:11216
    v_mfma_f32_16x16x32_bf16 v[100:103], v[192:195], v[52:55], v[100:103]
    ds_read_b128 v[32:35], v8 offset:11152
    s_waitcnt lgkmcnt(5)
    v_mfma_f32_16x16x32_bf16 v[94:97], v[212:215], v[56:59], 0
    ds_read_b128 v[36:39], v8 offset:12624
    v_mfma_f32_16x16x32_bf16 v[106:109], v[220:223], v[56:59], v[106:109]
    v_cvt_pk_bf16_f32 v115, v75, v16
    ds_write_b128 v9, v[112:115] offset:2080
    s_waitcnt lgkmcnt(6)
    v_mfma_f32_16x16x32_bf16 v[94:97], v[208:211], v[60:63], v[94:97]
    ds_read_b128 v[40:43], v8 offset:12560
    v_mfma_f32_16x16x32_bf16 v[106:109], v[216:219], v[60:63], v[106:109]
    v_add_f32 v77, v77, v82
    v_add_f32 v78, v78, v83
    s_waitcnt lgkmcnt(6)
    v_mfma_f32_16x16x32_bf16 v[94:97], v[204:207], v[20:23], v[94:97]
    ds_read_b128 v[44:47], v8 offset:12496
    v_mfma_f32_16x16x32_bf16 v[106:109], v[212:215], v[20:23], v[106:109]
    v_add_f32 v79, v79, v84
    v_add_f32 v85, v85, v80
    s_waitcnt lgkmcnt(6)
    v_mfma_f32_16x16x32_bf16 v[94:97], v[200:203], v[24:27], v[94:97]
    ds_read_b128 v[48:51], v8 offset:12432
    v_mfma_f32_16x16x32_bf16 v[106:109], v[208:211], v[24:27], v[106:109]
    v_add_f32 v86, v86, v81
    v_cvt_pk_bf16_f32 v116, v76, v77
    s_waitcnt lgkmcnt(6)
    v_mfma_f32_16x16x32_bf16 v[94:97], v[196:199], v[28:31], v[94:97]
    ds_read_b128 v[52:55], v8 offset:12368
    v_mfma_f32_16x16x32_bf16 v[106:109], v[204:207], v[28:31], v[106:109]
    v_cvt_pk_bf16_f32 v117, v78, v79
    v_cvt_pk_bf16_f32 v118, v85, v86
    s_waitcnt lgkmcnt(6)
    v_mfma_f32_16x16x32_bf16 v[94:97], v[192:195], v[32:35], v[94:97]
    ds_read_b128 v[56:59], v8 offset:12304
    v_mfma_f32_16x16x32_bf16 v[106:109], v[200:203], v[32:35], v[106:109]
    v_cvt_pk_bf16_f32 v119, v87, v16
    ds_write_b128 v9, v[116:119] offset:3104
    s_waitcnt lgkmcnt(7)
    v_mfma_f32_16x16x32_bf16 v[90:93], v[212:215], v[36:39], v[90:93]
    ds_read_b128 v[60:63], v8 offset:13392
    v_mfma_f32_16x16x32_bf16 v[102:105], v[220:223], v[36:39], v[102:105]
    v_mov_b64 v[68:69], 0
    v_mov_b64 v[74:75], 0
    s_waitcnt lgkmcnt(6)
    v_mfma_f32_16x16x32_bf16 v[90:93], v[208:211], v[40:43], v[90:93]
    ds_read_b128 v[20:23], v8 offset:12240
    v_mfma_f32_16x16x32_bf16 v[102:105], v[216:219], v[40:43], v[102:105]
    v_mov_b64 v[80:81], 0
    v_mov_b64 v[86:87], 0
    s_waitcnt lgkmcnt(6)
    v_mfma_f32_16x16x32_bf16 v[90:93], v[204:207], v[44:47], v[90:93]
    ds_read_b128 v[24:27], v8 offset:13328
    v_mfma_f32_16x16x32_bf16 v[102:105], v[212:215], v[44:47], v[102:105]
    ds_write_b128 v6, v[16:19] offset:16
    s_waitcnt lgkmcnt(7)
    v_mfma_f32_16x16x32_bf16 v[90:93], v[200:203], v[48:51], v[90:93]
    ds_read_b128 v[28:31], v8 offset:12176
    v_mfma_f32_16x16x32_bf16 v[102:105], v[208:211], v[48:51], v[102:105]
    s_waitcnt lgkmcnt(7)
    v_mfma_f32_16x16x32_bf16 v[90:93], v[196:199], v[52:55], v[90:93]
    ds_read_b128 v[32:35], v8 offset:13776
    v_mfma_f32_16x16x32_bf16 v[102:105], v[204:207], v[52:55], v[102:105]
    s_waitcnt lgkmcnt(7)
    v_mfma_f32_16x16x32_bf16 v[90:93], v[192:195], v[56:59], v[90:93]
    ds_read_b128 v[36:39], v8 offset:13712
    v_mfma_f32_16x16x32_bf16 v[102:105], v[200:203], v[56:59], v[102:105]
    s_waitcnt lgkmcnt(5)
    v_mfma_f32_16x16x32_bf16 v[108:111], v[196:199], v[60:63], v[108:111]
    ds_read_b128 v[40:43], v8 offset:13648
    v_mfma_f32_16x16x32_bf16 v[102:105], v[196:199], v[20:23], v[102:105]
    ds_read_b128 v[44:47], v8 offset:13584
    s_waitcnt lgkmcnt(4)
    v_mfma_f32_16x16x32_bf16 v[108:111], v[192:195], v[24:27], v[108:111]
    ds_read_b128 v[48:51], v8 offset:13520
    v_mfma_f32_16x16x32_bf16 v[102:105], v[192:195], v[28:31], v[102:105]
    ds_read_b128 v[52:55], v8 offset:13456
    s_waitcnt lgkmcnt(5)
    v_mfma_f32_16x16x32_bf16 v[96:99], v[212:215], v[32:35], v[96:99]
    ds_read_b128 v[56:59], v8 offset:960
    v_mfma_f32_16x16x32_bf16 v[108:111], v[220:223], v[32:35], v[108:111]
    s_waitcnt lgkmcnt(5)
    v_mfma_f32_16x16x32_bf16 v[96:99], v[208:211], v[36:39], v[96:99]
    ds_read_b128 v[60:63], v8 offset:896
    v_mfma_f32_16x16x32_bf16 v[108:111], v[216:219], v[36:39], v[108:111]
    s_waitcnt lgkmcnt(5)
    v_mfma_f32_16x16x32_bf16 v[96:99], v[204:207], v[40:43], v[96:99]
    ds_read_b128 v[20:23], v8 offset:1984
    v_mfma_f32_16x16x32_bf16 v[108:111], v[212:215], v[40:43], v[108:111]
    s_waitcnt lgkmcnt(5)
    v_mfma_f32_16x16x32_bf16 v[96:99], v[200:203], v[44:47], v[96:99]
    ds_read_b128 v[24:27], v8 offset:832
    v_mfma_f32_16x16x32_bf16 v[108:111], v[208:211], v[44:47], v[108:111]
    s_waitcnt lgkmcnt(5)
    v_mfma_f32_16x16x32_bf16 v[96:99], v[196:199], v[48:51], v[96:99]
    ds_read_b128 v[28:31], v8 offset:1920
    v_mfma_f32_16x16x32_bf16 v[108:111], v[204:207], v[48:51], v[108:111]
    s_waitcnt lgkmcnt(5)
    v_mfma_f32_16x16x32_bf16 v[96:99], v[192:195], v[52:55], v[96:99]
    ds_read_b128 v[32:35], v8 offset:768
    v_mfma_f32_16x16x32_bf16 v[108:111], v[200:203], v[52:55], v[108:111]
    s_waitcnt lgkmcnt(5)
    v_mfma_f32_16x16x32_bf16 v[64:67], v[132:135], v[56:59], 0
    ds_read_b128 v[36:39], v8 offset:2112
    v_mfma_f32_16x16x32_bf16 v[76:79], v[140:143], v[56:59], 0
    s_waitcnt lgkmcnt(5)
    v_mfma_f32_16x16x32_bf16 v[64:67], v[128:131], v[60:63], v[64:67]
    ds_read_b128 v[40:43], v8 offset:2048
    v_mfma_f32_16x16x32_bf16 v[76:79], v[136:139], v[60:63], v[76:79]
    s_waitcnt lgkmcnt(4)
    v_mfma_f32_16x16x32_bf16 v[82:85], v[132:135], v[20:23], 0
    ds_read_b128 v[44:47], v8 offset:3264
    v_add_f32 v89, v89, v94
    v_add_f32 v90, v90, v95
    v_mfma_f32_16x16x32_bf16 v[76:79], v[132:135], v[24:27], v[76:79]
    ds_read_b128 v[48:51], v8 offset:3200
    v_add_f32 v91, v91, v96
    v_add_f32 v97, v97, v92
    s_waitcnt lgkmcnt(4)
    v_mfma_f32_16x16x32_bf16 v[82:85], v[128:131], v[28:31], v[82:85]
    ds_read_b128 v[52:55], v8 offset:4288
    v_add_f32 v98, v98, v93
    v_cvt_pk_bf16_f32 v112, v88, v89
    v_mfma_f32_16x16x32_bf16 v[76:79], v[128:131], v[32:35], v[76:79]
    ds_read_b128 v[56:59], v8 offset:3136
    v_cvt_pk_bf16_f32 v113, v90, v91
    v_cvt_pk_bf16_f32 v114, v97, v98
    s_waitcnt lgkmcnt(5)
    v_mfma_f32_16x16x32_bf16 v[70:73], v[132:135], v[36:39], 0
    ds_read_b128 v[60:63], v8 offset:4224
    v_mfma_f32_16x16x32_bf16 v[82:85], v[140:143], v[36:39], v[82:85]
    v_cvt_pk_bf16_f32 v115, v99, v16
    ds_write_b128 v9, v[112:115] offset:10304
    s_waitcnt lgkmcnt(6)
    v_mfma_f32_16x16x32_bf16 v[70:73], v[128:131], v[40:43], v[70:73]
    ds_read_b128 v[20:23], v8 offset:3072
    v_mfma_f32_16x16x32_bf16 v[82:85], v[136:139], v[40:43], v[82:85]
    v_add_f32 v101, v101, v106
    v_add_f32 v102, v102, v107
    s_waitcnt lgkmcnt(6)
    v_mfma_f32_16x16x32_bf16 v[66:69], v[132:135], v[44:47], v[66:69]
    ds_read_b128 v[24:27], v8 offset:4416
    v_mfma_f32_16x16x32_bf16 v[78:81], v[140:143], v[44:47], v[78:81]
    v_add_f32 v103, v103, v108
    v_add_f32 v109, v109, v104
    s_waitcnt lgkmcnt(6)
    v_mfma_f32_16x16x32_bf16 v[66:69], v[128:131], v[48:51], v[66:69]
    ds_read_b128 v[28:31], v8 offset:4352
    v_mfma_f32_16x16x32_bf16 v[78:81], v[136:139], v[48:51], v[78:81]
    v_add_f32 v110, v110, v105
    v_cvt_pk_bf16_f32 v116, v100, v101
    s_waitcnt lgkmcnt(5)
    v_mfma_f32_16x16x32_bf16 v[84:87], v[132:135], v[52:55], v[84:87]
    ds_read_b128 v[32:35], v8 offset:10320
    v_cvt_pk_bf16_f32 v117, v102, v103
    v_cvt_pk_bf16_f32 v118, v109, v110
    v_mfma_f32_16x16x32_bf16 v[78:81], v[132:135], v[56:59], v[78:81]
    ds_read_b128 v[36:39], v8 offset:10256
    v_cvt_pk_bf16_f32 v119, v111, v16
    ds_write_b128 v9, v[116:119] offset:11328
    s_waitcnt lgkmcnt(5)
    v_mfma_f32_16x16x32_bf16 v[84:87], v[128:131], v[60:63], v[84:87]
    ds_read_b128 v[40:43], v8 offset:11344
    v_mov_b64 v[92:93], 0
    v_mov_b64 v[98:99], 0
    v_mfma_f32_16x16x32_bf16 v[78:81], v[128:131], v[20:23], v[78:81]
    ds_read_b128 v[44:47], v8 offset:10192
    v_mov_b64 v[104:105], 0
    v_mov_b64 v[110:111], 0
    s_waitcnt lgkmcnt(6)
    v_mfma_f32_16x16x32_bf16 v[72:75], v[132:135], v[24:27], v[72:75]
    ds_read_b128 v[48:51], v8 offset:11280
    v_mfma_f32_16x16x32_bf16 v[84:87], v[140:143], v[24:27], v[84:87]
    s_waitcnt lgkmcnt(6)
    v_mfma_f32_16x16x32_bf16 v[72:75], v[128:131], v[28:31], v[72:75]
    ds_read_b128 v[52:55], v8 offset:10128
    v_mfma_f32_16x16x32_bf16 v[84:87], v[136:139], v[28:31], v[84:87]
    s_waitcnt lgkmcnt(6)
    v_mfma_f32_16x16x32_bf16 v[88:91], v[196:199], v[32:35], 0
    ds_read_b128 v[56:59], v8 offset:11472
    v_mfma_f32_16x16x32_bf16 v[100:103], v[204:207], v[32:35], 0
    s_waitcnt lgkmcnt(6)
    v_mfma_f32_16x16x32_bf16 v[88:91], v[192:195], v[36:39], v[88:91]
    ds_read_b128 v[60:63], v8 offset:11408
    v_mfma_f32_16x16x32_bf16 v[100:103], v[200:203], v[36:39], v[100:103]
    s_waitcnt lgkmcnt(4)
    v_mfma_f32_16x16x32_bf16 v[106:109], v[196:199], v[40:43], 0
    ds_read_b128 v[20:23], v8 offset:12624
    v_add_f32 v65, v65, v70
    v_add_f32 v66, v66, v71
    v_mfma_f32_16x16x32_bf16 v[100:103], v[196:199], v[44:47], v[100:103]
    ds_read_b128 v[24:27], v8 offset:12560
    v_add_f32 v67, v67, v72
    v_add_f32 v73, v73, v68
    s_waitcnt lgkmcnt(4)
    v_mfma_f32_16x16x32_bf16 v[106:109], v[192:195], v[48:51], v[106:109]
    ds_read_b128 v[28:31], v8 offset:13648
    v_add_f32 v74, v74, v69
    v_cvt_pk_bf16_f32 v112, v64, v65
    v_mfma_f32_16x16x32_bf16 v[100:103], v[192:195], v[52:55], v[100:103]
    ds_read_b128 v[32:35], v8 offset:12496
    v_cvt_pk_bf16_f32 v113, v66, v67
    v_cvt_pk_bf16_f32 v114, v73, v74
    s_waitcnt lgkmcnt(5)
    v_mfma_f32_16x16x32_bf16 v[94:97], v[196:199], v[56:59], 0
    ds_read_b128 v[36:39], v8 offset:13584
    v_mfma_f32_16x16x32_bf16 v[106:109], v[204:207], v[56:59], v[106:109]
    v_cvt_pk_bf16_f32 v115, v75, v16
    ds_write_b128 v9, v[112:115] offset:32
    s_waitcnt lgkmcnt(6)
    v_mfma_f32_16x16x32_bf16 v[94:97], v[192:195], v[60:63], v[94:97]
    ds_read_b128 v[40:43], v8 offset:12432
    v_mfma_f32_16x16x32_bf16 v[106:109], v[200:203], v[60:63], v[106:109]
    v_add_f32 v77, v77, v82
    v_add_f32 v78, v78, v83
    s_waitcnt lgkmcnt(6)
    v_mfma_f32_16x16x32_bf16 v[90:93], v[196:199], v[20:23], v[90:93]
    ds_read_b128 v[44:47], v8 offset:13776
    v_mfma_f32_16x16x32_bf16 v[102:105], v[204:207], v[20:23], v[102:105]
    v_add_f32 v79, v79, v84
    v_add_f32 v85, v85, v80
    s_waitcnt lgkmcnt(6)
    v_mfma_f32_16x16x32_bf16 v[90:93], v[192:195], v[24:27], v[90:93]
    ds_read_b128 v[48:51], v8 offset:13712
    v_mfma_f32_16x16x32_bf16 v[102:105], v[200:203], v[24:27], v[102:105]
    v_add_f32 v86, v86, v81
    v_cvt_pk_bf16_f32 v116, v76, v77
    s_waitcnt lgkmcnt(5)
    v_mfma_f32_16x16x32_bf16 v[108:111], v[196:199], v[28:31], v[108:111]
    ds_read_b128 v[52:55], v8 offset:960
    v_cvt_pk_bf16_f32 v117, v78, v79
    v_cvt_pk_bf16_f32 v118, v85, v86
    v_mfma_f32_16x16x32_bf16 v[102:105], v[196:199], v[32:35], v[102:105]
    ds_read_b128 v[56:59], v8 offset:896
    v_cvt_pk_bf16_f32 v119, v87, v16
    ds_write_b128 v9, v[116:119] offset:1056
    s_waitcnt lgkmcnt(5)
    v_mfma_f32_16x16x32_bf16 v[108:111], v[192:195], v[36:39], v[108:111]
    ds_read_b128 v[60:63], v8 offset:832
    v_mov_b64 v[68:69], 0
    v_mov_b64 v[74:75], 0
    v_mfma_f32_16x16x32_bf16 v[102:105], v[192:195], v[40:43], v[102:105]
    ds_read_b128 v[20:23], v8 offset:768
    v_mov_b64 v[80:81], 0
    v_mov_b64 v[86:87], 0
    s_waitcnt lgkmcnt(6)
    v_mfma_f32_16x16x32_bf16 v[96:99], v[196:199], v[44:47], v[96:99]
    ds_read_b128 v[24:27], v8 offset:704
    v_mfma_f32_16x16x32_bf16 v[108:111], v[204:207], v[44:47], v[108:111]
    s_waitcnt lgkmcnt(6)
    v_mfma_f32_16x16x32_bf16 v[96:99], v[192:195], v[48:51], v[96:99]
    ds_read_b128 v[28:31], v8 offset:640
    v_mfma_f32_16x16x32_bf16 v[108:111], v[200:203], v[48:51], v[108:111]
    s_waitcnt lgkmcnt(6)
    v_mfma_f32_16x16x32_bf16 v[64:67], v[164:167], v[52:55], 0
    ds_read_b128 v[32:35], v8 offset:576
    v_mfma_f32_16x16x32_bf16 v[76:79], v[172:175], v[52:55], 0
    s_waitcnt lgkmcnt(6)
    v_mfma_f32_16x16x32_bf16 v[64:67], v[160:163], v[56:59], v[64:67]
    ds_read_b128 v[36:39], v8 offset:512
    v_mfma_f32_16x16x32_bf16 v[76:79], v[168:171], v[56:59], v[76:79]
    s_waitcnt lgkmcnt(5)
    v_mfma_f32_16x16x32_bf16 v[64:67], v[156:159], v[60:63], v[64:67]
    ds_read_b128 v[40:43], v8 offset:448
    v_mfma_f32_16x16x32_bf16 v[76:79], v[164:167], v[60:63], v[76:79]
    v_add_f32 v89, v89, v94
    s_waitcnt lgkmcnt(5)
    v_mfma_f32_16x16x32_bf16 v[64:67], v[152:155], v[20:23], v[64:67]
    ds_read_b128 v[44:47], v8 offset:384
    v_mfma_f32_16x16x32_bf16 v[76:79], v[160:163], v[20:23], v[76:79]
    v_add_f32 v90, v90, v95
    s_waitcnt lgkmcnt(5)
    v_mfma_f32_16x16x32_bf16 v[64:67], v[148:151], v[24:27], v[64:67]
    ds_read_b128 v[48:51], v8 offset:1472
    v_mfma_f32_16x16x32_bf16 v[76:79], v[156:159], v[24:27], v[76:79]
    v_add_f32 v91, v91, v96
    s_waitcnt lgkmcnt(5)
    v_mfma_f32_16x16x32_bf16 v[64:67], v[144:147], v[28:31], v[64:67]
    ds_read_b128 v[52:55], v8 offset:320
    v_mfma_f32_16x16x32_bf16 v[76:79], v[152:155], v[28:31], v[76:79]
    v_add_f32 v97, v97, v92
    s_waitcnt lgkmcnt(5)
    v_mfma_f32_16x16x32_bf16 v[64:67], v[140:143], v[32:35], v[64:67]
    ds_read_b128 v[56:59], v8 offset:1408
    v_mfma_f32_16x16x32_bf16 v[76:79], v[148:151], v[32:35], v[76:79]
    v_add_f32 v98, v98, v93
    s_waitcnt lgkmcnt(5)
    v_mfma_f32_16x16x32_bf16 v[64:67], v[136:139], v[36:39], v[64:67]
    ds_read_b128 v[60:63], v8 offset:256
    v_mfma_f32_16x16x32_bf16 v[76:79], v[144:147], v[36:39], v[76:79]
    v_cvt_pk_bf16_f32 v112, v88, v89
    s_waitcnt lgkmcnt(5)
    v_mfma_f32_16x16x32_bf16 v[64:67], v[132:135], v[40:43], v[64:67]
    ds_read_b128 v[20:23], v8 offset:2112
    v_mfma_f32_16x16x32_bf16 v[76:79], v[140:143], v[40:43], v[76:79]
    v_cvt_pk_bf16_f32 v113, v90, v91
    s_waitcnt lgkmcnt(5)
    v_mfma_f32_16x16x32_bf16 v[64:67], v[128:131], v[44:47], v[64:67]
    ds_read_b128 v[24:27], v8 offset:2048
    v_mfma_f32_16x16x32_bf16 v[76:79], v[136:139], v[44:47], v[76:79]
    v_cvt_pk_bf16_f32 v114, v97, v98
    s_waitcnt lgkmcnt(4)
    v_mfma_f32_16x16x32_bf16 v[82:85], v[132:135], v[48:51], 0
    ds_read_b128 v[28:31], v8 offset:1984
    v_mfma_f32_16x16x32_bf16 v[76:79], v[132:135], v[52:55], v[76:79]
    ds_read_b128 v[32:35], v8 offset:1920
    s_waitcnt lgkmcnt(4)
    v_mfma_f32_16x16x32_bf16 v[82:85], v[128:131], v[56:59], v[82:85]
    ds_read_b128 v[36:39], v8 offset:1856
    v_mfma_f32_16x16x32_bf16 v[76:79], v[128:131], v[60:63], v[76:79]
    ds_read_b128 v[40:43], v8 offset:1792
    s_waitcnt lgkmcnt(5)
    v_mfma_f32_16x16x32_bf16 v[70:73], v[164:167], v[20:23], 0
    ds_read_b128 v[44:47], v8 offset:1728
    v_mfma_f32_16x16x32_bf16 v[82:85], v[172:175], v[20:23], v[82:85]
    v_cvt_pk_bf16_f32 v115, v99, v16
    s_waitcnt lgkmcnt(5)
    v_mfma_f32_16x16x32_bf16 v[70:73], v[160:163], v[24:27], v[70:73]
    ds_read_b128 v[48:51], v8 offset:1664
    v_mfma_f32_16x16x32_bf16 v[82:85], v[168:171], v[24:27], v[82:85]
    ds_write_b128 v9, v[112:115] offset:8256
    s_waitcnt lgkmcnt(6)
    v_mfma_f32_16x16x32_bf16 v[70:73], v[156:159], v[28:31], v[70:73]
    ds_read_b128 v[52:55], v8 offset:1600
    v_mfma_f32_16x16x32_bf16 v[82:85], v[164:167], v[28:31], v[82:85]
    v_add_f32 v101, v101, v106
    s_waitcnt lgkmcnt(6)
    v_mfma_f32_16x16x32_bf16 v[70:73], v[152:155], v[32:35], v[70:73]
    ds_read_b128 v[56:59], v8 offset:1536
    v_mfma_f32_16x16x32_bf16 v[82:85], v[160:163], v[32:35], v[82:85]
    v_add_f32 v102, v102, v107
    s_waitcnt lgkmcnt(6)
    v_mfma_f32_16x16x32_bf16 v[70:73], v[148:151], v[36:39], v[70:73]
    ds_read_b128 v[60:63], v8 offset:3264
    v_mfma_f32_16x16x32_bf16 v[82:85], v[156:159], v[36:39], v[82:85]
    v_add_f32 v103, v103, v108
    s_waitcnt lgkmcnt(6)
    v_mfma_f32_16x16x32_bf16 v[70:73], v[144:147], v[40:43], v[70:73]
    ds_read_b128 v[20:23], v8 offset:3200
    v_mfma_f32_16x16x32_bf16 v[82:85], v[152:155], v[40:43], v[82:85]
    v_add_f32 v109, v109, v104
    s_waitcnt lgkmcnt(6)
    v_mfma_f32_16x16x32_bf16 v[70:73], v[140:143], v[44:47], v[70:73]
    ds_read_b128 v[24:27], v8 offset:3136
    v_mfma_f32_16x16x32_bf16 v[82:85], v[148:151], v[44:47], v[82:85]
    v_add_f32 v110, v110, v105
    s_waitcnt lgkmcnt(6)
    v_mfma_f32_16x16x32_bf16 v[70:73], v[136:139], v[48:51], v[70:73]
    ds_read_b128 v[28:31], v8 offset:3072
    v_mfma_f32_16x16x32_bf16 v[82:85], v[144:147], v[48:51], v[82:85]
    v_cvt_pk_bf16_f32 v116, v100, v101
    s_waitcnt lgkmcnt(5)
    v_mfma_f32_16x16x32_bf16 v[70:73], v[132:135], v[52:55], v[70:73]
    ds_read_b128 v[32:35], v8 offset:3008
    v_mfma_f32_16x16x32_bf16 v[82:85], v[140:143], v[52:55], v[82:85]
    v_cvt_pk_bf16_f32 v117, v102, v103
    s_waitcnt lgkmcnt(5)
    v_mfma_f32_16x16x32_bf16 v[70:73], v[128:131], v[56:59], v[70:73]
    ds_read_b128 v[36:39], v8 offset:2944
    v_mfma_f32_16x16x32_bf16 v[82:85], v[136:139], v[56:59], v[82:85]
    v_cvt_pk_bf16_f32 v118, v109, v110
    s_waitcnt lgkmcnt(5)
    v_mfma_f32_16x16x32_bf16 v[66:69], v[164:167], v[60:63], v[66:69]
    ds_read_b128 v[40:43], v8 offset:2880
    v_mfma_f32_16x16x32_bf16 v[78:81], v[172:175], v[60:63], v[78:81]
    v_cvt_pk_bf16_f32 v119, v111, v16
    s_waitcnt lgkmcnt(5)
    v_mfma_f32_16x16x32_bf16 v[66:69], v[160:163], v[20:23], v[66:69]
    ds_read_b128 v[44:47], v8 offset:2816
    v_mfma_f32_16x16x32_bf16 v[78:81], v[168:171], v[20:23], v[78:81]
    ds_write_b128 v9, v[116:119] offset:9280
    s_waitcnt lgkmcnt(6)
    v_mfma_f32_16x16x32_bf16 v[66:69], v[156:159], v[24:27], v[66:69]
    ds_read_b128 v[48:51], v8 offset:2752
    v_mfma_f32_16x16x32_bf16 v[78:81], v[164:167], v[24:27], v[78:81]
    v_mov_b64 v[92:93], 0
    s_waitcnt lgkmcnt(6)
    v_mfma_f32_16x16x32_bf16 v[66:69], v[152:155], v[28:31], v[66:69]
    ds_read_b128 v[52:55], v8 offset:2688
    v_mfma_f32_16x16x32_bf16 v[78:81], v[160:163], v[28:31], v[78:81]
    v_mov_b64 v[98:99], 0
    s_waitcnt lgkmcnt(6)
    v_mfma_f32_16x16x32_bf16 v[66:69], v[148:151], v[32:35], v[66:69]
    ds_read_b128 v[56:59], v8 offset:3776
    v_mfma_f32_16x16x32_bf16 v[78:81], v[156:159], v[32:35], v[78:81]
    v_mov_b64 v[104:105], 0
    s_waitcnt lgkmcnt(6)
    v_mfma_f32_16x16x32_bf16 v[66:69], v[144:147], v[36:39], v[66:69]
    ds_read_b128 v[60:63], v8 offset:2624
    v_mfma_f32_16x16x32_bf16 v[78:81], v[152:155], v[36:39], v[78:81]
    v_mov_b64 v[110:111], 0
    s_waitcnt lgkmcnt(6)
    v_mfma_f32_16x16x32_bf16 v[66:69], v[140:143], v[40:43], v[66:69]
    ds_read_b128 v[20:23], v8 offset:3712
    v_mfma_f32_16x16x32_bf16 v[78:81], v[148:151], v[40:43], v[78:81]
    s_waitcnt lgkmcnt(6)
    v_mfma_f32_16x16x32_bf16 v[66:69], v[136:139], v[44:47], v[66:69]
    ds_read_b128 v[24:27], v8 offset:2560
    v_mfma_f32_16x16x32_bf16 v[78:81], v[144:147], v[44:47], v[78:81]
    s_waitcnt lgkmcnt(5)
    v_mfma_f32_16x16x32_bf16 v[66:69], v[132:135], v[48:51], v[66:69]
    ds_read_b128 v[28:31], v8 offset:4416
    v_mfma_f32_16x16x32_bf16 v[78:81], v[140:143], v[48:51], v[78:81]
    s_waitcnt lgkmcnt(5)
    v_mfma_f32_16x16x32_bf16 v[66:69], v[128:131], v[52:55], v[66:69]
    ds_read_b128 v[32:35], v8 offset:4352
    v_mfma_f32_16x16x32_bf16 v[78:81], v[136:139], v[52:55], v[78:81]
    s_waitcnt lgkmcnt(4)
    v_mfma_f32_16x16x32_bf16 v[84:87], v[132:135], v[56:59], v[84:87]
    ds_read_b128 v[36:39], v8 offset:4288
    v_mfma_f32_16x16x32_bf16 v[78:81], v[132:135], v[60:63], v[78:81]
    ds_read_b128 v[40:43], v8 offset:4224
    s_waitcnt lgkmcnt(4)
    v_mfma_f32_16x16x32_bf16 v[84:87], v[128:131], v[20:23], v[84:87]
    ds_read_b128 v[44:47], v8 offset:4160
    v_mfma_f32_16x16x32_bf16 v[78:81], v[128:131], v[24:27], v[78:81]
    ds_read_b128 v[48:51], v8 offset:4096
    s_waitcnt lgkmcnt(5)
    v_mfma_f32_16x16x32_bf16 v[72:75], v[164:167], v[28:31], v[72:75]
    ds_read_b128 v[52:55], v8 offset:4032
    v_mfma_f32_16x16x32_bf16 v[84:87], v[172:175], v[28:31], v[84:87]
Lhk_m_1:
    s_cbranch_execz Lhr_m
    s_waitcnt lgkmcnt(5)
    v_mfma_f32_16x16x32_bf16 v[72:75], v[160:163], v[32:35], v[72:75]
    ds_read_b128 v[56:59], v8 offset:3968
    v_mfma_f32_16x16x32_bf16 v[84:87], v[168:171], v[32:35], v[84:87]
    s_waitcnt lgkmcnt(5)
    v_mfma_f32_16x16x32_bf16 v[72:75], v[156:159], v[36:39], v[72:75]
    ds_read_b128 v[60:63], v8 offset:3904
    v_mfma_f32_16x16x32_bf16 v[84:87], v[164:167], v[36:39], v[84:87]
    s_waitcnt lgkmcnt(5)
    v_mfma_f32_16x16x32_bf16 v[72:75], v[152:155], v[40:43], v[72:75]
    ds_read_b128 v[20:23], v8 offset:3840
    v_mfma_f32_16x16x32_bf16 v[84:87], v[160:163], v[40:43], v[84:87]
    s_waitcnt lgkmcnt(5)
    v_mfma_f32_16x16x32_bf16 v[72:75], v[148:151], v[44:47], v[72:75]
    ds_read_b128 v[24:27], v8 offset:10320
    v_mfma_f32_16x16x32_bf16 v[84:87], v[156:159], v[44:47], v[84:87]
    s_waitcnt lgkmcnt(5)
    v_mfma_f32_16x16x32_bf16 v[72:75], v[144:147], v[48:51], v[72:75]
    ds_read_b128 v[28:31], v8 offset:10256
    v_mfma_f32_16x16x32_bf16 v[84:87], v[152:155], v[48:51], v[84:87]
    s_waitcnt lgkmcnt(5)
    v_mfma_f32_16x16x32_bf16 v[72:75], v[140:143], v[52:55], v[72:75]
    ds_read_b128 v[32:35], v8 offset:10192
    v_mfma_f32_16x16x32_bf16 v[84:87], v[148:151], v[52:55], v[84:87]
    s_waitcnt lgkmcnt(5)
    v_mfma_f32_16x16x32_bf16 v[72:75], v[136:139], v[56:59], v[72:75]
    ds_read_b128 v[36:39], v8 offset:10128
    v_mfma_f32_16x16x32_bf16 v[84:87], v[144:147], v[56:59], v[84:87]
    s_waitcnt lgkmcnt(5)
    v_mfma_f32_16x16x32_bf16 v[72:75], v[132:135], v[60:63], v[72:75]
    ds_read_b128 v[40:43], v8 offset:10064
    v_mfma_f32_16x16x32_bf16 v[84:87], v[140:143], v[60:63], v[84:87]
    s_barrier
    s_waitcnt lgkmcnt(5)
    v_mfma_f32_16x16x32_bf16 v[72:75], v[128:131], v[20:23], v[72:75]
    ds_read_b128 v[44:47], v8 offset:10000
    v_mfma_f32_16x16x32_bf16 v[84:87], v[136:139], v[20:23], v[84:87]
    s_waitcnt lgkmcnt(5)
    v_mfma_f32_16x16x32_bf16 v[88:91], v[228:231], v[24:27], 0
    ds_read_b128 v[48:51], v8 offset:9936
    v_mfma_f32_16x16x32_bf16 v[100:103], v[236:239], v[24:27], 0
    s_waitcnt lgkmcnt(5)
    v_mfma_f32_16x16x32_bf16 v[88:91], v[224:227], v[28:31], v[88:91]
    ds_read_b128 v[52:55], v8 offset:9872
    v_mfma_f32_16x16x32_bf16 v[100:103], v[232:235], v[28:31], v[100:103]
    s_waitcnt lgkmcnt(5)
    v_mfma_f32_16x16x32_bf16 v[88:91], v[220:223], v[32:35], v[88:91]
    ds_read_b128 v[56:59], v8 offset:9808
    v_mfma_f32_16x16x32_bf16 v[100:103], v[228:231], v[32:35], v[100:103]
    v_add_f32 v65, v65, v70
    s_waitcnt lgkmcnt(5)
    v_mfma_f32_16x16x32_bf16 v[88:91], v[216:219], v[36:39], v[88:91]
    ds_read_b128 v[60:63], v8 offset:9744
    v_mfma_f32_16x16x32_bf16 v[100:103], v[224:227], v[36:39], v[100:103]
    v_add_f32 v66, v66, v71
    s_waitcnt lgkmcnt(5)
    v_mfma_f32_16x16x32_bf16 v[88:91], v[212:215], v[40:43], v[88:91]
    ds_read_b128 v[20:23], v8 offset:10832
    v_mfma_f32_16x16x32_bf16 v[100:103], v[220:223], v[40:43], v[100:103]
    v_add_f32 v67, v67, v72
    s_waitcnt lgkmcnt(5)
    v_mfma_f32_16x16x32_bf16 v[88:91], v[208:211], v[44:47], v[88:91]
    ds_read_b128 v[24:27], v8 offset:9680
    v_mfma_f32_16x16x32_bf16 v[100:103], v[216:219], v[44:47], v[100:103]
    v_add_f32 v73, v73, v68
    s_waitcnt lgkmcnt(5)
    v_mfma_f32_16x16x32_bf16 v[88:91], v[204:207], v[48:51], v[88:91]
    ds_read_b128 v[28:31], v8 offset:10768
    v_mfma_f32_16x16x32_bf16 v[100:103], v[212:215], v[48:51], v[100:103]
    v_add_f32 v74, v74, v69
    s_waitcnt lgkmcnt(5)
    v_mfma_f32_16x16x32_bf16 v[88:91], v[200:203], v[52:55], v[88:91]
    ds_read_b128 v[32:35], v8 offset:9616
    v_mfma_f32_16x16x32_bf16 v[100:103], v[208:211], v[52:55], v[100:103]
    v_cvt_pk_bf16_f32 v112, v64, v65
    s_waitcnt lgkmcnt(5)
    v_mfma_f32_16x16x32_bf16 v[88:91], v[196:199], v[56:59], v[88:91]
    ds_read_b128 v[36:39], v8 offset:11472
    v_mfma_f32_16x16x32_bf16 v[100:103], v[204:207], v[56:59], v[100:103]
    v_cvt_pk_bf16_f32 v113, v66, v67
    s_waitcnt lgkmcnt(5)
    v_mfma_f32_16x16x32_bf16 v[88:91], v[192:195], v[60:63], v[88:91]
    ds_read_b128 v[40:43], v8 offset:11408
    v_mfma_f32_16x16x32_bf16 v[100:103], v[200:203], v[60:63], v[100:103]
    v_cvt_pk_bf16_f32 v114, v73, v74
    s_waitcnt lgkmcnt(4)
    v_mfma_f32_16x16x32_bf16 v[106:109], v[196:199], v[20:23], 0
    ds_read_b128 v[44:47], v8 offset:11344
    v_mfma_f32_16x16x32_bf16 v[100:103], v[196:199], v[24:27], v[100:103]
    ds_read_b128 v[48:51], v8 offset:11280
    s_waitcnt lgkmcnt(4)
    v_mfma_f32_16x16x32_bf16 v[106:109], v[192:195], v[28:31], v[106:109]
    ds_read_b128 v[52:55], v8 offset:11216
    v_mfma_f32_16x16x32_bf16 v[100:103], v[192:195], v[32:35], v[100:103]
    ds_read_b128 v[56:59], v8 offset:11152
    s_waitcnt lgkmcnt(5)
    v_mfma_f32_16x16x32_bf16 v[94:97], v[228:231], v[36:39], 0
    ds_read_b128 v[60:63], v8 offset:11088
    v_mfma_f32_16x16x32_bf16 v[106:109], v[236:239], v[36:39], v[106:109]
    v_cvt_pk_bf16_f32 v115, v75, v16
    s_waitcnt lgkmcnt(5)
    v_mfma_f32_16x16x32_bf16 v[94:97], v[224:227], v[40:43], v[94:97]
    ds_read_b128 v[20:23], v8 offset:11024
    v_mfma_f32_16x16x32_bf16 v[106:109], v[232:235], v[40:43], v[106:109]
    ds_write_b128 v9, v[112:115] offset:4128
    s_waitcnt lgkmcnt(6)
    v_mfma_f32_16x16x32_bf16 v[94:97], v[220:223], v[44:47], v[94:97]
    ds_read_b128 v[24:27], v8 offset:10960
    v_mfma_f32_16x16x32_bf16 v[106:109], v[228:231], v[44:47], v[106:109]
    v_add_f32 v77, v77, v82
    s_waitcnt lgkmcnt(6)
    v_mfma_f32_16x16x32_bf16 v[94:97], v[216:219], v[48:51], v[94:97]
    ds_read_b128 v[28:31], v8 offset:10896
    v_mfma_f32_16x16x32_bf16 v[106:109], v[224:227], v[48:51], v[106:109]
    v_add_f32 v78, v78, v83
    s_waitcnt lgkmcnt(6)
    v_mfma_f32_16x16x32_bf16 v[94:97], v[212:215], v[52:55], v[94:97]
    ds_read_b128 v[32:35], v8 offset:12624
    v_mfma_f32_16x16x32_bf16 v[106:109], v[220:223], v[52:55], v[106:109]
    v_add_f32 v79, v79, v84
    s_waitcnt lgkmcnt(6)
    v_mfma_f32_16x16x32_bf16 v[94:97], v[208:211], v[56:59], v[94:97]
    ds_read_b128 v[36:39], v8 offset:12560
    v_mfma_f32_16x16x32_bf16 v[106:109], v[216:219], v[56:59], v[106:109]
    v_add_f32 v85, v85, v80
    s_waitcnt lgkmcnt(6)
    v_mfma_f32_16x16x32_bf16 v[94:97], v[204:207], v[60:63], v[94:97]
    ds_read_b128 v[40:43], v8 offset:12496
    v_mfma_f32_16x16x32_bf16 v[106:109], v[212:215], v[60:63], v[106:109]
    v_add_f32 v86, v86, v81
    s_waitcnt lgkmcnt(6)
    v_mfma_f32_16x16x32_bf16 v[94:97], v[200:203], v[20:23], v[94:97]
    ds_read_b128 v[44:47], v8 offset:12432
    v_mfma_f32_16x16x32_bf16 v[106:109], v[208:211], v[20:23], v[106:109]
    v_cvt_pk_bf16_f32 v116, v76, v77
    s_waitcnt lgkmcnt(5)
    v_mfma_f32_16x16x32_bf16 v[94:97], v[196:199], v[24:27], v[94:97]
    ds_read_b128 v[48:51], v8 offset:12368
    v_mfma_f32_16x16x32_bf16 v[106:109], v[204:207], v[24:27], v[106:109]
    v_cvt_pk_bf16_f32 v117, v78, v79
    s_waitcnt lgkmcnt(5)
    v_mfma_f32_16x16x32_bf16 v[94:97], v[192:195], v[28:31], v[94:97]
    ds_read_b128 v[52:55], v8 offset:12304
    v_mfma_f32_16x16x32_bf16 v[106:109], v[200:203], v[28:31], v[106:109]
    v_cvt_pk_bf16_f32 v118, v85, v86
    s_waitcnt lgkmcnt(5)
    v_mfma_f32_16x16x32_bf16 v[90:93], v[228:231], v[32:35], v[90:93]
    ds_read_b128 v[56:59], v8 offset:12240
    v_mfma_f32_16x16x32_bf16 v[102:105], v[236:239], v[32:35], v[102:105]
    v_cvt_pk_bf16_f32 v119, v87, v16
    s_waitcnt lgkmcnt(5)
    v_mfma_f32_16x16x32_bf16 v[90:93], v[224:227], v[36:39], v[90:93]
    ds_read_b128 v[60:63], v8 offset:12176
    v_mfma_f32_16x16x32_bf16 v[102:105], v[232:235], v[36:39], v[102:105]
    ds_write_b128 v9, v[116:119] offset:5152
    s_waitcnt lgkmcnt(6)
    v_mfma_f32_16x16x32_bf16 v[90:93], v[220:223], v[40:43], v[90:93]
    ds_read_b128 v[20:23], v8 offset:12112
    v_mfma_f32_16x16x32_bf16 v[102:105], v[228:231], v[40:43], v[102:105]
    v_mov_b64 v[68:69], 0
    s_waitcnt lgkmcnt(6)
    v_mfma_f32_16x16x32_bf16 v[90:93], v[216:219], v[44:47], v[90:93]
    ds_read_b128 v[24:27], v8 offset:12048
    v_mfma_f32_16x16x32_bf16 v[102:105], v[224:227], v[44:47], v[102:105]
    v_mov_b64 v[74:75], 0
    s_waitcnt lgkmcnt(6)
    v_mfma_f32_16x16x32_bf16 v[90:93], v[212:215], v[48:51], v[90:93]
    ds_read_b128 v[28:31], v8 offset:13136
    v_mfma_f32_16x16x32_bf16 v[102:105], v[220:223], v[48:51], v[102:105]
    v_mov_b64 v[80:81], 0
    s_waitcnt lgkmcnt(6)
    v_mfma_f32_16x16x32_bf16 v[90:93], v[208:211], v[52:55], v[90:93]
    ds_read_b128 v[32:35], v8 offset:11984
    v_mfma_f32_16x16x32_bf16 v[102:105], v[216:219], v[52:55], v[102:105]
    v_mov_b64 v[86:87], 0
    s_waitcnt lgkmcnt(6)
    v_mfma_f32_16x16x32_bf16 v[90:93], v[204:207], v[56:59], v[90:93]
    ds_read_b128 v[36:39], v8 offset:13072
    v_mfma_f32_16x16x32_bf16 v[102:105], v[212:215], v[56:59], v[102:105]
    s_waitcnt lgkmcnt(6)
    v_mfma_f32_16x16x32_bf16 v[90:93], v[200:203], v[60:63], v[90:93]
    ds_read_b128 v[40:43], v8 offset:11920
    v_mfma_f32_16x16x32_bf16 v[102:105], v[208:211], v[60:63], v[102:105]
    s_waitcnt lgkmcnt(5)
    v_mfma_f32_16x16x32_bf16 v[90:93], v[196:199], v[20:23], v[90:93]
    ds_read_b128 v[44:47], v8 offset:13776
    v_mfma_f32_16x16x32_bf16 v[102:105], v[204:207], v[20:23], v[102:105]
    s_waitcnt lgkmcnt(5)
    v_mfma_f32_16x16x32_bf16 v[90:93], v[192:195], v[24:27], v[90:93]
    ds_read_b128 v[48:51], v8 offset:13712
    v_mfma_f32_16x16x32_bf16 v[102:105], v[200:203], v[24:27], v[102:105]
    s_waitcnt lgkmcnt(4)
    v_mfma_f32_16x16x32_bf16 v[108:111], v[196:199], v[28:31], v[108:111]
    ds_read_b128 v[52:55], v8 offset:13648
    v_mfma_f32_16x16x32_bf16 v[102:105], v[196:199], v[32:35], v[102:105]
    ds_read_b128 v[56:59], v8 offset:13584
    s_waitcnt lgkmcnt(4)
    v_mfma_f32_16x16x32_bf16 v[108:111], v[192:195], v[36:39], v[108:111]
    ds_read_b128 v[60:63], v8 offset:13520
    v_mfma_f32_16x16x32_bf16 v[102:105], v[192:195], v[40:43], v[102:105]
    ds_read_b128 v[20:23], v8 offset:13456
    s_waitcnt lgkmcnt(5)
    v_mfma_f32_16x16x32_bf16 v[96:99], v[228:231], v[44:47], v[96:99]
    ds_read_b128 v[24:27], v8 offset:13392
    v_mfma_f32_16x16x32_bf16 v[108:111], v[236:239], v[44:47], v[108:111]
    s_waitcnt lgkmcnt(5)
    v_mfma_f32_16x16x32_bf16 v[96:99], v[224:227], v[48:51], v[96:99]
    ds_read_b128 v[28:31], v8 offset:13328
    v_mfma_f32_16x16x32_bf16 v[108:111], v[232:235], v[48:51], v[108:111]
    s_waitcnt lgkmcnt(5)
    v_mfma_f32_16x16x32_bf16 v[96:99], v[220:223], v[52:55], v[96:99]
    ds_read_b128 v[32:35], v8 offset:13264
    v_mfma_f32_16x16x32_bf16 v[108:111], v[228:231], v[52:55], v[108:111]
    s_waitcnt lgkmcnt(5)
    v_mfma_f32_16x16x32_bf16 v[96:99], v[216:219], v[56:59], v[96:99]
    ds_read_b128 v[36:39], v8 offset:13200
    v_mfma_f32_16x16x32_bf16 v[108:111], v[224:227], v[56:59], v[108:111]
    s_waitcnt lgkmcnt(5)
    v_mfma_f32_16x16x32_bf16 v[96:99], v[212:215], v[60:63], v[96:99]
    ds_read_b128 v[40:43], v8 offset:960
    v_mfma_f32_16x16x32_bf16 v[108:111], v[220:223], v[60:63], v[108:111]
    s_waitcnt lgkmcnt(5)
    v_mfma_f32_16x16x32_bf16 v[96:99], v[208:211], v[20:23], v[96:99]
    ds_read_b128 v[44:47], v8 offset:896
    v_mfma_f32_16x16x32_bf16 v[108:111], v[216:219], v[20:23], v[108:111]
    s_waitcnt lgkmcnt(5)
    v_mfma_f32_16x16x32_bf16 v[96:99], v[204:207], v[24:27], v[96:99]
    ds_read_b128 v[48:51], v8 offset:832
    v_mfma_f32_16x16x32_bf16 v[108:111], v[212:215], v[24:27], v[108:111]
    s_waitcnt lgkmcnt(5)
    v_mfma_f32_16x16x32_bf16 v[96:99], v[200:203], v[28:31], v[96:99]
    ds_read_b128 v[52:55], v8 offset:768
    v_mfma_f32_16x16x32_bf16 v[108:111], v[208:211], v[28:31], v[108:111]
    s_waitcnt lgkmcnt(5)
    v_mfma_f32_16x16x32_bf16 v[96:99], v[196:199], v[32:35], v[96:99]
    ds_read_b128 v[56:59], v8 offset:704
    v_mfma_f32_16x16x32_bf16 v[108:111], v[204:207], v[32:35], v[108:111]
    s_waitcnt lgkmcnt(5)
    v_mfma_f32_16x16x32_bf16 v[96:99], v[192:195], v[36:39], v[96:99]
    ds_read_b128 v[60:63], v8 offset:640
    v_mfma_f32_16x16x32_bf16 v[108:111], v[200:203], v[36:39], v[108:111]
    s_waitcnt lgkmcnt(5)
    v_mfma_f32_16x16x32_bf16 v[64:67], v[180:183], v[40:43], 0
    ds_read_b128 v[20:23], v8 offset:576
    v_mfma_f32_16x16x32_bf16 v[76:79], v[188:191], v[40:43], 0
    s_waitcnt lgkmcnt(5)
    v_mfma_f32_16x16x32_bf16 v[64:67], v[176:179], v[44:47], v[64:67]
    ds_read_b128 v[24:27], v8 offset:512
    v_mfma_f32_16x16x32_bf16 v[76:79], v[184:187], v[44:47], v[76:79]
    s_waitcnt lgkmcnt(5)
    v_mfma_f32_16x16x32_bf16 v[64:67], v[172:175], v[48:51], v[64:67]
    ds_read_b128 v[28:31], v8 offset:448
    v_mfma_f32_16x16x32_bf16 v[76:79], v[180:183], v[48:51], v[76:79]
    v_add_f32 v89, v89, v94
    s_waitcnt lgkmcnt(5)
    v_mfma_f32_16x16x32_bf16 v[64:67], v[168:171], v[52:55], v[64:67]
    ds_read_b128 v[32:35], v8 offset:384
    v_mfma_f32_16x16x32_bf16 v[76:79], v[176:179], v[52:55], v[76:79]
    v_add_f32 v90, v90, v95
    s_waitcnt lgkmcnt(5)
    v_mfma_f32_16x16x32_bf16 v[64:67], v[164:167], v[56:59], v[64:67]
    ds_read_b128 v[36:39], v8 offset:320
    v_mfma_f32_16x16x32_bf16 v[76:79], v[172:175], v[56:59], v[76:79]
    v_add_f32 v91, v91, v96
    s_waitcnt lgkmcnt(5)
    v_mfma_f32_16x16x32_bf16 v[64:67], v[160:163], v[60:63], v[64:67]
    ds_read_b128 v[40:43], v8 offset:256
    v_mfma_f32_16x16x32_bf16 v[76:79], v[168:171], v[60:63], v[76:79]
    v_add_f32 v97, v97, v92
    s_waitcnt lgkmcnt(5)
    v_mfma_f32_16x16x32_bf16 v[64:67], v[156:159], v[20:23], v[64:67]
    ds_read_b128 v[44:47], v8 offset:192
    v_mfma_f32_16x16x32_bf16 v[76:79], v[164:167], v[20:23], v[76:79]
    v_add_f32 v98, v98, v93
    s_waitcnt lgkmcnt(5)
    v_mfma_f32_16x16x32_bf16 v[64:67], v[152:155], v[24:27], v[64:67]
    ds_read_b128 v[48:51], v8 offset:128
    v_mfma_f32_16x16x32_bf16 v[76:79], v[160:163], v[24:27], v[76:79]
    v_cvt_pk_bf16_f32 v112, v88, v89
    s_waitcnt lgkmcnt(5)
    v_mfma_f32_16x16x32_bf16 v[64:67], v[148:151], v[28:31], v[64:67]
    ds_read_b128 v[52:55], v8 offset:1216
    v_mfma_f32_16x16x32_bf16 v[76:79], v[156:159], v[28:31], v[76:79]
    v_cvt_pk_bf16_f32 v113, v90, v91
    s_waitcnt lgkmcnt(5)
    v_mfma_f32_16x16x32_bf16 v[64:67], v[144:147], v[32:35], v[64:67]
    ds_read_b128 v[56:59], v8 offset:64
    v_mfma_f32_16x16x32_bf16 v[76:79], v[152:155], v[32:35], v[76:79]
    v_cvt_pk_bf16_f32 v114, v97, v98
    s_waitcnt lgkmcnt(5)
    v_mfma_f32_16x16x32_bf16 v[64:67], v[140:143], v[36:39], v[64:67]
    ds_read_b128 v[60:63], v8 offset:1152
    v_mfma_f32_16x16x32_bf16 v[76:79], v[148:151], v[36:39], v[76:79]
    v_cvt_pk_bf16_f32 v115, v99, v16
    s_waitcnt lgkmcnt(5)
    v_mfma_f32_16x16x32_bf16 v[64:67], v[136:139], v[40:43], v[64:67]
    ds_read_b128 v[20:23], v8 offset:0
    v_mfma_f32_16x16x32_bf16 v[76:79], v[144:147], v[40:43], v[76:79]
    ds_write_b128 v9, v[112:115] offset:12352
    s_waitcnt lgkmcnt(6)
    v_mfma_f32_16x16x32_bf16 v[64:67], v[132:135], v[44:47], v[64:67]
    ds_read_b128 v[24:27], v8 offset:2112
    v_mfma_f32_16x16x32_bf16 v[76:79], v[140:143], v[44:47], v[76:79]
    v_add_f32 v101, v101, v106
    s_waitcnt lgkmcnt(6)
    v_mfma_f32_16x16x32_bf16 v[64:67], v[128:131], v[48:51], v[64:67]
    ds_read_b128 v[28:31], v8 offset:2048
    v_mfma_f32_16x16x32_bf16 v[76:79], v[136:139], v[48:51], v[76:79]
    v_add_f32 v102, v102, v107
    s_waitcnt lgkmcnt(5)
    v_mfma_f32_16x16x32_bf16 v[82:85], v[132:135], v[52:55], 0
    ds_read_b128 v[32:35], v8 offset:1984
    v_mfma_f32_16x16x32_bf16 v[76:79], v[132:135], v[56:59], v[76:79]
    ds_read_b128 v[36:39], v8 offset:1920
    s_waitcnt lgkmcnt(5)
    v_mfma_f32_16x16x32_bf16 v[82:85], v[128:131], v[60:63], v[82:85]
    ds_read_b128 v[40:43], v8 offset:1856
    v_mfma_f32_16x16x32_bf16 v[76:79], v[128:131], v[20:23], v[76:79]
    ds_read_b128 v[44:47], v8 offset:1792
    s_waitcnt lgkmcnt(5)
    v_mfma_f32_16x16x32_bf16 v[70:73], v[180:183], v[24:27], 0
    ds_read_b128 v[48:51], v8 offset:1728
    v_mfma_f32_16x16x32_bf16 v[82:85], v[188:191], v[24:27], v[82:85]
    v_add_f32 v103, v103, v108
    s_waitcnt lgkmcnt(5)
    v_mfma_f32_16x16x32_bf16 v[70:73], v[176:179], v[28:31], v[70:73]
    ds_read_b128 v[52:55], v8 offset:1664
    v_mfma_f32_16x16x32_bf16 v[82:85], v[184:187], v[28:31], v[82:85]
    v_add_f32 v109, v109, v104
    s_waitcnt lgkmcnt(5)
    v_mfma_f32_16x16x32_bf16 v[70:73], v[172:175], v[32:35], v[70:73]
    ds_read_b128 v[56:59], v8 offset:1600
    v_mfma_f32_16x16x32_bf16 v[82:85], v[180:183], v[32:35], v[82:85]
    v_add_f32 v110, v110, v105
    s_waitcnt lgkmcnt(5)
    v_mfma_f32_16x16x32_bf16 v[70:73], v[168:171], v[36:39], v[70:73]
    ds_read_b128 v[60:63], v8 offset:1536
    v_mfma_f32_16x16x32_bf16 v[82:85], v[176:179], v[36:39], v[82:85]
    v_cvt_pk_bf16_f32 v116, v100, v101
    s_waitcnt lgkmcnt(5)
    v_mfma_f32_16x16x32_bf16 v[70:73], v[164:167], v[40:43], v[70:73]
    ds_read_b128 v[20:23], v8 offset:1472
    v_mfma_f32_16x16x32_bf16 v[82:85], v[172:175], v[40:43], v[82:85]
    v_cvt_pk_bf16_f32 v117, v102, v103
    s_waitcnt lgkmcnt(5)
    v_mfma_f32_16x16x32_bf16 v[70:73], v[160:163], v[44:47], v[70:73]
    ds_read_b128 v[24:27], v8 offset:1408
    v_mfma_f32_16x16x32_bf16 v[82:85], v[168:171], v[44:47], v[82:85]
    v_cvt_pk_bf16_f32 v118, v109, v110
    s_waitcnt lgkmcnt(5)
    v_mfma_f32_16x16x32_bf16 v[70:73], v[156:159], v[48:51], v[70:73]
    ds_read_b128 v[28:31], v8 offset:1344
    v_mfma_f32_16x16x32_bf16 v[82:85], v[164:167], v[48:51], v[82:85]
    v_cvt_pk_bf16_f32 v119, v111, v16
    s_waitcnt lgkmcnt(5)
    v_mfma_f32_16x16x32_bf16 v[70:73], v[152:155], v[52:55], v[70:73]
    ds_read_b128 v[32:35], v8 offset:1280
    v_mfma_f32_16x16x32_bf16 v[82:85], v[160:163], v[52:55], v[82:85]
    ds_write_b128 v9, v[116:119] offset:13376
    s_waitcnt lgkmcnt(6)
    v_mfma_f32_16x16x32_bf16 v[70:73], v[148:151], v[56:59], v[70:73]
    ds_read_b128 v[36:39], v8 offset:3264
    v_mfma_f32_16x16x32_bf16 v[82:85], v[156:159], v[56:59], v[82:85]
    v_mov_b64 v[92:93], 0
    s_waitcnt lgkmcnt(6)
    v_mfma_f32_16x16x32_bf16 v[70:73], v[144:147], v[60:63], v[70:73]
    ds_read_b128 v[40:43], v8 offset:3200
    v_mfma_f32_16x16x32_bf16 v[82:85], v[152:155], v[60:63], v[82:85]
    v_mov_b64 v[98:99], 0
    s_waitcnt lgkmcnt(6)
    v_mfma_f32_16x16x32_bf16 v[70:73], v[140:143], v[20:23], v[70:73]
    ds_read_b128 v[44:47], v8 offset:3136
    v_mfma_f32_16x16x32_bf16 v[82:85], v[148:151], v[20:23], v[82:85]
    v_mov_b64 v[104:105], 0
    s_waitcnt lgkmcnt(6)
    v_mfma_f32_16x16x32_bf16 v[70:73], v[136:139], v[24:27], v[70:73]
    ds_read_b128 v[48:51], v8 offset:3072
    v_mfma_f32_16x16x32_bf16 v[82:85], v[144:147], v[24:27], v[82:85]
    v_mov_b64 v[110:111], 0
    s_waitcnt lgkmcnt(6)
    v_mfma_f32_16x16x32_bf16 v[70:73], v[132:135], v[28:31], v[70:73]
    ds_read_b128 v[52:55], v8 offset:3008
    v_mfma_f32_16x16x32_bf16 v[82:85], v[140:143], v[28:31], v[82:85]
    s_waitcnt lgkmcnt(6)
    v_mfma_f32_16x16x32_bf16 v[70:73], v[128:131], v[32:35], v[70:73]
    ds_read_b128 v[56:59], v8 offset:2944
    v_mfma_f32_16x16x32_bf16 v[82:85], v[136:139], v[32:35], v[82:85]
    s_waitcnt lgkmcnt(5)
    v_mfma_f32_16x16x32_bf16 v[66:69], v[180:183], v[36:39], v[66:69]
    ds_read_b128 v[60:63], v8 offset:2880
    v_mfma_f32_16x16x32_bf16 v[78:81], v[188:191], v[36:39], v[78:81]
    s_waitcnt lgkmcnt(5)
    v_mfma_f32_16x16x32_bf16 v[66:69], v[176:179], v[40:43], v[66:69]
    ds_read_b128 v[20:23], v8 offset:2816
    v_mfma_f32_16x16x32_bf16 v[78:81], v[184:187], v[40:43], v[78:81]
    s_waitcnt lgkmcnt(5)
    v_mfma_f32_16x16x32_bf16 v[66:69], v[172:175], v[44:47], v[66:69]
    ds_read_b128 v[24:27], v8 offset:2752
    v_mfma_f32_16x16x32_bf16 v[78:81], v[180:183], v[44:47], v[78:81]
    s_waitcnt lgkmcnt(5)
    v_mfma_f32_16x16x32_bf16 v[66:69], v[168:171], v[48:51], v[66:69]
    ds_read_b128 v[28:31], v8 offset:2688
    v_mfma_f32_16x16x32_bf16 v[78:81], v[176:179], v[48:51], v[78:81]
    s_waitcnt lgkmcnt(5)
    v_mfma_f32_16x16x32_bf16 v[66:69], v[164:167], v[52:55], v[66:69]
    ds_read_b128 v[32:35], v8 offset:2624
    v_mfma_f32_16x16x32_bf16 v[78:81], v[172:175], v[52:55], v[78:81]
    s_waitcnt lgkmcnt(5)
    v_mfma_f32_16x16x32_bf16 v[66:69], v[160:163], v[56:59], v[66:69]
    ds_read_b128 v[36:39], v8 offset:2560
    v_mfma_f32_16x16x32_bf16 v[78:81], v[168:171], v[56:59], v[78:81]
    s_waitcnt lgkmcnt(5)
    v_mfma_f32_16x16x32_bf16 v[66:69], v[156:159], v[60:63], v[66:69]
    ds_read_b128 v[40:43], v8 offset:2496
    v_mfma_f32_16x16x32_bf16 v[78:81], v[164:167], v[60:63], v[78:81]
    s_waitcnt lgkmcnt(5)
    v_mfma_f32_16x16x32_bf16 v[66:69], v[152:155], v[20:23], v[66:69]
    ds_read_b128 v[44:47], v8 offset:2432
    v_mfma_f32_16x16x32_bf16 v[78:81], v[160:163], v[20:23], v[78:81]
    s_waitcnt lgkmcnt(5)
    v_mfma_f32_16x16x32_bf16 v[66:69], v[148:151], v[24:27], v[66:69]
    ds_read_b128 v[48:51], v8 offset:3520
    v_mfma_f32_16x16x32_bf16 v[78:81], v[156:159], v[24:27], v[78:81]
    s_waitcnt lgkmcnt(5)
    v_mfma_f32_16x16x32_bf16 v[66:69], v[144:147], v[28:31], v[66:69]
    ds_read_b128 v[52:55], v8 offset:2368
    v_mfma_f32_16x16x32_bf16 v[78:81], v[152:155], v[28:31], v[78:81]
    s_waitcnt lgkmcnt(5)
    v_mfma_f32_16x16x32_bf16 v[66:69], v[140:143], v[32:35], v[66:69]
    ds_read_b128 v[56:59], v8 offset:3456
    v_mfma_f32_16x16x32_bf16 v[78:81], v[148:151], v[32:35], v[78:81]
    s_waitcnt lgkmcnt(5)
    v_mfma_f32_16x16x32_bf16 v[66:69], v[136:139], v[36:39], v[66:69]
    ds_read_b128 v[60:63], v8 offset:2304
    v_mfma_f32_16x16x32_bf16 v[78:81], v[144:147], v[36:39], v[78:81]
    s_waitcnt lgkmcnt(5)
    v_mfma_f32_16x16x32_bf16 v[66:69], v[132:135], v[40:43], v[66:69]
    ds_read_b128 v[20:23], v8 offset:4416
    v_mfma_f32_16x16x32_bf16 v[78:81], v[140:143], v[40:43], v[78:81]
    s_waitcnt lgkmcnt(5)
    v_mfma_f32_16x16x32_bf16 v[66:69], v[128:131], v[44:47], v[66:69]
    ds_read_b128 v[24:27], v8 offset:4352
    v_mfma_f32_16x16x32_bf16 v[78:81], v[136:139], v[44:47], v[78:81]
    s_waitcnt lgkmcnt(4)
    v_mfma_f32_16x16x32_bf16 v[84:87], v[132:135], v[48:51], v[84:87]
    ds_read_b128 v[28:31], v8 offset:4288
    v_mfma_f32_16x16x32_bf16 v[78:81], v[132:135], v[52:55], v[78:81]
    ds_read_b128 v[32:35], v8 offset:4224
    s_waitcnt lgkmcnt(4)
    v_mfma_f32_16x16x32_bf16 v[84:87], v[128:131], v[56:59], v[84:87]
    ds_read_b128 v[36:39], v8 offset:4160
    v_mfma_f32_16x16x32_bf16 v[78:81], v[128:131], v[60:63], v[78:81]
    ds_read_b128 v[40:43], v8 offset:4096
    s_waitcnt lgkmcnt(5)
    v_mfma_f32_16x16x32_bf16 v[72:75], v[180:183], v[20:23], v[72:75]
    ds_read_b128 v[44:47], v8 offset:4032
    v_mfma_f32_16x16x32_bf16 v[84:87], v[188:191], v[20:23], v[84:87]
    s_barrier
    s_waitcnt lgkmcnt(5)
    v_mfma_f32_16x16x32_bf16 v[72:75], v[176:179], v[24:27], v[72:75]
    ds_read_b128 v[48:51], v8 offset:3968
    v_mfma_f32_16x16x32_bf16 v[84:87], v[184:187], v[24:27], v[84:87]
    s_waitcnt lgkmcnt(5)
    v_mfma_f32_16x16x32_bf16 v[72:75], v[172:175], v[28:31], v[72:75]
    ds_read_b128 v[52:55], v8 offset:3904
    v_mfma_f32_16x16x32_bf16 v[84:87], v[180:183], v[28:31], v[84:87]
    s_waitcnt lgkmcnt(5)
    v_mfma_f32_16x16x32_bf16 v[72:75], v[168:171], v[32:35], v[72:75]
    ds_read_b128 v[56:59], v8 offset:3840
    v_mfma_f32_16x16x32_bf16 v[84:87], v[176:179], v[32:35], v[84:87]
    s_waitcnt lgkmcnt(5)
    v_mfma_f32_16x16x32_bf16 v[72:75], v[164:167], v[36:39], v[72:75]
    ds_read_b128 v[60:63], v8 offset:3776
    v_mfma_f32_16x16x32_bf16 v[84:87], v[172:175], v[36:39], v[84:87]
    s_waitcnt lgkmcnt(5)
    v_mfma_f32_16x16x32_bf16 v[72:75], v[160:163], v[40:43], v[72:75]
    ds_read_b128 v[20:23], v8 offset:3712
    v_mfma_f32_16x16x32_bf16 v[84:87], v[168:171], v[40:43], v[84:87]
    s_waitcnt lgkmcnt(5)
    v_mfma_f32_16x16x32_bf16 v[72:75], v[156:159], v[44:47], v[72:75]
    ds_read_b128 v[24:27], v8 offset:3648
    v_mfma_f32_16x16x32_bf16 v[84:87], v[164:167], v[44:47], v[84:87]
    s_waitcnt lgkmcnt(5)
    v_mfma_f32_16x16x32_bf16 v[72:75], v[152:155], v[48:51], v[72:75]
    ds_read_b128 v[28:31], v8 offset:3584
    v_mfma_f32_16x16x32_bf16 v[84:87], v[160:163], v[48:51], v[84:87]
    s_waitcnt lgkmcnt(5)
    v_mfma_f32_16x16x32_bf16 v[72:75], v[148:151], v[52:55], v[72:75]
    ds_read_b128 v[32:35], v8 offset:10320
    v_mfma_f32_16x16x32_bf16 v[84:87], v[156:159], v[52:55], v[84:87]
    s_waitcnt lgkmcnt(5)
    v_mfma_f32_16x16x32_bf16 v[72:75], v[144:147], v[56:59], v[72:75]
    ds_read_b128 v[36:39], v8 offset:10256
    v_mfma_f32_16x16x32_bf16 v[84:87], v[152:155], v[56:59], v[84:87]
    s_waitcnt lgkmcnt(5)
    v_mfma_f32_16x16x32_bf16 v[72:75], v[140:143], v[60:63], v[72:75]
    ds_read_b128 v[40:43], v8 offset:10192
    v_mfma_f32_16x16x32_bf16 v[84:87], v[148:151], v[60:63], v[84:87]
    s_waitcnt lgkmcnt(5)
    v_mfma_f32_16x16x32_bf16 v[72:75], v[136:139], v[20:23], v[72:75]
    ds_read_b128 v[44:47], v8 offset:10128
    v_mfma_f32_16x16x32_bf16 v[84:87], v[144:147], v[20:23], v[84:87]
    s_waitcnt lgkmcnt(5)
    v_mfma_f32_16x16x32_bf16 v[72:75], v[132:135], v[24:27], v[72:75]
    ds_read_b128 v[48:51], v8 offset:10064
    v_mfma_f32_16x16x32_bf16 v[84:87], v[140:143], v[24:27], v[84:87]
    s_waitcnt lgkmcnt(5)
    v_mfma_f32_16x16x32_bf16 v[72:75], v[128:131], v[28:31], v[72:75]
    ds_read_b128 v[52:55], v8 offset:10000
    v_mfma_f32_16x16x32_bf16 v[84:87], v[136:139], v[28:31], v[84:87]
    s_waitcnt lgkmcnt(5)
    v_mfma_f32_16x16x32_bf16 v[88:91], v[244:247], v[32:35], 0
    ds_read_b128 v[56:59], v8 offset:9936
    v_mfma_f32_16x16x32_bf16 v[100:103], v[252:255], v[32:35], 0
    s_waitcnt lgkmcnt(5)
    v_mfma_f32_16x16x32_bf16 v[88:91], v[240:243], v[36:39], v[88:91]
    ds_read_b128 v[60:63], v8 offset:9872
    v_mfma_f32_16x16x32_bf16 v[100:103], v[248:251], v[36:39], v[100:103]
    s_waitcnt lgkmcnt(5)
    v_mfma_f32_16x16x32_bf16 v[88:91], v[236:239], v[40:43], v[88:91]
    ds_read_b128 v[20:23], v8 offset:9808
    v_mfma_f32_16x16x32_bf16 v[100:103], v[244:247], v[40:43], v[100:103]
    v_add_f32 v65, v65, v70
    s_waitcnt lgkmcnt(5)
    v_mfma_f32_16x16x32_bf16 v[88:91], v[232:235], v[44:47], v[88:91]
    ds_read_b128 v[24:27], v8 offset:9744
    v_mfma_f32_16x16x32_bf16 v[100:103], v[240:243], v[44:47], v[100:103]
    v_add_f32 v66, v66, v71
    s_waitcnt lgkmcnt(5)
    v_mfma_f32_16x16x32_bf16 v[88:91], v[228:231], v[48:51], v[88:91]
    ds_read_b128 v[28:31], v8 offset:9680
    v_mfma_f32_16x16x32_bf16 v[100:103], v[236:239], v[48:51], v[100:103]
    v_add_f32 v67, v67, v72
    s_waitcnt lgkmcnt(5)
    v_mfma_f32_16x16x32_bf16 v[88:91], v[224:227], v[52:55], v[88:91]
    ds_read_b128 v[32:35], v8 offset:9616
    v_mfma_f32_16x16x32_bf16 v[100:103], v[232:235], v[52:55], v[100:103]
    v_add_f32 v73, v73, v68
    s_waitcnt lgkmcnt(5)
    v_mfma_f32_16x16x32_bf16 v[88:91], v[220:223], v[56:59], v[88:91]
    ds_read_b128 v[36:39], v8 offset:9552
    v_mfma_f32_16x16x32_bf16 v[100:103], v[228:231], v[56:59], v[100:103]
    v_add_f32 v74, v74, v69
    s_waitcnt lgkmcnt(5)
    v_mfma_f32_16x16x32_bf16 v[88:91], v[216:219], v[60:63], v[88:91]
    ds_read_b128 v[40:43], v8 offset:9488
    v_mfma_f32_16x16x32_bf16 v[100:103], v[224:227], v[60:63], v[100:103]
    v_cvt_pk_bf16_f32 v112, v64, v65
    s_waitcnt lgkmcnt(5)
    v_mfma_f32_16x16x32_bf16 v[88:91], v[212:215], v[20:23], v[88:91]
    ds_read_b128 v[44:47], v8 offset:10576
    v_mfma_f32_16x16x32_bf16 v[100:103], v[220:223], v[20:23], v[100:103]
    v_cvt_pk_bf16_f32 v113, v66, v67
    s_waitcnt lgkmcnt(5)
    v_mfma_f32_16x16x32_bf16 v[88:91], v[208:211], v[24:27], v[88:91]
    ds_read_b128 v[48:51], v8 offset:9424
    v_mfma_f32_16x16x32_bf16 v[100:103], v[216:219], v[24:27], v[100:103]
    v_cvt_pk_bf16_f32 v114, v73, v74
    s_waitcnt lgkmcnt(5)
    v_mfma_f32_16x16x32_bf16 v[88:91], v[204:207], v[28:31], v[88:91]
    ds_read_b128 v[52:55], v8 offset:10512
    v_mfma_f32_16x16x32_bf16 v[100:103], v[212:215], v[28:31], v[100:103]
    v_cvt_pk_bf16_f32 v115, v75, v16
    s_waitcnt lgkmcnt(5)
    v_mfma_f32_16x16x32_bf16 v[88:91], v[200:203], v[32:35], v[88:91]
    ds_read_b128 v[56:59], v8 offset:9360
    v_mfma_f32_16x16x32_bf16 v[100:103], v[208:211], v[32:35], v[100:103]
    ds_write_b128 v9, v[112:115] offset:6176
    s_waitcnt lgkmcnt(6)
    v_mfma_f32_16x16x32_bf16 v[88:91], v[196:199], v[36:39], v[88:91]
    ds_read_b128 v[60:63], v8 offset:11472
    v_mfma_f32_16x16x32_bf16 v[100:103], v[204:207], v[36:39], v[100:103]
    v_add_f32 v77, v77, v82
    s_waitcnt lgkmcnt(6)
    v_mfma_f32_16x16x32_bf16 v[88:91], v[192:195], v[40:43], v[88:91]
    ds_read_b128 v[20:23], v8 offset:11408
    v_mfma_f32_16x16x32_bf16 v[100:103], v[200:203], v[40:43], v[100:103]
    v_add_f32 v78, v78, v83
    s_waitcnt lgkmcnt(5)
    v_mfma_f32_16x16x32_bf16 v[106:109], v[196:199], v[44:47], 0
    ds_read_b128 v[24:27], v8 offset:11344
    v_mfma_f32_16x16x32_bf16 v[100:103], v[196:199], v[48:51], v[100:103]
    ds_read_b128 v[28:31], v8 offset:11280
    s_waitcnt lgkmcnt(5)
    v_mfma_f32_16x16x32_bf16 v[106:109], v[192:195], v[52:55], v[106:109]
    ds_read_b128 v[32:35], v8 offset:11216
    v_mfma_f32_16x16x32_bf16 v[100:103], v[192:195], v[56:59], v[100:103]
    ds_read_b128 v[36:39], v8 offset:11152
    s_waitcnt lgkmcnt(5)
    v_mfma_f32_16x16x32_bf16 v[94:97], v[244:247], v[60:63], 0
    ds_read_b128 v[40:43], v8 offset:11088
    v_mfma_f32_16x16x32_bf16 v[106:109], v[252:255], v[60:63], v[106:109]
    v_add_f32 v79, v79, v84
    s_waitcnt lgkmcnt(5)
    v_mfma_f32_16x16x32_bf16 v[94:97], v[240:243], v[20:23], v[94:97]
    ds_read_b128 v[44:47], v8 offset:11024
Lhk_m_2:
    s_cbranch_execz Lhr_m
    v_mfma_f32_16x16x32_bf16 v[106:109], v[248:251], v[20:23], v[106:109]
    v_add_f32 v85, v85, v80
    s_waitcnt lgkmcnt(5)
    v_mfma_f32_16x16x32_bf16 v[94:97], v[236:239], v[24:27], v[94:97]
    ds_read_b128 v[48:51], v8 offset:10960
    v_mfma_f32_16x16x32_bf16 v[106:109], v[244:247], v[24:27], v[106:109]
    v_add_f32 v86, v86, v81
    s_waitcnt lgkmcnt(5)
    v_mfma_f32_16x16x32_bf16 v[94:97], v[232:235], v[28:31], v[94:97]
    ds_read_b128 v[52:55], v8 offset:10896
    v_mfma_f32_16x16x32_bf16 v[106:109], v[240:243], v[28:31], v[106:109]
    v_cvt_pk_bf16_f32 v116, v76, v77
    s_waitcnt lgkmcnt(5)
    v_mfma_f32_16x16x32_bf16 v[94:97], v[228:231], v[32:35], v[94:97]
    ds_read_b128 v[56:59], v8 offset:10832
    v_mfma_f32_16x16x32_bf16 v[106:109], v[236:239], v[32:35], v[106:109]
    v_cvt_pk_bf16_f32 v117, v78, v79
    s_waitcnt lgkmcnt(5)
    v_mfma_f32_16x16x32_bf16 v[94:97], v[224:227], v[36:39], v[94:97]
    ds_read_b128 v[60:63], v8 offset:10768
    v_mfma_f32_16x16x32_bf16 v[106:109], v[232:235], v[36:39], v[106:109]
    v_cvt_pk_bf16_f32 v118, v85, v86
    s_waitcnt lgkmcnt(5)
    v_mfma_f32_16x16x32_bf16 v[94:97], v[220:223], v[40:43], v[94:97]
    ds_read_b128 v[20:23], v8 offset:10704
    v_mfma_f32_16x16x32_bf16 v[106:109], v[228:231], v[40:43], v[106:109]
    v_cvt_pk_bf16_f32 v119, v87, v16
    s_waitcnt lgkmcnt(5)
    v_mfma_f32_16x16x32_bf16 v[94:97], v[216:219], v[44:47], v[94:97]
    ds_read_b128 v[24:27], v8 offset:10640
    v_mfma_f32_16x16x32_bf16 v[106:109], v[224:227], v[44:47], v[106:109]
    ds_write_b128 v9, v[116:119] offset:7200
    s_waitcnt lgkmcnt(6)
    v_mfma_f32_16x16x32_bf16 v[94:97], v[212:215], v[48:51], v[94:97]
    ds_read_b128 v[28:31], v8 offset:12624
    v_mfma_f32_16x16x32_bf16 v[106:109], v[220:223], v[48:51], v[106:109]
    v_mov_b64 v[68:69], 0
    s_waitcnt lgkmcnt(6)
    v_mfma_f32_16x16x32_bf16 v[94:97], v[208:211], v[52:55], v[94:97]
    ds_read_b128 v[32:35], v8 offset:12560
    v_mfma_f32_16x16x32_bf16 v[106:109], v[216:219], v[52:55], v[106:109]
    v_mov_b64 v[74:75], 0
    s_waitcnt lgkmcnt(6)
    v_mfma_f32_16x16x32_bf16 v[94:97], v[204:207], v[56:59], v[94:97]
    ds_read_b128 v[36:39], v8 offset:12496
    v_mfma_f32_16x16x32_bf16 v[106:109], v[212:215], v[56:59], v[106:109]
    v_mov_b64 v[80:81], 0
    s_waitcnt lgkmcnt(6)
    v_mfma_f32_16x16x32_bf16 v[94:97], v[200:203], v[60:63], v[94:97]
    ds_read_b128 v[40:43], v8 offset:12432
    v_mfma_f32_16x16x32_bf16 v[106:109], v[208:211], v[60:63], v[106:109]
    v_mov_b64 v[86:87], 0
    s_waitcnt lgkmcnt(6)
    v_mfma_f32_16x16x32_bf16 v[94:97], v[196:199], v[20:23], v[94:97]
    ds_read_b128 v[44:47], v8 offset:12368
    v_mfma_f32_16x16x32_bf16 v[106:109], v[204:207], v[20:23], v[106:109]
    s_waitcnt lgkmcnt(6)
    v_mfma_f32_16x16x32_bf16 v[94:97], v[192:195], v[24:27], v[94:97]
    ds_read_b128 v[48:51], v8 offset:12304
    v_mfma_f32_16x16x32_bf16 v[106:109], v[200:203], v[24:27], v[106:109]
    s_waitcnt lgkmcnt(5)
    v_mfma_f32_16x16x32_bf16 v[90:93], v[244:247], v[28:31], v[90:93]
    ds_read_b128 v[52:55], v8 offset:12240
    v_mfma_f32_16x16x32_bf16 v[102:105], v[252:255], v[28:31], v[102:105]
    s_waitcnt lgkmcnt(5)
    v_mfma_f32_16x16x32_bf16 v[90:93], v[240:243], v[32:35], v[90:93]
    ds_read_b128 v[56:59], v8 offset:12176
    v_mfma_f32_16x16x32_bf16 v[102:105], v[248:251], v[32:35], v[102:105]
    s_waitcnt lgkmcnt(5)
    v_mfma_f32_16x16x32_bf16 v[90:93], v[236:239], v[36:39], v[90:93]
    ds_read_b128 v[60:63], v8 offset:12112
    v_mfma_f32_16x16x32_bf16 v[102:105], v[244:247], v[36:39], v[102:105]
    s_waitcnt lgkmcnt(5)
    v_mfma_f32_16x16x32_bf16 v[90:93], v[232:235], v[40:43], v[90:93]
    ds_read_b128 v[20:23], v8 offset:12048
    v_mfma_f32_16x16x32_bf16 v[102:105], v[240:243], v[40:43], v[102:105]
    s_waitcnt lgkmcnt(5)
    v_mfma_f32_16x16x32_bf16 v[90:93], v[228:231], v[44:47], v[90:93]
    ds_read_b128 v[24:27], v8 offset:11984
    v_mfma_f32_16x16x32_bf16 v[102:105], v[236:239], v[44:47], v[102:105]
    s_waitcnt lgkmcnt(5)
    v_mfma_f32_16x16x32_bf16 v[90:93], v[224:227], v[48:51], v[90:93]
    ds_read_b128 v[28:31], v8 offset:11920
    v_mfma_f32_16x16x32_bf16 v[102:105], v[232:235], v[48:51], v[102:105]
    s_waitcnt lgkmcnt(5)
    v_mfma_f32_16x16x32_bf16 v[90:93], v[220:223], v[52:55], v[90:93]
    ds_read_b128 v[32:35], v8 offset:11856
    v_mfma_f32_16x16x32_bf16 v[102:105], v[228:231], v[52:55], v[102:105]
    s_waitcnt lgkmcnt(5)
    v_mfma_f32_16x16x32_bf16 v[90:93], v[216:219], v[56:59], v[90:93]
    ds_read_b128 v[36:39], v8 offset:11792
    v_mfma_f32_16x16x32_bf16 v[102:105], v[224:227], v[56:59], v[102:105]
    s_waitcnt lgkmcnt(5)
    v_mfma_f32_16x16x32_bf16 v[90:93], v[212:215], v[60:63], v[90:93]
    ds_read_b128 v[40:43], v8 offset:12880
    v_mfma_f32_16x16x32_bf16 v[102:105], v[220:223], v[60:63], v[102:105]
    s_waitcnt lgkmcnt(5)
    v_mfma_f32_16x16x32_bf16 v[90:93], v[208:211], v[20:23], v[90:93]
    ds_read_b128 v[44:47], v8 offset:11728
    v_mfma_f32_16x16x32_bf16 v[102:105], v[216:219], v[20:23], v[102:105]
    s_waitcnt lgkmcnt(5)
    v_mfma_f32_16x16x32_bf16 v[90:93], v[204:207], v[24:27], v[90:93]
    ds_read_b128 v[48:51], v8 offset:12816
    v_mfma_f32_16x16x32_bf16 v[102:105], v[212:215], v[24:27], v[102:105]
    s_waitcnt lgkmcnt(5)
    v_mfma_f32_16x16x32_bf16 v[90:93], v[200:203], v[28:31], v[90:93]
    ds_read_b128 v[52:55], v8 offset:11664
    v_mfma_f32_16x16x32_bf16 v[102:105], v[208:211], v[28:31], v[102:105]
    s_waitcnt lgkmcnt(5)
    v_mfma_f32_16x16x32_bf16 v[90:93], v[196:199], v[32:35], v[90:93]
    ds_read_b128 v[56:59], v8 offset:13776
    v_mfma_f32_16x16x32_bf16 v[102:105], v[204:207], v[32:35], v[102:105]
    s_waitcnt lgkmcnt(5)
    v_mfma_f32_16x16x32_bf16 v[90:93], v[192:195], v[36:39], v[90:93]
    ds_read_b128 v[60:63], v8 offset:13712
    v_mfma_f32_16x16x32_bf16 v[102:105], v[200:203], v[36:39], v[102:105]
    s_waitcnt lgkmcnt(4)
    v_mfma_f32_16x16x32_bf16 v[108:111], v[196:199], v[40:43], v[108:111]
    ds_read_b128 v[20:23], v8 offset:13648
    v_mfma_f32_16x16x32_bf16 v[102:105], v[196:199], v[44:47], v[102:105]
    ds_read_b128 v[24:27], v8 offset:13584
    s_waitcnt lgkmcnt(4)
    v_mfma_f32_16x16x32_bf16 v[108:111], v[192:195], v[48:51], v[108:111]
    ds_read_b128 v[28:31], v8 offset:13520
    v_mfma_f32_16x16x32_bf16 v[102:105], v[192:195], v[52:55], v[102:105]
    ds_read_b128 v[32:35], v8 offset:13456
    s_waitcnt lgkmcnt(5)
    v_mfma_f32_16x16x32_bf16 v[96:99], v[244:247], v[56:59], v[96:99]
    ds_read_b128 v[36:39], v8 offset:13392
    v_mfma_f32_16x16x32_bf16 v[108:111], v[252:255], v[56:59], v[108:111]
    s_waitcnt lgkmcnt(5)
    v_mfma_f32_16x16x32_bf16 v[96:99], v[240:243], v[60:63], v[96:99]
    ds_read_b128 v[40:43], v8 offset:13328
    v_mfma_f32_16x16x32_bf16 v[108:111], v[248:251], v[60:63], v[108:111]
    s_waitcnt lgkmcnt(5)
    v_mfma_f32_16x16x32_bf16 v[96:99], v[236:239], v[20:23], v[96:99]
    ds_read_b128 v[44:47], v8 offset:13264
    v_mfma_f32_16x16x32_bf16 v[108:111], v[244:247], v[20:23], v[108:111]
    s_waitcnt lgkmcnt(5)
    v_mfma_f32_16x16x32_bf16 v[96:99], v[232:235], v[24:27], v[96:99]
    ds_read_b128 v[48:51], v8 offset:13200
    v_mfma_f32_16x16x32_bf16 v[108:111], v[240:243], v[24:27], v[108:111]
    s_waitcnt lgkmcnt(5)
    v_mfma_f32_16x16x32_bf16 v[96:99], v[228:231], v[28:31], v[96:99]
    ds_read_b128 v[52:55], v8 offset:13136
    v_mfma_f32_16x16x32_bf16 v[108:111], v[236:239], v[28:31], v[108:111]
    s_waitcnt lgkmcnt(5)
    v_mfma_f32_16x16x32_bf16 v[96:99], v[224:227], v[32:35], v[96:99]
    ds_read_b128 v[56:59], v8 offset:13072
    v_mfma_f32_16x16x32_bf16 v[108:111], v[232:235], v[32:35], v[108:111]
    s_waitcnt lgkmcnt(5)
    v_mfma_f32_16x16x32_bf16 v[96:99], v[220:223], v[36:39], v[96:99]
    ds_read_b128 v[60:63], v8 offset:13008
    v_mfma_f32_16x16x32_bf16 v[108:111], v[228:231], v[36:39], v[108:111]
    s_waitcnt lgkmcnt(5)
    v_mfma_f32_16x16x32_bf16 v[96:99], v[216:219], v[40:43], v[96:99]
    ds_read_b128 v[20:23], v8 offset:12944
    v_mfma_f32_16x16x32_bf16 v[108:111], v[224:227], v[40:43], v[108:111]
    s_waitcnt lgkmcnt(5)
    v_mfma_f32_16x16x32_bf16 v[96:99], v[212:215], v[44:47], v[96:99]
    v_mfma_f32_16x16x32_bf16 v[108:111], v[220:223], v[44:47], v[108:111]
    s_waitcnt lgkmcnt(4)
    v_mfma_f32_16x16x32_bf16 v[96:99], v[208:211], v[48:51], v[96:99]
    v_mfma_f32_16x16x32_bf16 v[108:111], v[216:219], v[48:51], v[108:111]
    s_waitcnt lgkmcnt(3)
    v_mfma_f32_16x16x32_bf16 v[96:99], v[204:207], v[52:55], v[96:99]
    v_mfma_f32_16x16x32_bf16 v[108:111], v[212:215], v[52:55], v[108:111]
    s_waitcnt lgkmcnt(2)
    v_mfma_f32_16x16x32_bf16 v[96:99], v[200:203], v[56:59], v[96:99]
    v_mfma_f32_16x16x32_bf16 v[108:111], v[208:211], v[56:59], v[108:111]
    s_waitcnt lgkmcnt(1)
    v_mfma_f32_16x16x32_bf16 v[96:99], v[196:199], v[60:63], v[96:99]
    v_mfma_f32_16x16x32_bf16 v[108:111], v[204:207], v[60:63], v[108:111]
    s_waitcnt lgkmcnt(0)
    v_mfma_f32_16x16x32_bf16 v[96:99], v[192:195], v[20:23], v[96:99]
    v_mfma_f32_16x16x32_bf16 v[108:111], v[200:203], v[20:23], v[108:111]
    v_add_f32 v89, v89, v94
    v_add_f32 v90, v90, v95
    s_nop 4
    v_add_f32 v91, v91, v96
    v_add_f32 v97, v97, v92
    v_add_f32 v98, v98, v93
    v_cvt_pk_bf16_f32 v112, v88, v89
    v_cvt_pk_bf16_f32 v113, v90, v91
    v_cvt_pk_bf16_f32 v114, v97, v98
    v_cvt_pk_bf16_f32 v115, v99, v16
    ds_write_b128 v9, v[112:115] offset:14400
    v_add_f32 v101, v101, v106
    v_add_f32 v102, v102, v107
    v_add_f32 v103, v103, v108
    v_add_f32 v109, v109, v104
    v_add_f32 v110, v110, v105
    v_cvt_pk_bf16_f32 v116, v100, v101
    v_cvt_pk_bf16_f32 v117, v102, v103
    v_cvt_pk_bf16_f32 v118, v109, v110
    v_cvt_pk_bf16_f32 v119, v111, v16
    ds_write_b128 v9, v[116:119] offset:15424
    s_waitcnt lgkmcnt(0)
    s_barrier
    s_endpgm
L_cl:
    s_mov_b32 s12, s48
    s_and_b32 s13, s49, 0xffff
    s_mov_b32 s14, 2621440
    s_mov_b32 s15, 0x00020000
    s_mov_b32 s32, s78
    s_and_b32 s33, s79, 0xffff
    s_mov_b32 s34, 10485760
    s_mov_b32 s35, 0x00020000
    s_lshl_b32 s43, s36, 10
    s_add_u32 s43, s43, 393216
    v_min_u32 v29, 7, v1
    v_lshl_add_u32 v29, v29, 7, s43
    v_and_b32 v20, 255, v0
    v_and_b32 v21, 1, v20
    v_lshrrev_b32 v20, 1, v20
    v_and_b32 v22, 63, v20
    v_subrev_u32 v30, 16, v20
    v_add_u32 v31, 47, v20
    v_cmp_gt_u32 vcc, 16, v22
    s_nop 1
    v_cndmask_b32 v30, v30, v31, vcc
    v_add_u32 v31, -1, v20
    v_cmp_eq_u32 vcc, 0, v22
    s_nop 1
    v_cndmask_b32 v30, v30, v31, vcc
    v_lshlrev_b32 v30, 4, v30
    v_add_u32 v30, 40, v30
    v_lshl_add_u32 v31, v20, 4, 32
    v_mul_u32_u24 v25, 32896, v21
    v_add_u32 v30, v30, v25
    v_add_u32 v31, v31, v25
    v_cmp_eq_u32 vcc, 1, v21
    s_nop 1
    v_cndmask_b32 v25, v31, v30, vcc
    v_cndmask_b32 v26, v30, v31, vcc
    v_lshrrev_b32 v30, 6, v20
    v_lshlrev_b32 v30, 8, v30
    v_and_b32 v31, 15, v22
    v_lshl_add_u32 v30, v31, 4, v30
    v_lshrrev_b32 v31, 4, v22
    v_lshl_add_u32 v30, v31, 2, v30
    v_mul_lo_u32 v30, v30, s46
    s_lshl_b32 s43, s36, 4
    v_lshl_add_u32 v31, v21, 3, s43
    v_add_u32 v27, v30, v31
    v_lshlrev_b32 v28, 2, v30
    v_lshl_add_u32 v28, v31, 1, v28
    s_sub_u32 s43, s45, 21
    s_lshl_b32 s43, s43, 2
    s_add_u32 s43, s43, s41
    s_mul_i32 s47, s43, 5462
    s_lshr_b32 s47, s47, 16
    s_mul_i32 s0, s47, 12
    s_sub_u32 s43, s43, s0
    s_sub_u32 s0, s43, 6
    s_cselect_b32 s43, s43, s0
    s_cselect_b64 s[28:29], s[70:71], s[72:73]
    s_and_b32 s0, s44, 1
    s_lshl_b32 s0, s0, 2
    s_add_u32 s43, s43, s0
    s_mov_b32 s30, 819200
    s_mov_b32 s31, 0x00020000
    s_mul_i32 s43, s43, 81920
    s_lshl_b32 s47, s47, 7
    s_add_u32 s43, s43, s47
    v_mul_u32_u24 v43, 1280, v1
    v_add_u32 v43, s43, v43
    buffer_load_dword v44, v43, s[28:31], 0 offen
    s_sub_u32 s43, s45, 21
    s_lshl_b32 s43, s43, 2
    s_add_u32 s43, s43, s41
    s_add_u32 s43, s43, 40
    s_mul_i32 s47, s43, 5462
    s_lshr_b32 s47, s47, 16
    s_mul_i32 s0, s47, 12
    s_sub_u32 s43, s43, s0
    s_sub_u32 s0, s43, 6
    s_cselect_b32 s43, s43, s0
    s_cselect_b64 s[28:29], s[70:71], s[72:73]
    s_and_b32 s0, s44, 1
    s_lshl_b32 s0, s0, 2
    s_add_u32 s43, s43, s0
    s_mov_b32 s30, 819200
    s_mov_b32 s31, 0x00020000
    s_mul_i32 s43, s43, 81920
    s_lshl_b32 s47, s47, 7
    s_add_u32 s43, s43, s47
    v_mul_u32_u24 v43, 1280, v1
    v_add_u32 v43, s43, v43
    buffer_load_dword v44, v43, s[28:31], 0 offen
    s_cmp_lg_u32 s3, 4
    s_cbranch_scc1 Lp1_11
    s_mov_b32 s47, 200000
    s_mov_b64 exec, 255
Lpl_12:
    s_sleep 8
    buffer_load_dword v5, v29, s[4:7], 0 offen sc1
    s_waitcnt vmcnt(0)
    v_cmp_ne_u32 vcc, s42, v5
    s_nop 0
    s_and_b32 exec_lo, vcc_lo, exec_lo
    s_cbranch_scc0 Lpok_13
    s_sub_u32 s47, s47, 1
    s_cbranch_scc0 Lpl_12
Lpok_13:
    s_mov_b64 exec, -1
    s_cmp_lg_u32 s38, 0
    s_cbranch_scc1 Lep_14
    s_lshl_b32 s43, s37, 8
    v_mov_b32 v6, s43
    v_mov_b32 v7, s42
    s_mov_b64 exec, 1
    buffer_store_dword v7, v6, s[4:7], 0 offen sc1
    s_mov_b64 exec, -1
Lep_14:
Lp1_11:
    s_waitcnt lgkmcnt(0)
    s_barrier
    s_barrier
    s_sub_u32 s43, s45, 21
    s_lshl_b32 s43, s43, 2
    s_add_u32 s43, s43, s41
    s_add_u32 s43, s43, 80
    s_mul_i32 s47, s43, 5462
    s_lshr_b32 s47, s47, 16
    s_mul_i32 s0, s47, 12
    s_sub_u32 s43, s43, s0
    s_sub_u32 s0, s43, 6
    s_cselect_b32 s43, s43, s0
    s_cselect_b64 s[28:29], s[70:71], s[72:73]
    s_and_b32 s0, s44, 1
    s_lshl_b32 s0, s0, 2
    s_add_u32 s43, s43, s0
    s_mov_b32 s30, 819200
    s_mov_b32 s31, 0x00020000
    s_mul_i32 s43, s43, 81920
    s_lshl_b32 s47, s47, 7
    s_add_u32 s43, s43, s47
    v_mul_u32_u24 v43, 1280, v1
    v_add_u32 v43, s43, v43
    buffer_load_dword v44, v43, s[28:31], 0 offen
    s_mov_b32 s40, 0
    buffer_load_dwordx2 v[160:161], v27, s[12:15], s40 offen offset:0
    buffer_load_dwordx2 v[162:163], v27, s[12:15], s40 offen offset:1280
    buffer_load_dwordx2 v[164:165], v27, s[12:15], s40 offen offset:2560
    buffer_load_dwordx2 v[166:167], v27, s[12:15], s40 offen offset:3840
    s_mov_b32 s40, 655360
    buffer_load_dwordx2 v[168:169], v27, s[12:15], s40 offen offset:0
    buffer_load_dwordx2 v[170:171], v27, s[12:15], s40 offen offset:1280
    buffer_load_dwordx2 v[172:173], v27, s[12:15], s40 offen offset:2560
    buffer_load_dwordx2 v[174:175], v27, s[12:15], s40 offen offset:3840
    s_barrier
    ds_read_b64 v[192:193], v25 offset:0
    ds_read_b64 v[200:201], v26 offset:0
    ds_read_b64 v[194:195], v25 offset:8224
    ds_read_b64 v[202:203], v26 offset:8224
    ds_read_b64 v[196:197], v25 offset:16448
    ds_read_b64 v[204:205], v26 offset:16448
    ds_read_b64 v[198:199], v25 offset:24672
    ds_read_b64 v[206:207], v26 offset:24672
    s_waitcnt vmcnt(4)
    v_lshlrev_b32 v224, 16, v160
    v_and_b32 v225, 0xffff0000, v160
    v_lshlrev_b32 v226, 16, v161
    v_and_b32 v227, 0xffff0000, v161
    v_lshlrev_b32 v228, 16, v162
    v_and_b32 v229, 0xffff0000, v162
    v_lshlrev_b32 v230, 16, v163
    v_and_b32 v231, 0xffff0000, v163
    v_lshlrev_b32 v232, 16, v164
    v_and_b32 v233, 0xffff0000, v164
    v_lshlrev_b32 v234, 16, v165
    v_and_b32 v235, 0xffff0000, v165
    v_lshlrev_b32 v236, 16, v166
    v_and_b32 v237, 0xffff0000, v166
    v_lshlrev_b32 v238, 16, v167
    v_and_b32 v239, 0xffff0000, v167
    s_waitcnt lgkmcnt(0)
    v_lshlrev_b32 v208, 16, v192
    v_lshlrev_b32 v212, 16, v200
    v_lshlrev_b32 v209, 16, v194
    v_lshlrev_b32 v213, 16, v202
    v_lshlrev_b32 v210, 16, v196
    v_lshlrev_b32 v214, 16, v204
    v_lshlrev_b32 v211, 16, v198
    v_lshlrev_b32 v215, 16, v206
    v_add_f32 v208, v208, v212
    v_add_f32 v209, v209, v213
    v_add_f32 v210, v210, v214
    v_add_f32 v211, v211, v215
    v_mul_f32 v224, v224, v208
    v_mul_f32 v225, v225, v209
    v_mul_f32 v226, v226, v210
    v_mul_f32 v227, v227, v211
    s_mov_b32 s43, 0
    buffer_store_dwordx4 v[224:227], v28, s[32:35], s43 offen
    v_and_b32 v208, 0xffff0000, v192
    v_and_b32 v212, 0xffff0000, v200
    v_and_b32 v209, 0xffff0000, v194
    v_and_b32 v213, 0xffff0000, v202
    v_and_b32 v210, 0xffff0000, v196
    v_and_b32 v214, 0xffff0000, v204
    v_and_b32 v211, 0xffff0000, v198
    v_and_b32 v215, 0xffff0000, v206
    v_add_f32 v208, v208, v212
    v_add_f32 v209, v209, v213
    v_add_f32 v210, v210, v214
    v_add_f32 v211, v211, v215
    v_mul_f32 v228, v228, v208
    v_mul_f32 v229, v229, v209
    v_mul_f32 v230, v230, v210
    v_mul_f32 v231, v231, v211
    s_mov_b32 s43, 5120
    buffer_store_dwordx4 v[228:231], v28, s[32:35], s43 offen
    v_lshlrev_b32 v208, 16, v193
    v_lshlrev_b32 v212, 16, v201
    v_lshlrev_b32 v209, 16, v195
    v_lshlrev_b32 v213, 16, v203
    v_lshlrev_b32 v210, 16, v197
    v_lshlrev_b32 v214, 16, v205
    v_lshlrev_b32 v211, 16, v199
    v_lshlrev_b32 v215, 16, v207
    v_add_f32 v208, v208, v212
    v_add_f32 v209, v209, v213
    v_add_f32 v210, v210, v214
    v_add_f32 v211, v211, v215
    v_mul_f32 v232, v232, v208
    v_mul_f32 v233, v233, v209
    v_mul_f32 v234, v234, v210
    v_mul_f32 v235, v235, v211
    s_mov_b32 s43, 10240
    buffer_store_dwordx4 v[232:235], v28, s[32:35], s43 offen
    v_and_b32 v208, 0xffff0000, v193
    v_and_b32 v212, 0xffff0000, v201
    v_and_b32 v209, 0xffff0000, v195
    v_and_b32 v213, 0xffff0000, v203
    v_and_b32 v210, 0xffff0000, v197
    v_and_b32 v214, 0xffff0000, v205
    v_and_b32 v211, 0xffff0000, v199
    v_and_b32 v215, 0xffff0000, v207
    v_add_f32 v208, v208, v212
    v_add_f32 v209, v209, v213
    v_add_f32 v210, v210, v214
    v_add_f32 v211, v211, v215
    v_mul_f32 v236, v236, v208
    v_mul_f32 v237, v237, v209
    v_mul_f32 v238, v238, v210
    v_mul_f32 v239, v239, v211
    s_mov_b32 s43, 15360
    buffer_store_dwordx4 v[236:239], v28, s[32:35], s43 offen
    ds_read_b64 v[192:193], v25 offset:2048
    ds_read_b64 v[200:201], v26 offset:2048
    ds_read_b64 v[194:195], v25 offset:10272
    ds_read_b64 v[202:203], v26 offset:10272
    ds_read_b64 v[196:197], v25 offset:18496
    ds_read_b64 v[204:205], v26 offset:18496
    ds_read_b64 v[198:199], v25 offset:26720
    ds_read_b64 v[206:207], v26 offset:26720
    s_waitcnt vmcnt(4)
    v_lshlrev_b32 v224, 16, v168
    v_and_b32 v225, 0xffff0000, v168
    v_lshlrev_b32 v226, 16, v169
    v_and_b32 v227, 0xffff0000, v169
    v_lshlrev_b32 v228, 16, v170
    v_and_b32 v229, 0xffff0000, v170
    v_lshlrev_b32 v230, 16, v171
    v_and_b32 v231, 0xffff0000, v171
    v_lshlrev_b32 v232, 16, v172
    v_and_b32 v233, 0xffff0000, v172
    v_lshlrev_b32 v234, 16, v173
    v_and_b32 v235, 0xffff0000, v173
    v_lshlrev_b32 v236, 16, v174
    v_and_b32 v237, 0xffff0000, v174
    v_lshlrev_b32 v238, 16, v175
    v_and_b32 v239, 0xffff0000, v175
    s_waitcnt lgkmcnt(0)
    v_lshlrev_b32 v208, 16, v192
    v_lshlrev_b32 v212, 16, v200
    v_lshlrev_b32 v209, 16, v194
    v_lshlrev_b32 v213, 16, v202
    v_lshlrev_b32 v210, 16, v196
    v_lshlrev_b32 v214, 16, v204
    v_lshlrev_b32 v211, 16, v198
    v_lshlrev_b32 v215, 16, v206
    v_add_f32 v208, v208, v212
    v_add_f32 v209, v209, v213
    v_add_f32 v210, v210, v214
    v_add_f32 v211, v211, v215
    v_mul_f32 v224, v224, v208
    v_mul_f32 v225, v225, v209
    v_mul_f32 v226, v226, v210
    v_mul_f32 v227, v227, v211
    s_mov_b32 s43, 2621440
    buffer_store_dwordx4 v[224:227], v28, s[32:35], s43 offen
    v_and_b32 v208, 0xffff0000, v192
    v_and_b32 v212, 0xffff0000, v200
    v_and_b32 v209, 0xffff0000, v194
    v_and_b32 v213, 0xffff0000, v202
    v_and_b32 v210, 0xffff0000, v196
    v_and_b32 v214, 0xffff0000, v204
    v_and_b32 v211, 0xffff0000, v198
    v_and_b32 v215, 0xffff0000, v206
    v_add_f32 v208, v208, v212
    v_add_f32 v209, v209, v213
    v_add_f32 v210, v210, v214
    v_add_f32 v211, v211, v215
    v_mul_f32 v228, v228, v208
    v_mul_f32 v229, v229, v209
    v_mul_f32 v230, v230, v210
    v_mul_f32 v231, v231, v211
    s_mov_b32 s43, 2626560
    buffer_store_dwordx4 v[228:231], v28, s[32:35], s43 offen
    v_lshlrev_b32 v208, 16, v193
    v_lshlrev_b32 v212, 16, v201
    v_lshlrev_b32 v209, 16, v195
    v_lshlrev_b32 v213, 16, v203
    v_lshlrev_b32 v210, 16, v197
    v_lshlrev_b32 v214, 16, v205
    v_lshlrev_b32 v211, 16, v199
    v_lshlrev_b32 v215, 16, v207
    v_add_f32 v208, v208, v212
    v_add_f32 v209, v209, v213
    v_add_f32 v210, v210, v214
    v_add_f32 v211, v211, v215
    v_mul_f32 v232, v232, v208
    v_mul_f32 v233, v233, v209
    v_mul_f32 v234, v234, v210
    v_mul_f32 v235, v235, v211
    s_mov_b32 s43, 2631680
    buffer_store_dwordx4 v[232:235], v28, s[32:35], s43 offen
    v_and_b32 v208, 0xffff0000, v193
    v_and_b32 v212, 0xffff0000, v201
    v_and_b32 v209, 0xffff0000, v195
    v_and_b32 v213, 0xffff0000, v203
    v_and_b32 v210, 0xffff0000, v197
    v_and_b32 v214, 0xffff0000, v205
    v_and_b32 v211, 0xffff0000, v199
    v_and_b32 v215, 0xffff0000, v207
    v_add_f32 v208, v208, v212
    v_add_f32 v209, v209, v213
    v_add_f32 v210, v210, v214
    v_add_f32 v211, v211, v215
    v_mul_f32 v236, v236, v208
    v_mul_f32 v237, v237, v209
    v_mul_f32 v238, v238, v210
    v_mul_f32 v239, v239, v211
    s_mov_b32 s43, 2636800
    buffer_store_dwordx4 v[236:239], v28, s[32:35], s43 offen
    s_barrier
    s_mov_b32 s40, 1310720
    buffer_load_dwordx2 v[176:177], v27, s[12:15], s40 offen offset:0
    buffer_load_dwordx2 v[178:179], v27, s[12:15], s40 offen offset:1280
    buffer_load_dwordx2 v[180:181], v27, s[12:15], s40 offen offset:2560
    buffer_load_dwordx2 v[182:183], v27, s[12:15], s40 offen offset:3840
    s_mov_b32 s40, 1966080
    buffer_load_dwordx2 v[184:185], v27, s[12:15], s40 offen offset:0
    buffer_load_dwordx2 v[186:187], v27, s[12:15], s40 offen offset:1280
    buffer_load_dwordx2 v[188:189], v27, s[12:15], s40 offen offset:2560
    buffer_load_dwordx2 v[190:191], v27, s[12:15], s40 offen offset:3840
    ds_read_b64 v[192:193], v25 offset:4096
    ds_read_b64 v[200:201], v26 offset:4096
    ds_read_b64 v[194:195], v25 offset:12320
    ds_read_b64 v[202:203], v26 offset:12320
    ds_read_b64 v[196:197], v25 offset:20544
    ds_read_b64 v[204:205], v26 offset:20544
    ds_read_b64 v[198:199], v25 offset:28768
    ds_read_b64 v[206:207], v26 offset:28768
    s_waitcnt vmcnt(4)
    v_lshlrev_b32 v224, 16, v176
    v_and_b32 v225, 0xffff0000, v176
    v_lshlrev_b32 v226, 16, v177
    v_and_b32 v227, 0xffff0000, v177
    v_lshlrev_b32 v228, 16, v178
    v_and_b32 v229, 0xffff0000, v178
    v_lshlrev_b32 v230, 16, v179
    v_and_b32 v231, 0xffff0000, v179
    v_lshlrev_b32 v232, 16, v180
    v_and_b32 v233, 0xffff0000, v180
    v_lshlrev_b32 v234, 16, v181
    v_and_b32 v235, 0xffff0000, v181
    v_lshlrev_b32 v236, 16, v182
    v_and_b32 v237, 0xffff0000, v182
    v_lshlrev_b32 v238, 16, v183
    v_and_b32 v239, 0xffff0000, v183
    s_waitcnt lgkmcnt(0)
    v_lshlrev_b32 v208, 16, v192
    v_lshlrev_b32 v212, 16, v200
    v_lshlrev_b32 v209, 16, v194
    v_lshlrev_b32 v213, 16, v202
    v_lshlrev_b32 v210, 16, v196
    v_lshlrev_b32 v214, 16, v204
    v_lshlrev_b32 v211, 16, v198
    v_lshlrev_b32 v215, 16, v206
    v_add_f32 v208, v208, v212
    v_add_f32 v209, v209, v213
    v_add_f32 v210, v210, v214
    v_add_f32 v211, v211, v215
    v_mul_f32 v224, v224, v208
    v_mul_f32 v225, v225, v209
    v_mul_f32 v226, v226, v210
    v_mul_f32 v227, v227, v211
    s_mov_b32 s43, 5242880
    buffer_store_dwordx4 v[224:227], v28, s[32:35], s43 offen
    v_and_b32 v208, 0xffff0000, v192
    v_and_b32 v212, 0xffff0000, v200
    v_and_b32 v209, 0xffff0000, v194
    v_and_b32 v213, 0xffff0000, v202
    v_and_b32 v210, 0xffff0000, v196
    v_and_b32 v214, 0xffff0000, v204
    v_and_b32 v211, 0xffff0000, v198
    v_and_b32 v215, 0xffff0000, v206
    v_add_f32 v208, v208, v212
    v_add_f32 v209, v209, v213
    v_add_f32 v210, v210, v214
    v_add_f32 v211, v211, v215
    v_mul_f32 v228, v228, v208
    v_mul_f32 v229, v229, v209
    v_mul_f32 v230, v230, v210
    v_mul_f32 v231, v231, v211
    s_mov_b32 s43, 5248000
    buffer_store_dwordx4 v[228:231], v28, s[32:35], s43 offen
    v_lshlrev_b32 v208, 16, v193
    v_lshlrev_b32 v212, 16, v201
    v_lshlrev_b32 v209, 16, v195
    v_lshlrev_b32 v213, 16, v203
    v_lshlrev_b32 v210, 16, v197
    v_lshlrev_b32 v214, 16, v205
    v_lshlrev_b32 v211, 16, v199
    v_lshlrev_b32 v215, 16, v207
    v_add_f32 v208, v208, v212
    v_add_f32 v209, v209, v213
    v_add_f32 v210, v210, v214
    v_add_f32 v211, v211, v215
    v_mul_f32 v232, v232, v208
    v_mul_f32 v233, v233, v209
    v_mul_f32 v234, v234, v210
    v_mul_f32 v235, v235, v211
    s_mov_b32 s43, 5253120
    buffer_store_dwordx4 v[232:235], v28, s[32:35], s43 offen
    v_and_b32 v208, 0xffff0000, v193
    v_and_b32 v212, 0xffff0000, v201
    v_and_b32 v209, 0xffff0000, v195
    v_and_b32 v213, 0xffff0000, v203
    v_and_b32 v210, 0xffff0000, v197
    v_and_b32 v214, 0xffff0000, v205
    v_and_b32 v211, 0xffff0000, v199
    v_and_b32 v215, 0xffff0000, v207
    v_add_f32 v208, v208, v212
    v_add_f32 v209, v209, v213
    v_add_f32 v210, v210, v214
    v_add_f32 v211, v211, v215
    v_mul_f32 v236, v236, v208
    v_mul_f32 v237, v237, v209
    v_mul_f32 v238, v238, v210
    v_mul_f32 v239, v239, v211
    s_mov_b32 s43, 5258240
    buffer_store_dwordx4 v[236:239], v28, s[32:35], s43 offen
    s_waitcnt vmcnt(4)
    v_lshlrev_b32 v224, 16, v184
    v_and_b32 v225, 0xffff0000, v184
    v_lshlrev_b32 v226, 16, v185
    v_and_b32 v227, 0xffff0000, v185
    v_lshlrev_b32 v228, 16, v186
    v_and_b32 v229, 0xffff0000, v186
    v_lshlrev_b32 v230, 16, v187
    v_and_b32 v231, 0xffff0000, v187
    v_lshlrev_b32 v232, 16, v188
    v_and_b32 v233, 0xffff0000, v188
    v_lshlrev_b32 v234, 16, v189
    v_and_b32 v235, 0xffff0000, v189
    v_lshlrev_b32 v236, 16, v190
    v_and_b32 v237, 0xffff0000, v190
    v_lshlrev_b32 v238, 16, v191
    v_and_b32 v239, 0xffff0000, v191
    s_barrier
    ds_read_b64 v[192:193], v25 offset:6144
    ds_read_b64 v[200:201], v26 offset:6144
    ds_read_b64 v[194:195], v25 offset:14368
    ds_read_b64 v[202:203], v26 offset:14368
    ds_read_b64 v[196:197], v25 offset:22592
    ds_read_b64 v[204:205], v26 offset:22592
    ds_read_b64 v[198:199], v25 offset:30816
    ds_read_b64 v[206:207], v26 offset:30816
    s_waitcnt lgkmcnt(0)
    v_lshlrev_b32 v208, 16, v192
    v_lshlrev_b32 v212, 16, v200
    v_lshlrev_b32 v209, 16, v194
    v_lshlrev_b32 v213, 16, v202
    v_lshlrev_b32 v210, 16, v196
    v_lshlrev_b32 v214, 16, v204
    v_lshlrev_b32 v211, 16, v198
    v_lshlrev_b32 v215, 16, v206
    v_add_f32 v208, v208, v212
    v_add_f32 v209, v209, v213
    v_add_f32 v210, v210, v214
    v_add_f32 v211, v211, v215
Lhk_m_3:
    s_cbranch_execz Lhr_m
    v_mul_f32 v224, v224, v208
    v_mul_f32 v225, v225, v209
    v_mul_f32 v226, v226, v210
    v_mul_f32 v227, v227, v211
    s_mov_b32 s43, 7864320
    buffer_store_dwordx4 v[224:227], v28, s[32:35], s43 offen
    v_and_b32 v208, 0xffff0000, v192
    v_and_b32 v212, 0xffff0000, v200
    v_and_b32 v209, 0xffff0000, v194
    v_and_b32 v213, 0xffff0000, v202
    v_and_b32 v210, 0xffff0000, v196
    v_and_b32 v214, 0xffff0000, v204
    v_and_b32 v211, 0xffff0000, v198
    v_and_b32 v215, 0xffff0000, v206
    v_add_f32 v208, v208, v212
    v_add_f32 v209, v209, v213
    v_add_f32 v210, v210, v214
    v_add_f32 v211, v211, v215
    v_mul_f32 v228, v228, v208
    v_mul_f32 v229, v229, v209
    v_mul_f32 v230, v230, v210
    v_mul_f32 v231, v231, v211
    s_mov_b32 s43, 7869440
    buffer_store_dwordx4 v[228:231], v28, s[32:35], s43 offen
    v_lshlrev_b32 v208, 16, v193
    v_lshlrev_b32 v212, 16, v201
    v_lshlrev_b32 v209, 16, v195
    v_lshlrev_b32 v213, 16, v203
    v_lshlrev_b32 v210, 16, v197
    v_lshlrev_b32 v214, 16, v205
    v_lshlrev_b32 v211, 16, v199
    v_lshlrev_b32 v215, 16, v207
    v_add_f32 v208, v208, v212
    v_add_f32 v209, v209, v213
    v_add_f32 v210, v210, v214
    v_add_f32 v211, v211, v215
    v_mul_f32 v232, v232, v208
    v_mul_f32 v233, v233, v209
    v_mul_f32 v234, v234, v210
    v_mul_f32 v235, v235, v211
    s_mov_b32 s43, 7874560
    buffer_store_dwordx4 v[232:235], v28, s[32:35], s43 offen
    v_and_b32 v208, 0xffff0000, v193
    v_and_b32 v212, 0xffff0000, v201
    v_and_b32 v209, 0xffff0000, v195
    v_and_b32 v213, 0xffff0000, v203
    v_and_b32 v210, 0xffff0000, v197
    v_and_b32 v214, 0xffff0000, v205
    v_and_b32 v211, 0xffff0000, v199
    v_and_b32 v215, 0xffff0000, v207
    v_add_f32 v208, v208, v212
    v_add_f32 v209, v209, v213
    v_add_f32 v210, v210, v214
    v_add_f32 v211, v211, v215
    v_mul_f32 v236, v236, v208
    v_mul_f32 v237, v237, v209
    v_mul_f32 v238, v238, v210
    v_mul_f32 v239, v239, v211
    s_mov_b32 s43, 7879680
    buffer_store_dwordx4 v[236:239], v28, s[32:35], s43 offen
    s_endpgm
L_pf2:
    s_waitcnt lgkmcnt(0)
    s_cmp_lg_u32 s45, 0
    s_cselect_b32 s43, 8, 0
    s_add_u32 s43, s43, s3
    s_cmp_ge_u32 s43, 52
    s_cbranch_scc1 Ltx_16
    s_mul_i32 s30, s43, 5042
    s_lshr_b32 s30, s30, 16
    s_mul_i32 s47, s30, 13
    s_sub_u32 s43, s43, s47
    s_lshl_b32 s30, s30, 1
    s_and_b32 s0, s44, 1
    s_lshr_b32 s1, s44, 1
    s_mul_i32 s47, s1, 5
    s_add_u32 s47, s47, s43
    s_sub_u32 s47, s47, 8
    s_cmp_ge_i32 s47, 10
    s_cselect_b32 s28, 10, 0
    s_cselect_b32 vcc_lo, 1, 0
    s_sub_u32 s47, s47, s28
    s_mul_i32 s31, s0, 5
    s_add_u32 s31, s31, s47
    s_cmp_lt_i32 s47, 5
    s_cselect_b32 s47, 0, 5
    s_cselect_b64 s[28:29], s[66:67], s[68:69]
    s_sub_u32 s31, s31, s47
    s_lshl_b32 s1, s1, 3
    s_add_u32 s1, s1, s43
    s_cmp_lt_u32 s43, 8
    s_cselect_b32 s1, s1, s31
    s_cselect_b32 s0, s0, vcc_lo
    s_cselect_b64 s[28:29], s[60:61], s[28:29]
    s_cselect_b32 s47, 2621440, 0
    s_add_u32 s0, s0, s30
    s_max_u32 s30, s47, 819200
    s_mov_b32 s31, 0x00020000
    s_mul_i32 s1, s1, 81920
    s_lshl_b32 s0, s0, 7
    s_add_u32 s1, s1, s0
    v_mul_u32_u24 v13, 1280, v1
    v_add_u32 v13, s1, v13
    buffer_load_dword v14, v13, s[28:31], 0 offen offset:256
Ltx_16:
    s_cmp_lg_u32 s45, 0
    s_cselect_b32 s43, 24, 16
    s_add_u32 s43, s43, s3
    s_cmp_ge_u32 s43, 52
    s_cbranch_scc1 Ltx_17
    s_mul_i32 s30, s43, 5042
    s_lshr_b32 s30, s30, 16
    s_mul_i32 s47, s30, 13
    s_sub_u32 s43, s43, s47
    s_lshl_b32 s30, s30, 1
    s_and_b32 s0, s44, 1
    s_lshr_b32 s1, s44, 1
    s_mul_i32 s47, s1, 5
    s_add_u32 s47, s47, s43
    s_sub_u32 s47, s47, 8
    s_cmp_ge_i32 s47, 10
    s_cselect_b32 s28, 10, 0
    s_cselect_b32 vcc_lo, 1, 0
    s_sub_u32 s47, s47, s28
    s_mul_i32 s31, s0, 5
    s_add_u32 s31, s31, s47
    s_cmp_lt_i32 s47, 5
    s_cselect_b32 s47, 0, 5
    s_cselect_b64 s[28:29], s[66:67], s[68:69]
    s_sub_u32 s31, s31, s47
    s_lshl_b32 s1, s1, 3
    s_add_u32 s1, s1, s43
    s_cmp_lt_u32 s43, 8
    s_cselect_b32 s1, s1, s31
    s_cselect_b32 s0, s0, vcc_lo
    s_cselect_b64 s[28:29], s[60:61], s[28:29]
    s_cselect_b32 s47, 2621440, 0
    s_add_u32 s0, s0, s30
    s_max_u32 s30, s47, 819200
    s_mov_b32 s31, 0x00020000
    s_mul_i32 s1, s1, 81920
    s_lshl_b32 s0, s0, 7
    s_add_u32 s1, s1, s0
    v_mul_u32_u24 v13, 1280, v1
    v_add_u32 v13, s1, v13
    buffer_load_dword v14, v13, s[28:31], 0 offen offset:256
Ltx_17:
    s_cmp_lg_u32 s45, 0
    s_cselect_b32 s20, 8, 0
    s_add_u32 s20, s20, s44
    s_lshl_b32 s21, s20, 16
    v_lshl_add_u32 v6, v0, 7, s21
    s_mov_b32 s12, s70
    s_and_b32 s13, s71, 0xffff
    s_mov_b32 s14, 819200
    s_mov_b32 s15, 0x00020000
    s_mov_b32 s16, s72
    s_and_b32 s17, s73, 0xffff
    s_mov_b32 s18, 819200
    s_mov_b32 s19, 0x00020000
    s_mov_b32 s23, 0
    buffer_load_dword v12, v6, s[12:15], s23 offen
    buffer_load_dword v12, v6, s[16:19], s23 offen
    s_cmp_lg_u32 s45, 0
    s_cselect_b32 s20, 8, 0
    s_add_u32 s20, s20, s44
    s_lshl_b32 s21, s20, 16
    v_lshl_add_u32 v6, v0, 7, s21
    s_mov_b32 s12, s48
    s_and_b32 s13, s49, 0xffff
    s_mov_b32 s14, 2621440
    s_mov_b32 s15, 0x00020000
    s_mov_b32 s23, 0
    buffer_load_dword v12, v6, s[12:15], s23 offen
    s_mov_b32 s23, 1048576
    buffer_load_dword v12, v6, s[12:15], s23 offen
    s_mov_b32 s23, 2097152
    buffer_load_dword v12, v6, s[12:15], s23 offen
    s_waitcnt vmcnt(0)
L_exit:
    s_endpgm
.section .rodata,"a"
.p2align 6
.amdhsa_kernel concat_heads__ssm_conv_h3__ssm_conv_s5__prompt_kernel
  .amdhsa_next_free_vgpr 256
  .amdhsa_next_free_sgpr 102
  .amdhsa_accum_offset 256
  .amdhsa_group_segment_fixed_size 0
  .amdhsa_kernarg_size 144
  .amdhsa_user_sgpr_count 2
  .amdhsa_user_sgpr_kernarg_segment_ptr 1
  .amdhsa_system_sgpr_workgroup_id_x 1
.end_amdhsa_kernel
```
